```python
import torch

def _softmax(x, axis=-1):
    return torch.softmax(x, dim=axis)
def _gelu(x):
    return torch.nn.functional.gelu(x, approximate="tanh")
def _silu(x):
    return torch.nn.functional.silu(x)
def _sigmoid(x):
    return torch.sigmoid(x)
def _layernorm(x, axis=-1, eps=1e-5):
    m = x.mean(dim=axis, keepdim=True)
    v = x.var(dim=axis, keepdim=True, unbiased=False)
    return (x - m) / torch.sqrt(v + eps)
def _scatter_add(tgt, idx, src, axis=0):
    return tgt.clone().index_add_(axis, idx, src)
def _segment_sum(src, seg, n):
    out = torch.zeros((n,) + src.shape[1:], dtype=src.dtype)
    return out.index_add_(0, seg, src)
def _pad(x, pw):
    flat = tuple(v for pair in reversed(pw) for v in pair)
    return torch.nn.functional.pad(x, flat)

kernel_name = 'recurrent_scan__ssm_conv_s5__glu_gated_swiglu__prompt'

def setup_inputs():

    _w = (lambda a: (lambda t: t.to(torch.bfloat16) if t.is_floating_point() else t)(torch.as_tensor(a)))
    def _A_setup():
        B, S, D = 1, 2048, 512
        P = D
        Lambda_re = -0.5 * (lambda _x: torch.exp(torch.as_tensor(_x)))((lambda *s: torch.randn(*s, dtype=torch.bfloat16) * 0.8)(P))
        Lambda_im = (lambda *s: torch.randn(*s, dtype=torch.bfloat16) * 0.8)(P) * 1.0
        B_re = (lambda *s: torch.randn(*s, dtype=torch.bfloat16) * 0.8)(P, D) * (D ** -0.5)
        B_im = (lambda *s: torch.randn(*s, dtype=torch.bfloat16) * 0.8)(P, D) * (D ** -0.5)
        C_re = (lambda *s: torch.randn(*s, dtype=torch.bfloat16) * 0.8)(D, P) * (P ** -0.5)
        C_im = (lambda *s: torch.randn(*s, dtype=torch.bfloat16) * 0.8)(D, P) * (P ** -0.5)
        log_dt = (lambda *s: torch.randn(*s, dtype=torch.bfloat16) * 0.8)(P) * 0.3 - 2.0
        Dskip = (lambda *s: torch.randn(*s, dtype=torch.bfloat16) * 0.8)(D)
        return {
            "x": _w((lambda *s: torch.randn(*s, dtype=torch.bfloat16) * 0.05)(B, S, D)),
            "Lambda_re": _w(Lambda_re),
            "Lambda_im": _w(Lambda_im),
            "B_re": _w(B_re),
            "B_im": _w(B_im),
            "C_re": _w(C_re),
            "C_im": _w(C_im),
            "log_dt": _w(log_dt),
            "Dskip": _w(Dskip),
        }
    _A_in = _A_setup()

    def _B_setup():
        B, S, D, F = 1, 2048, 512, 1792
        return {
            "x": _w((lambda *s: torch.randn(*s, dtype=torch.bfloat16) * 0.05)(B, S, D)),
            "w1": _w((lambda *s: torch.randn(*s, dtype=torch.bfloat16) * 0.2)(D, F) * (2.0 / D) ** 0.5),
            "w3": _w((lambda *s: torch.randn(*s, dtype=torch.bfloat16) * 0.2)(D, F) * (2.0 / D) ** 0.5),
            "w2": _w((lambda *s: torch.randn(*s, dtype=torch.bfloat16) * 0.2)(F, D) * (2.0 / F) ** 0.5),
        }
    _B_in = _B_setup()

    return {
        "A_x": _A_in["x"],
        "A_Lambda_re": _A_in["Lambda_re"],
        "A_Lambda_im": _A_in["Lambda_im"],
        "A_B_re": _A_in["B_re"],
        "A_B_im": _A_in["B_im"],
        "A_C_re": _A_in["C_re"],
        "A_C_im": _A_in["C_im"],
        "A_log_dt": _A_in["log_dt"],
        "A_Dskip": _A_in["Dskip"],
        "B_x": _B_in["x"],
        "B_w1": _B_in["w1"],
        "B_w3": _B_in["w3"],
        "B_w2": _B_in["w2"],
    }

def reference(A_x, A_Lambda_re, A_Lambda_im, A_B_re, A_B_im, A_C_re, A_C_im, A_log_dt, A_Dskip, B_x, B_w1, B_w3, B_w2):
    def _A_ref(x, Lambda_re, Lambda_im, B_re, B_im, C_re, C_im, log_dt, Dskip):
        Bsz, L, H = x.shape
        Lam = Lambda_re + 1j * Lambda_im
        Bmat = B_re + 1j * B_im
        Cmat = C_re + 1j * C_im
        dt = torch.exp(log_dt)
        Lam_bar = torch.exp(dt * Lam)
        B_bar = ((Lam_bar - 1.0) / Lam)[:, None] * Bmat
        Bu = torch.einsum("bld,pd->blp", x + 0j, B_bar)
        h = torch.zeros_like(Bu[:, 0, :])
        hs = []
        for t in range(L):
            h = Lam_bar[None, :] * h + Bu[:, t, :]
            hs.append(h)
        hseq = torch.stack(hs, 1)
        y = 2.0 * torch.einsum("blp,dp->bld", hseq, Cmat).real + x * Dskip[None, None, :]
        return y

    def _B_ref(x, w1, w3, w2):
        gate = torch.einsum("bsd,df->bsf", x, w1)
        up = torch.einsum("bsd,df->bsf", x, w3)
        h = _silu(gate) * up
        out = torch.einsum("bsf,fd->bsd", h, w2)
        return out

    x = A_x
    xn = _layernorm(x, axis=-1)
    s = _A_ref(xn, A_Lambda_re, A_Lambda_im, A_B_re, A_B_im, A_C_re, A_C_im, A_log_dt, A_Dskip)
    g = _silu(_B_ref(xn, B_w1, B_w3, B_w2))
    return x + s * g
```

```asm
; @launch grid=(256,1,1) block=(256,1,1) lds=163840
.amdgcn_target "amdgcn-amd-amdhsa--gfx950"
.text
.globl recurrent_scan__ssm_conv_s5__glu_gated_swiglu__prompt_kernel
.p2align 8
.type recurrent_scan__ssm_conv_s5__glu_gated_swiglu__prompt_kernel,@function
recurrent_scan__ssm_conv_s5__glu_gated_swiglu__prompt_kernel:
  s_cmp_ge_u32 s2, 256
  s_cbranch_scc1 FZ_done
  s_load_dwordx16 s[64:79], s[0:1], 0
  s_load_dwordx8 s[80:87], s[0:1], 64
  s_load_dwordx8 s[88:95], s[0:1], 96
  s_memrealtime s[24:25]
  v_and_b32 v193, 63, v0
  v_lshrrev_b32 v222, 6, v0
  s_nop 0
  v_readfirstlane_b32 s32, v222
  s_getpc_b64 s[4:5]
PF_base:
  s_lshr_b32 s6, s2, 3
  s_and_b32 s6, s6, 1
  s_lshl_b32 s6, s6, 15
  v_lshlrev_b32 v223, 7, v0
  v_add_u32 v223, s6, v223
  v_min_u32 v223, TEXT_END-PF_base-4, v223
  v_mov_b32 v226, s4
  v_mov_b32 v227, s5
  v_add_co_u32 v226, vcc, v226, v223
  s_nop 1
  v_addc_co_u32 v227, vcc, 0, v227, vcc
  global_load_dword v255, v[226:227], off
  s_and_b32 s48, s2, 7
  s_lshr_b32 s49, s2, 3
  s_lshr_b32 s41, s49, 2
  s_and_b32 s39, s49, 3
  s_and_b32 s50, s48, 1
  s_lshl_b32 s33, s41, 1
  s_add_u32 s33, s33, s50
  s_lshr_b32 s40, s48, 1
  s_lshl_b32 s34, s40, 2
  s_add_u32 s34, s34, s39
  s_lshl_b32 s48, s39, 1
  s_mov_b32 s35, 0
  s_mul_i32 s101, s40, 7
  s_add_u32 s101, s101, s48
  s_lshl_b32 s101, s101, 7
  s_and_b32 s37, s32, 1
  s_lshr_b32 s38, s32, 1
  s_mov_b32 s10, 2097152
  s_mov_b32 s11, 0x00020000
  s_mov_b32 s14, 1835008
  s_mov_b32 s15, 0x00020000
  s_mov_b32 s18, 1835008
  s_mov_b32 s19, 0x00020000
  s_mov_b32 s6, 1835008
  s_mov_b32 s7, 0x00020000
  s_mov_b32 s26, 524288
  s_mov_b32 s27, 0x00020000
  s_mov_b32 s22, 16777216
  s_mov_b32 s23, 0x00020000
  s_mov_b32 s30, 256
  s_mov_b32 s31, 0x00020000
  s_lshl_b32 s42, s33, 2
  s_add_u32 s42, s42, s32
  s_lshl_b32 s42, s42, 15
  s_lshl_b32 s43, s34, 15
  s_lshl_b32 s48, s37, 13
  s_add_u32 s43, s43, s48
  s_mul_i32 s44, s32, 57344
  s_add_u32 s44, s44, s101
  s_lshl_b32 s51, s32, 12
  s_lshl_b32 s52, s32, 11
  s_lshl_b32 s53, s32, 13
  v_lshlrev_b32 v194, 4, v193
  v_lshrrev_b32 v222, 5, v193
  v_lshlrev_b32 v222, 4, v222
  v_and_b32 v223, 8, v193
  v_add_u32 v222, v222, v223
  v_bfe_u32 v223, v193, 4, 1
  v_add_u32 v222, v222, v223
  v_lshlrev_b32 v222, 10, v222
  v_and_b32 v223, 7, v193
  v_lshrrev_b32 v224, 4, v193
  v_xor_b32 v225, v223, v224
  v_lshl_add_u32 v196, v225, 4, v222
  v_xor_b32 v197, 64, v196
  v_add_u32 v197, 1024, v197
  v_add_u32 v198, 2048, v196
  v_add_u32 v199, 2048, v197
  v_bfe_u32 v222, v193, 4, 1
  v_lshlrev_b32 v222, 2, v222
  v_xor_b32 v222, v222, v223
  v_lshlrev_b32 v222, 4, v222
  v_lshrrev_b32 v225, 3, v193
  v_mul_u32_u24 v200, 3584, v225
  v_add_u32 v200, v200, v222
  v_add_u32 v201, 27648, v200
  v_add_u32 v202, 55296, v200
  v_add_u32 v203, 82944, v200
  s_lshl_b32 s48, s37, 2
  v_add_u32 v224, s48, v224
  v_xor_b32 v222, v223, v224
  v_lshlrev_b32 v222, 4, v222
  v_lshl_add_u32 v204, v225, 10, v222
  v_add_u32 v205, 15360, v204
  v_and_b32 v240, 31, v193
  v_bfe_u32 v241, v193, 1, 3
  v_lshrrev_b32 v242, 5, v193
  v_xor_b32 v241, v241, v242
  v_lshlrev_b32 v241, 4, v241
  v_lshl_add_u32 v243, v240, 7, v241
  s_lshl_b32 s48, s37, 13
  v_add_u32 v184, s48, v243
  v_xor_b32 v185, 32, v184
  v_xor_b32 v186, 64, v184
  v_xor_b32 v187, 96, v184
  v_lshrrev_b32 v242, 3, v240
  v_lshlrev_b32 v242, 11, v242
  v_and_b32 v243, 7, v240
  v_lshl_add_u32 v242, v243, 7, v242
  v_add_u32 v242, v242, v241
  s_lshl_b32 s48, s38, 10
  s_add_u32 s48, s48, 16384
  v_add_u32 v188, s48, v242
  v_xor_b32 v189, 32, v188
  v_xor_b32 v190, 64, v188
  v_xor_b32 v191, 96, v188
  v_lshrrev_b32 v241, 5, v193
  v_bfe_u32 v242, v193, 2, 2
  v_lshl_add_u32 v241, v241, 3, v242
  v_and_b32 v243, 3, v193
  v_lshlrev_b32 v243, 3, v243
  v_lshl_add_u32 v243, v241, 7, v243
  v_bfe_u32 v240, v193, 4, 1
  v_lshl_add_u32 v243, v240, 5, v243
  v_lshrrev_b32 v242, 1, v242
  v_lshlrev_b32 v242, 6, v242
  v_add_u32 v243, v243, v242
  s_lshl_b32 s48, s38, 6
  v_xor_b32 v192, s48, v243
  s_lshl_b32 s48, s37, 6
  v_xor_b32 v195, s48, v243
  s_lshl_b32 s48, s38, 13
  s_cmp_eq_u32 s39, 3
  s_cselect_b32 s48, 0, s48
  s_add_u32 s48, s48, 147456
  v_add_u32 v195, s48, v195
  s_mov_b32 s56, 0
  s_mov_b32 s57, -1
  s_mov_b32 s58, 0xffff0000
  s_mov_b32 s59, 0xffff0000
  s_lshl_b32 s48, s33, 2
  s_lshl_b32 s49, s37, 1
  s_add_u32 s48, s48, s49
  s_mul_i32 s54, s48, 180224
  s_lshl_b32 s48, s101, 5
  s_lshl_b32 s49, s38, 11
  s_add_u32 s48, s48, s49
  s_add_u32 s55, s54, s48
  v_mov_b32 v116, 0
  v_mov_b32 v117, 0
  v_mov_b32 v118, 0
  v_mov_b32 v119, 0
  v_add_u32 v240, 131584, v194
  ds_write_b128 v240, v[116:119]
  s_lshl_b32 s48, s33, 7
  s_lshl_b32 s49, s34, 3
  s_add_u32 s48, s48, s49
  s_lshl_b32 s49, s32, 1
  s_add_u32 s48, s48, s49
  s_lshl_b32 s96, s48, 10
  s_lshr_b32 s50, s33, 3
  s_lshl_b32 s50, s50, 4
  s_and_b32 s48, s33, 3
  s_lshl_b32 s48, s48, 2
  s_add_u32 s50, s50, s48
  s_lshl_b32 s48, s34, 5
  s_add_u32 s50, s50, s48
  s_add_u32 s50, s50, s32
  s_lshl_b32 s50, s50, 10
  v_add_u32 v104, s50, v194
  s_lshl_b32 s97, s33, 2
  s_add_u32 s97, s97, s32
  s_lshl_b32 s97, s97, 3
  s_lshl_b32 s50, s34, 9
  s_add_u32 s97, s97, s50
  s_add_u32 s97, s97, 12648448
  v_and_b32 v240, 31, v193
  v_lshlrev_b32 v240, 1, v240
  s_lshl_b32 s48, s34, 6
  v_add_u32 v111, s48, v240
  s_waitcnt lgkmcnt(0)
  s_cmp_eq_u32 s39, 3
  s_cbranch_scc1 FZ_L
  s_mov_b64 s[8:9], s[64:65]
  s_mov_b64 s[28:29], s[92:93]
  s_or_b32 s49, s2, s32
  s_cmp_eq_u32 s49, 0
  s_cbranch_scc0 FZH_nn1
  s_or_b32 s48, s24, 1
  v_mov_b32 v240, s48
  v_lshlrev_b32 v241, 10, v193
  buffer_store_dword v240, v241, s[28:31], 0 offen sc1
FZH_nn1:
  buffer_load_dwordx4 v[96:99], v194, s[8:11], s96 offen
  buffer_load_dwordx4 v[100:103], v194, s[8:11], s96 offen offset:1024
  s_mov_b64 s[12:13], s[84:85]
  s_cmp_eq_u32 s38, 0
  s_cselect_b64 s[24:25], s[70:71], s[72:73]
  s_bitcmp1_b32 s33, 2
  s_cselect_b64 s[48:49], s[72:73], s[70:71]
  global_load_dwordx4 v[104:107], v104, s[48:49]
  global_load_ushort v108, v111, s[66:67]
  global_load_ushort v109, v111, s[68:69]
  global_load_ushort v110, v111, s[78:79]
  s_mov_b64 s[20:21], s[94:95]
  s_mov_b64 s[16:17], s[86:87]
  s_and_b32 s48, s33, 1
  s_cmp_eq_u32 s48, 0
  s_cselect_b64 s[4:5], s[84:85], s[86:87]
  s_add_u32 s45, s35, 0
  s_and_b32 s45, s45, 7
  s_lshl_b32 s46, s45, 7
  s_add_u32 s47, s42, s46
  s_add_u32 m0, s51, 0
  s_nop 0
  buffer_load_dwordx4 v196, s[8:11], s47 offen offset:0 lds
  s_mov_b64 s[64:65], s[88:89]
  s_mov_b32 s66, 1835008
  s_mov_b32 s67, 0x00020000
  s_mov_b64 s[68:69], s[74:75]
  s_mov_b32 s70, 524288
  s_mov_b32 s71, 0x00020000
  s_mov_b64 s[84:85], s[76:77]
  s_mov_b32 s86, 524288
  s_mov_b32 s87, 0x00020000
  s_mov_b64 s[92:93], s[90:91]
  s_mov_b32 s94, 4194304
  s_mov_b32 s95, 0x00020000
  s_and_b32 s48, s2, 7
  s_lshl_b32 s48, s48, 2
  buffer_load_dwordx4 v197, s[8:11], s47 offen offset:1024 lds
  s_add_u32 s48, s48, s39
  s_mul_i32 s49, s48, 360448
  s_mul_i32 s72, s32, 28672
  s_add_u32 s72, s72, s49
  s_lshl_b32 s73, s32, 14
  s_add_u32 s73, s73, s49
  s_add_u32 s73, s73, 114688
  s_mul_i32 s78, s32, 458752
  s_lshl_b32 s77, s41, 7
  s_add_u32 s78, s78, s77
  s_lshl_b32 s79, s41, 16
  s_lshl_b32 s49, s32, 8
  s_add_u32 s79, s79, s49
  s_lshl_b32 s74, s48, 2
  buffer_load_dwordx4 v198, s[8:11], s47 offen offset:2048 lds
  s_add_u32 s74, s74, s32
  s_lshl_b32 s74, s74, 7
  s_add_u32 s74, s74, 14155776
  s_lshl_b32 s48, s48, 6
  s_lshl_b32 s49, s32, 4
  s_add_u32 s48, s48, s49
  s_lshl_b32 s75, s48, 10
  s_add_u32 s75, s75, s77
  s_lshl_b32 s88, s75, 1
  s_lshl_b32 s76, s48, 3
  s_add_u32 s76, s76, 12582912
  s_lshl_b32 s100, s33, 1
  s_add_u32 s100, s100, s37
  s_lshl_b32 s100, s100, 2
  buffer_load_dwordx4 v199, s[8:11], s47 offen offset:3072 lds
  s_add_u32 s100, s100, s40
  s_lshl_b32 s100, s100, 7
  s_lshl_b32 s48, s39, 1
  s_add_u32 s48, s48, s38
  s_lshl_b32 s48, s48, 2
  s_add_u32 s100, s100, s48
  s_add_u32 s100, s100, 14155776
  v_bfe_u32 v240, v193, 4, 1
  v_lshlrev_b32 v240, 2, v240
  v_and_b32 v241, 7, v193
  v_xor_b32 v240, v240, v241
  v_lshrrev_b32 v242, 3, v193
  v_lshlrev_b32 v242, 10, v242
  v_lshl_add_u32 v176, v240, 4, v242
  s_add_u32 s47, s43, s46
  s_add_u32 m0, s52, 16384
  s_nop 0
  buffer_load_dwordx4 v204, s[24:27], s47 offen offset:0 lds
  v_add_u32 v177, 7168, v176
  v_add_u32 v178, 14336, v176
  v_add_u32 v179, 21504, v176
  v_lshrrev_b32 v240, 5, v193
  v_lshlrev_b32 v240, 2, v240
  v_bfe_u32 v242, v193, 2, 2
  v_add_u32 v240, v240, v242
  v_lshlrev_b32 v240, 7, v240
  v_lshrrev_b32 v242, 1, v242
  v_lshlrev_b32 v242, 6, v242
  v_add_u32 v240, v240, v242
  v_bfe_u32 v242, v193, 4, 1
  v_lshl_add_u32 v240, v242, 5, v240
  v_and_b32 v242, 3, v193
  buffer_load_dwordx4 v205, s[24:27], s47 offen offset:1024 lds
  v_lshl_add_u32 v240, v242, 3, v240
  v_add_u32 v180, s53, v240
  v_xor_b32 v181, 64, v180
  v_add_u32 v182, 180224, v194
  v_and_b32 v183, 31, v193
  v_lshlrev_b32 v183, 2, v183
  v_and_b32 v240, 15, v193
  v_lshlrev_b32 v241, 3, v240
  s_lshl_b32 s48, s38, 11
  s_add_u32 s48, s48, 133376
  v_add_u32 v222, s48, v241
  v_lshlrev_b32 v223, 3, v193
  v_add_u32 v223, s48, v223
  s_lshl_b32 s48, s38, 7
  s_mul_i32 s47, s45, 229376
  s_add_u32 s47, s47, s44
  s_add_u32 m0, s52, 24576
  s_nop 0
  buffer_load_dwordx4 v200, s[12:15], s47 offen offset:0 lds
  s_lshl_b32 s49, s37, 9
  s_add_u32 s48, s48, s49
  s_add_u32 s48, s48, 131584
  v_add_u32 v225, s48, v241
  v_lshrrev_b32 v241, 4, v193
  v_lshlrev_b32 v224, 5, v241
  s_lshl_b32 s48, s37, 8
  s_add_u32 s48, s48, 131072
  v_add_u32 v224, s48, v224
  s_mul_i32 s48, s32, 2560
  s_add_u32 s48, s48, 147456
  v_mul_u32_u24 v226, 80, v240
  v_lshl_add_u32 v226, v241, 4, v226
  v_add_u32 v226, s48, v226
  buffer_load_dwordx4 v201, s[12:15], s47 offen offset:1024 lds
  v_lshrrev_b32 v227, 5, v193
  v_lshlrev_b32 v227, 3, v227
  v_bfe_u32 v241, v193, 2, 2
  v_add_u32 v227, v227, v241
  v_mul_u32_u24 v227, 80, v227
  v_and_b32 v241, 3, v193
  v_lshl_add_u32 v227, v241, 3, v227
  v_bfe_u32 v241, v193, 4, 1
  v_lshl_add_u32 v227, v241, 5, v227
  v_add_u32 v227, s48, v227
  v_lshlrev_b32 v240, 4, v240
  s_lshl_b32 s48, s33, 8
  s_cmp_eq_u32 s37, 1
  s_cselect_b32 s48, s48, 1073741824
  v_add_u32 v240, s48, v240
  v_mov_b32 v241, 1073741824
  v_cmp_gt_u32 vcc, 16, v193
  s_nop 1
  v_cndmask_b32 v228, v241, v240, vcc
  v_cmp_eq_u32 vcc, 0, v193
  s_nop 1
  v_cndmask_b32 v229, v241, 0, vcc
  s_lshr_b32 s96, s96, 7
  s_add_u32 s96, s96, 12582912
  v_mov_b32 v115, 0
  s_waitcnt vmcnt(12)
  buffer_load_dword v114, v115, s[28:31], 0 offen sc1
  v_lshlrev_b32 v128, 16, v96
  v_and_b32 v129, 0xffff0000, v96
  v_lshlrev_b32 v130, 16, v97
  v_and_b32 v131, 0xffff0000, v97
  v_lshlrev_b32 v132, 16, v98
  v_and_b32 v133, 0xffff0000, v98
  v_lshlrev_b32 v134, 16, v99
  v_and_b32 v135, 0xffff0000, v99
  v_lshlrev_b32 v136, 16, v100
  v_and_b32 v137, 0xffff0000, v100
  v_lshlrev_b32 v138, 16, v101
  v_and_b32 v139, 0xffff0000, v101
  v_lshlrev_b32 v140, 16, v102
  s_add_u32 s45, s35, 1
  s_and_b32 s45, s45, 7
  s_lshl_b32 s46, s45, 7
  s_add_u32 s47, s42, s46
  s_add_u32 m0, s51, 32768
  s_nop 0
  buffer_load_dwordx4 v196, s[8:11], s47 offen offset:0 lds
  v_and_b32 v141, 0xffff0000, v102
  v_lshlrev_b32 v142, 16, v103
  v_and_b32 v143, 0xffff0000, v103
  v_add_f32 v144, v128, v129
  v_add_f32 v145, v136, v137
  v_add_f32 v144, v144, v130
  v_add_f32 v145, v145, v138
  v_add_f32 v144, v144, v131
  v_add_f32 v145, v145, v139
  v_add_f32 v144, v144, v132
  v_add_f32 v145, v145, v140
  v_add_f32 v144, v144, v133
  v_add_f32 v145, v145, v141
  v_add_f32 v144, v144, v134
  buffer_load_dwordx4 v197, s[8:11], s47 offen offset:1024 lds
  v_add_f32 v145, v145, v142
  v_add_f32 v144, v144, v135
  v_add_f32 v145, v145, v143
  s_nop 1
  v_permlane32_swap_b32 v144, v145
  v_add_f32 v144, v144, v145
  v_mov_b32 v145, v144
  s_nop 1
  v_permlane16_swap_b32 v144, v145
  v_add_f32 v144, v144, v145
  s_nop 1
  v_add_f32_dpp v144, v144, v144 row_ror:8 row_mask:0xf bank_mask:0xf
  buffer_load_dwordx4 v198, s[8:11], s47 offen offset:2048 lds
  s_nop 0
  v_add_f32_dpp v144, v144, v144 row_ror:4 row_mask:0xf bank_mask:0xf
  s_nop 1
  v_add_f32_dpp v144, v144, v144 row_ror:2 row_mask:0xf bank_mask:0xf
  s_nop 1
  v_add_f32_dpp v144, v144, v144 row_ror:1 row_mask:0xf bank_mask:0xf
  v_mov_b32 v145, v144
  s_nop 1
  v_permlane32_swap_b32 v144, v145
  v_mul_f32 v146, 0x3b000000, v144
  v_mul_f32 v147, 0x3b000000, v145
  buffer_load_dwordx4 v199, s[8:11], s47 offen offset:3072 lds
  v_sub_f32 v128, v128, v146
  v_sub_f32 v129, v129, v146
  v_sub_f32 v130, v130, v146
  v_sub_f32 v131, v131, v146
  v_sub_f32 v132, v132, v146
  v_sub_f32 v133, v133, v146
  v_sub_f32 v134, v134, v146
  v_sub_f32 v135, v135, v146
  v_sub_f32 v136, v136, v147
  v_sub_f32 v137, v137, v147
  v_sub_f32 v138, v138, v147
  v_sub_f32 v139, v139, v147
  v_sub_f32 v140, v140, v147
  v_sub_f32 v141, v141, v147
  s_add_u32 s47, s43, s46
  s_add_u32 m0, s52, 49152
  s_nop 0
  buffer_load_dwordx4 v204, s[24:27], s47 offen offset:0 lds
  v_sub_f32 v142, v142, v147
  v_sub_f32 v143, v143, v147
  v_mul_f32 v144, v128, v128
  v_mul_f32 v145, v136, v136
  v_fmac_f32 v144, v129, v129
  v_fmac_f32 v145, v137, v137
  v_fmac_f32 v144, v130, v130
  v_fmac_f32 v145, v138, v138
  v_fmac_f32 v144, v131, v131
  v_fmac_f32 v145, v139, v139
  v_fmac_f32 v144, v132, v132
  v_fmac_f32 v145, v140, v140
  v_fmac_f32 v144, v133, v133
  v_fmac_f32 v145, v141, v141
  buffer_load_dwordx4 v205, s[24:27], s47 offen offset:1024 lds
  v_fmac_f32 v144, v134, v134
  v_fmac_f32 v145, v142, v142
  v_fmac_f32 v144, v135, v135
  v_fmac_f32 v145, v143, v143
  s_nop 1
  v_permlane32_swap_b32 v144, v145
  v_add_f32 v144, v144, v145
  v_mov_b32 v145, v144
  s_nop 1
  v_permlane16_swap_b32 v144, v145
  v_add_f32 v144, v144, v145
  s_nop 1
  v_add_f32_dpp v144, v144, v144 row_ror:8 row_mask:0xf bank_mask:0xf
  s_mul_i32 s47, s45, 229376
  s_add_u32 s47, s47, s44
  s_add_u32 m0, s52, 57344
  s_nop 0
  buffer_load_dwordx4 v200, s[12:15], s47 offen offset:0 lds
  v_add_f32_dpp v144, v144, v144 row_ror:4 row_mask:0xf bank_mask:0xf
  s_nop 1
  v_add_f32_dpp v144, v144, v144 row_ror:2 row_mask:0xf bank_mask:0xf
  s_nop 1
  v_add_f32_dpp v144, v144, v144 row_ror:1 row_mask:0xf bank_mask:0xf
  v_mov_b32 v145, v144
  s_nop 1
  v_permlane32_swap_b32 v144, v145
  v_cndmask_b32 v146, v146, v147, s[56:57]
  v_cndmask_b32 v144, v144, v145, s[56:57]
  v_mul_f32 v144, 0x3b000000, v144
  buffer_load_dwordx4 v201, s[12:15], s47 offen offset:1024 lds
  v_cvt_pk_bf16_f32 v144, v144, v144
  v_lshlrev_b32 v144, 16, v144
  v_add_f32 v144, 0x3727c5ac, v144
  v_cvt_pk_bf16_f32 v144, v144, v144
  v_lshlrev_b32 v144, 16, v144
  v_sqrt_f32 v144, v144
  s_nop 0
  v_cvt_pk_bf16_f32 v152, v144, v146
  v_and_b32 v147, 31, v193
  v_lshrrev_b32 v146, 2, v193
  v_mov_b32 v145, 1073741824
  v_cmp_eq_u32 vcc, 0, v147
  s_nop 1
  v_cndmask_b32 v156, v145, v146, vcc
  s_waitcnt vmcnt(20)
  v_lshlrev_b32 v64, 16, v104
  v_and_b32 v65, 0xffff0000, v104
  v_lshlrev_b32 v66, 16, v105
  v_and_b32 v67, 0xffff0000, v105
  v_lshlrev_b32 v68, 16, v106
  v_and_b32 v69, 0xffff0000, v106
  v_lshlrev_b32 v70, 16, v107
  v_and_b32 v71, 0xffff0000, v107
  v_add_f32 v64, v64, v68
  v_add_f32 v65, v65, v69
  v_add_f32 v66, v66, v70
  v_add_f32 v67, v67, v71
  v_add_f32 v64, v64, v66
  v_add_f32 v65, v65, v67
  v_add_f32 v72, v64, v65
  v_mov_b32 v73, v72
  s_nop 1
  v_permlane32_swap_b32 v72, v73
  v_add_f32 v72, v72, v73
  v_mov_b32 v73, v72
  s_nop 1
  v_permlane16_swap_b32 v72, v73
  v_add_f32 v72, v72, v73
  s_nop 1
  v_add_f32_dpp v72, v72, v72 row_ror:8 row_mask:0xf bank_mask:0xf
  s_nop 1
  v_add_f32_dpp v72, v72, v72 row_ror:4 row_mask:0xf bank_mask:0xf
  s_nop 1
  v_add_f32_dpp v72, v72, v72 row_ror:2 row_mask:0xf bank_mask:0xf
  s_nop 1
  v_add_f32_dpp v154, v72, v72 row_ror:1 row_mask:0xf bank_mask:0xf
  v_mov_b32 v74, 1073741824
  v_cmp_eq_u32 vcc, 0, v193
  s_nop 1
  v_cndmask_b32 v157, v74, 0, vcc
  s_waitcnt vmcnt(9)
  s_barrier
  ds_read_b128 v[160:163], v188 offset:0
  ds_read_b128 a[0:3], v184 offset:0
  ds_read_b128 a[4:7], v184 offset:4096
  ds_read_b64_tr_b16 v[164:165], v192 offset:24576
  ds_read_b64_tr_b16 v[166:167], v192 offset:25088
  s_waitcnt lgkmcnt(3)
  v_mfma_f32_32x32x16_bf16 v[0:15], a[0:3], v[160:163], 0
  ds_read_b128 v[168:171], v189 offset:0
  ds_read_b128 a[8:11], v185 offset:0
  s_add_u32 s45, s35, 2
  s_and_b32 s45, s45, 7
  s_lshl_b32 s46, s45, 7
  s_add_u32 s47, s42, s46
  s_add_u32 m0, s51, 65536
  s_nop 0
  buffer_load_dwordx4 v196, s[8:11], s47 offen offset:0 lds
  s_waitcnt lgkmcnt(4)
  v_mfma_f32_32x32x16_bf16 v[16:31], a[4:7], v[160:163], 0
  ds_read_b128 a[12:15], v185 offset:4096
  ds_read_b64_tr_b16 v[172:173], v192 offset:26624
  s_waitcnt vmcnt(9)
  v_readfirstlane_b32 s36, v114
  s_nop 0
  s_cmp_eq_u32 s36, 0
  s_cbranch_scc1 FZH_nps2
FZH_npr3:
  s_waitcnt lgkmcnt(4)
  v_mfma_f32_32x32x16_bf16 v[32:47], v[164:167], a[0:3], 0
  ds_read_b64_tr_b16 v[174:175], v192 offset:27136
  buffer_load_dwordx4 v197, s[8:11], s47 offen offset:1024 lds
  v_mov_b32 v153, s36
  v_mov_b32 v155, s36
  v_mov_b32 v252, s36
  buffer_store_dwordx2 v[152:153], v156, s[20:23], s96 offen sc1
  buffer_store_dwordx2 v[154:155], v157, s[20:23], s97 offen sc1
  v_mfma_f32_32x32x16_bf16 v[48:63], v[164:167], a[4:7], 0
  buffer_load_dwordx4 v198, s[8:11], s47 offen offset:2048 lds
  v_lshrrev_b32 v121, 5, v193
  s_lshl_b32 s48, s32, 1
  s_lshl_b32 s48, 8, s48
  v_mul_u32_u24 v116, s48, v121
  s_waitcnt lgkmcnt(3)
  v_mfma_f32_32x32x16_bf16 v[0:15], a[8:11], v[168:171], v[0:15]
  ds_read_b128 v[160:163], v190 offset:0
  ds_read_b128 a[16:19], v186 offset:0
  s_cmp_eq_u32 s32, 3
  s_cselect_b64 s[60:61], -1, 0
  s_cselect_b32 s62, -1, 0
  s_mov_b32 s63, 0
  v_mul_u32_u24 v122, 511, v121
  s_waitcnt lgkmcnt(4)
  v_mfma_f32_32x32x16_bf16 v[16:31], a[12:15], v[168:171], v[16:31]
  ds_read_b128 a[20:23], v186 offset:4096
  ds_read_b64_tr_b16 v[164:165], v192 offset:28672
  buffer_load_dwordx4 v199, s[8:11], s47 offen offset:3072 lds
  v_add_u32 v122, 1, v122
  v_cndmask_b32 v122, v116, v122, s[60:61]
  v_cvt_f32_u32 v122, v122
  s_lshl_b32 s48, s48, 1
  s_waitcnt lgkmcnt(4)
  v_mfma_f32_32x32x16_bf16 v[32:47], v[172:175], a[8:11], v[32:47]
  ds_read_b64_tr_b16 v[166:167], v192 offset:29184
  s_add_u32 s47, s43, s46
  s_add_u32 m0, s52, 81920
  s_nop 0
  buffer_load_dwordx4 v204, s[24:27], s47 offen offset:0 lds
  v_add_u32 v116, s48, v116
  v_cndmask_b32 v116, v116, 1, s[60:61]
  v_mfma_f32_32x32x16_bf16 v[48:63], v[172:175], a[12:15], v[48:63]
  v_cvt_f32_u32 v116, v116
  v_bfe_u32 v125, v193, 4, 1
  v_lshlrev_b32 v125, 11, v125
  v_lshl_add_u32 v125, v121, 7, v125
  v_and_b32 v121, 15, v193
  v_lshl_add_u32 v125, v121, 3, v125
  s_lshl_b32 s48, s32, 9
  s_waitcnt lgkmcnt(3)
  v_mfma_f32_32x32x16_bf16 v[0:15], a[16:19], v[160:163], v[0:15]
  ds_read_b128 v[168:171], v191 offset:0
  ds_read_b128 a[24:27], v187 offset:0
  buffer_load_dwordx4 v205, s[24:27], s47 offen offset:1024 lds
  s_add_u32 s48, s48, 133376
  v_add_u32 v125, s48, v125
  v_lshlrev_b32 v119, 16, v108
  v_lshlrev_b32 v120, 16, v109
  s_waitcnt lgkmcnt(4)
  v_mfma_f32_32x32x16_bf16 v[16:31], a[20:23], v[160:163], v[16:31]
  ds_read_b128 a[28:31], v187 offset:4096
  ds_read_b64_tr_b16 v[172:173], v192 offset:30720
  s_mul_i32 s47, s45, 229376
  s_add_u32 s47, s47, s44
  s_add_u32 m0, s52, 90112
  s_nop 0
  buffer_load_dwordx4 v200, s[12:15], s47 offen offset:0 lds
  s_waitcnt lgkmcnt(4)
  v_mfma_f32_32x32x16_bf16 v[32:47], v[164:167], a[16:19], v[32:47]
  ds_read_b64_tr_b16 v[174:175], v192 offset:31232
  v_lshlrev_b32 v121, 16, v110
  v_mul_f32 v121, 0x3fb8aa3b, v121
  v_exp_f32 v121, v121
  s_nop 0
  v_cvt_pk_bf16_f32 v121, v121, v121
  v_mfma_f32_32x32x16_bf16 v[48:63], v[164:167], a[20:23], v[48:63]
  buffer_load_dwordx4 v201, s[12:15], s47 offen offset:1024 lds
  v_lshlrev_b32 v121, 16, v121
  v_mul_f32 v117, v121, v119
  v_mul_f32 v118, v121, v120
  v_mul_f32 v117, 0x3fb8aa3b, v117
  v_mul_f32 v118, 0x3e22f983, v118
  v_mul_f32 v126, v122, v117
  s_waitcnt lgkmcnt(3)
  v_mfma_f32_32x32x16_bf16 v[0:15], a[24:27], v[168:171], v[0:15]
  s_waitcnt vmcnt(10)
  s_waitcnt lgkmcnt(0)
  s_barrier
  ds_read_b128 v[160:163], v188 offset:32768
  ds_read_b128 a[32:35], v184 offset:32768
  s_mul_i32 s47, s41, 229376
  s_add_u32 s47, s47, s44
  s_add_u32 m0, s52, 147456
  s_nop 0
  buffer_load_dwordx4 v200, s[4:7], s47 offen offset:0 lds
  v_mfma_f32_32x32x16_bf16 v[16:31], a[28:31], v[168:171], v[16:31]
  ds_read_b128 a[36:39], v184 offset:36864
  ds_read_b64_tr_b16 v[164:165], v192 offset:57344
  v_mul_f32 v127, v122, v118
  v_exp_f32 v126, v126
  v_fract_f32 v127, v127
  v_mfma_f32_32x32x16_bf16 v[32:47], v[172:175], a[24:27], v[32:47]
  ds_read_b64_tr_b16 v[166:167], v192 offset:57856
  buffer_load_dwordx4 v201, s[4:7], s47 offen offset:1024 lds
  v_cos_f32 v121, v127
  v_sin_f32 v123, v127
  v_mul_f32 v148, v126, v121
  v_mfma_f32_32x32x16_bf16 v[48:63], v[172:175], a[28:31], v[48:63]
  s_mul_i32 s47, s41, 229376
  s_add_u32 s47, s47, s44
  s_add_u32 s47, s47, 128
  s_add_u32 m0, s52, 155648
  s_nop 0
  buffer_load_dwordx4 v200, s[4:7], s47 offen offset:0 lds
  v_mul_f32 v149, v126, v123
  s_waitcnt lgkmcnt(3)
  v_mfma_f32_32x32x16_bf16 v[0:15], a[32:35], v[160:163], v[0:15]
  ds_read_b128 v[168:171], v189 offset:32768
  ds_read_b128 a[40:43], v185 offset:32768
  buffer_load_dwordx4 v201, s[4:7], s47 offen offset:1024 lds
  ds_write_b64 v125, v[148:149] offset:0
  v_mul_f32 v126, v116, v117
  v_mul_f32 v127, v116, v118
  s_waitcnt lgkmcnt(5)
  v_mfma_f32_32x32x16_bf16 v[16:31], a[36:39], v[160:163], v[16:31]
  ds_read_b128 a[44:47], v185 offset:36864
  ds_read_b64_tr_b16 v[172:173], v192 offset:59392
  s_add_u32 s45, s35, 3
  s_and_b32 s45, s45, 7
  s_lshl_b32 s46, s45, 7
  s_add_u32 s47, s42, s46
  s_add_u32 m0, s51, 98304
  s_nop 0
  buffer_load_dwordx4 v196, s[8:11], s47 offen offset:0 lds
  s_waitcnt lgkmcnt(5)
  v_mfma_f32_32x32x16_bf16 v[32:47], v[164:167], a[32:35], v[32:47]
  ds_read_b64_tr_b16 v[174:175], v192 offset:59904
  v_exp_f32 v126, v126
  v_fract_f32 v127, v127
  v_cos_f32 v121, v127
  v_mfma_f32_32x32x16_bf16 v[48:63], v[164:167], a[36:39], v[48:63]
  buffer_load_dwordx4 v197, s[8:11], s47 offen offset:1024 lds
  v_sin_f32 v123, v127
  v_mul_f32 v148, v126, v121
  v_mul_f32 v149, v126, v123
  v_add_f32 v121, -1.0, v148
  v_mul_f32 v122, v119, v119
  s_waitcnt lgkmcnt(4)
  v_mfma_f32_32x32x16_bf16 v[0:15], a[40:43], v[168:171], v[0:15]
  ds_read_b128 v[160:163], v190 offset:32768
  ds_read_b128 a[48:51], v186 offset:32768
  buffer_load_dwordx4 v198, s[8:11], s47 offen offset:2048 lds
  v_fma_f32 v122, v120, v120, v122
  v_rcp_f32 v122, v122
  v_mul_f32 v123, v121, v119
  s_waitcnt lgkmcnt(4)
  v_mfma_f32_32x32x16_bf16 v[16:31], a[44:47], v[168:171], v[16:31]
  ds_read_b128 a[52:55], v186 offset:36864
  ds_read_b64_tr_b16 v[164:165], v192 offset:61440
  v_fma_f32 v123, v149, v120, v123
  v_mul_f32 v124, v149, v119
  v_fma_f32 v124, -v121, v120, v124
  v_add_f32 v122, v122, v122
  v_mul_f32 v123, v123, v122
  s_waitcnt lgkmcnt(4)
  v_mfma_f32_32x32x16_bf16 v[32:47], v[172:175], a[40:43], v[32:47]
  ds_read_b64_tr_b16 v[166:167], v192 offset:61952
  buffer_load_dwordx4 v199, s[8:11], s47 offen offset:3072 lds
  v_mul_f32 v124, v124, v122
  v_cndmask_b32 v148, v148, v123, s[62:63]
  v_cndmask_b32 v149, v149, v124, s[62:63]
  ds_write_b64 v125, v[148:149] offset:256
  v_mfma_f32_32x32x16_bf16 v[48:63], v[172:175], a[44:47], v[48:63]
  s_add_u32 s47, s43, s46
  s_add_u32 m0, s52, 114688
  s_nop 0
  buffer_load_dwordx4 v204, s[24:27], s47 offen offset:0 lds
  s_waitcnt lgkmcnt(4)
  v_mfma_f32_32x32x16_bf16 v[0:15], a[48:51], v[160:163], v[0:15]
  ds_read_b128 v[168:171], v191 offset:32768
  ds_read_b128 a[56:59], v187 offset:32768
  buffer_load_dwordx4 v205, s[24:27], s47 offen offset:1024 lds
  s_waitcnt lgkmcnt(5)
  v_mfma_f32_32x32x16_bf16 v[16:31], a[52:55], v[160:163], v[16:31]
  ds_read_b128 a[60:63], v187 offset:36864
  ds_read_b64_tr_b16 v[172:173], v192 offset:63488
  s_mul_i32 s47, s45, 229376
  s_add_u32 s47, s47, s44
  s_add_u32 m0, s52, 122880
  s_nop 0
  buffer_load_dwordx4 v200, s[12:15], s47 offen offset:0 lds
  s_waitcnt lgkmcnt(5)
  v_mfma_f32_32x32x16_bf16 v[32:47], v[164:167], a[48:51], v[32:47]
  ds_read_b64_tr_b16 v[174:175], v192 offset:64000
  v_mfma_f32_32x32x16_bf16 v[48:63], v[164:167], a[52:55], v[48:63]
  buffer_load_dwordx4 v201, s[12:15], s47 offen offset:1024 lds
  s_waitcnt lgkmcnt(3)
  v_mfma_f32_32x32x16_bf16 v[0:15], a[56:59], v[168:171], v[0:15]
  s_waitcnt vmcnt(12)
  s_waitcnt lgkmcnt(0)
  s_barrier
  v_add_u32 v188, 65536, v188
  ds_read_b128 v[160:163], v188 offset:0
  v_add_u32 v184, 65536, v184
  ds_read_b128 a[64:67], v184 offset:0
  s_add_u32 s45, s35, 4
  s_and_b32 s45, s45, 7
  s_lshl_b32 s46, s45, 7
  s_add_u32 s47, s42, s46
  s_add_u32 m0, s51, 0
  s_nop 0
  buffer_load_dwordx4 v196, s[8:11], s47 offen offset:0 lds
  v_mfma_f32_32x32x16_bf16 v[16:31], a[60:63], v[168:171], v[16:31]
  ds_read_b128 a[68:71], v184 offset:4096
  v_add_u32 v192, 65536, v192
  ds_read_b64_tr_b16 v[164:165], v192 offset:24576
  v_mfma_f32_32x32x16_bf16 v[32:47], v[172:175], a[56:59], v[32:47]
  ds_read_b64_tr_b16 v[166:167], v192 offset:25088
  v_mfma_f32_32x32x16_bf16 v[48:63], v[172:175], a[60:63], v[48:63]
  buffer_load_dwordx4 v197, s[8:11], s47 offen offset:1024 lds
  s_waitcnt lgkmcnt(3)
  v_mfma_f32_32x32x16_bf16 v[0:15], a[64:67], v[160:163], v[0:15]
  v_add_u32 v189, 65536, v189
  ds_read_b128 v[168:171], v189 offset:0
  v_add_u32 v185, 65536, v185
  ds_read_b128 a[72:75], v185 offset:0
  buffer_load_dwordx4 v198, s[8:11], s47 offen offset:2048 lds
  s_waitcnt lgkmcnt(4)
  v_mfma_f32_32x32x16_bf16 v[16:31], a[68:71], v[160:163], v[16:31]
  ds_read_b128 a[76:79], v185 offset:4096
  ds_read_b64_tr_b16 v[172:173], v192 offset:26624
  s_waitcnt lgkmcnt(4)
  v_mfma_f32_32x32x16_bf16 v[32:47], v[164:167], a[64:67], v[32:47]
  ds_read_b64_tr_b16 v[174:175], v192 offset:27136
  v_mfma_f32_32x32x16_bf16 v[48:63], v[164:167], a[68:71], v[48:63]
  buffer_load_dwordx4 v199, s[8:11], s47 offen offset:3072 lds
  s_waitcnt lgkmcnt(3)
  v_mfma_f32_32x32x16_bf16 v[0:15], a[72:75], v[168:171], v[0:15]
  v_add_u32 v190, 65536, v190
  ds_read_b128 v[160:163], v190 offset:0
  v_add_u32 v186, 65536, v186
  ds_read_b128 a[80:83], v186 offset:0
  s_add_u32 s47, s43, s46
  s_add_u32 m0, s52, 16384
  s_nop 0
  buffer_load_dwordx4 v204, s[24:27], s47 offen offset:0 lds
  s_waitcnt lgkmcnt(4)
  v_mfma_f32_32x32x16_bf16 v[16:31], a[76:79], v[168:171], v[16:31]
  ds_read_b128 a[84:87], v186 offset:4096
  ds_read_b64_tr_b16 v[164:165], v192 offset:28672
  s_waitcnt lgkmcnt(4)
  v_mfma_f32_32x32x16_bf16 v[32:47], v[172:175], a[72:75], v[32:47]
  ds_read_b64_tr_b16 v[166:167], v192 offset:29184
  v_mfma_f32_32x32x16_bf16 v[48:63], v[172:175], a[76:79], v[48:63]
  buffer_load_dwordx4 v205, s[24:27], s47 offen offset:1024 lds
  s_waitcnt lgkmcnt(3)
  v_mfma_f32_32x32x16_bf16 v[0:15], a[80:83], v[160:163], v[0:15]
  v_add_u32 v191, 65536, v191
  ds_read_b128 v[168:171], v191 offset:0
  v_add_u32 v187, 65536, v187
  ds_read_b128 a[88:91], v187 offset:0
  s_mul_i32 s47, s45, 229376
  s_add_u32 s47, s47, s44
  s_add_u32 m0, s52, 24576
  s_nop 0
  buffer_load_dwordx4 v200, s[12:15], s47 offen offset:0 lds
  s_waitcnt lgkmcnt(4)
  v_mfma_f32_32x32x16_bf16 v[16:31], a[84:87], v[160:163], v[16:31]
  ds_read_b128 a[92:95], v187 offset:4096
  ds_read_b64_tr_b16 v[172:173], v192 offset:30720
  s_waitcnt lgkmcnt(4)
  v_mfma_f32_32x32x16_bf16 v[32:47], v[164:167], a[80:83], v[32:47]
  ds_read_b64_tr_b16 v[174:175], v192 offset:31232
  v_mfma_f32_32x32x16_bf16 v[48:63], v[164:167], a[84:87], v[48:63]
  buffer_load_dwordx4 v201, s[12:15], s47 offen offset:1024 lds
  s_waitcnt lgkmcnt(3)
  v_mfma_f32_32x32x16_bf16 v[0:15], a[88:91], v[168:171], v[0:15]
  s_waitcnt vmcnt(8)
  s_waitcnt lgkmcnt(0)
  s_barrier
  ds_read_b128 v[160:163], v188 offset:32768
  ds_read_b128 a[96:99], v184 offset:32768
  s_add_u32 s45, s35, 5
  s_and_b32 s45, s45, 7
  s_lshl_b32 s46, s45, 7
  s_add_u32 s47, s42, s46
  s_add_u32 m0, s51, 32768
  s_nop 0
  buffer_load_dwordx4 v196, s[8:11], s47 offen offset:0 lds
  v_mfma_f32_32x32x16_bf16 v[16:31], a[92:95], v[168:171], v[16:31]
  ds_read_b128 a[100:103], v184 offset:36864
  ds_read_b64_tr_b16 v[164:165], v192 offset:57344
  v_mov_b32 v128, 0x3f803f80
  v_mov_b32 v129, 0x3f803f80
  v_mov_b32 v130, 0x3f803f80
  v_mov_b32 v131, 0x3f803f80
  v_mfma_f32_32x32x16_bf16 v[32:47], v[172:175], a[88:91], v[32:47]
  ds_read_b64_tr_b16 v[166:167], v192 offset:57856
  ds_read_b64_tr_b16 v[112:113], v195 offset:0
  ds_read_b64_tr_b16 v[114:115], v195 offset:512
  ds_read_b64_tr_b16 v[116:117], v195 offset:2048
  ds_read_b64_tr_b16 v[118:119], v195 offset:2560
  ds_read_b64_tr_b16 v[120:121], v195 offset:4096
  ds_read_b64_tr_b16 v[122:123], v195 offset:4608
  v_mfma_f32_32x32x16_bf16 v[48:63], v[172:175], a[92:95], v[48:63]
  buffer_load_dwordx4 v197, s[8:11], s47 offen offset:1024 lds
  ds_read_b64_tr_b16 v[124:125], v195 offset:6144
  ds_read_b64_tr_b16 v[126:127], v195 offset:6656
  v_lshlrev_b32 v134, 3, v193
  v_mov_b32 v135, 1073741824
  v_cndmask_b32 v134, v134, v135, s[56:57]
  s_and_b32 s48, s33, 1
  s_waitcnt lgkmcnt(11)
  v_mfma_f32_32x32x16_bf16 v[0:15], a[96:99], v[160:163], v[0:15]
  ds_read_b128 v[168:171], v189 offset:32768
  ds_read_b128 a[104:107], v185 offset:32768
  buffer_load_dwordx4 v198, s[8:11], s47 offen offset:2048 lds
  s_mul_i32 s48, s48, 114688
  s_lshl_b32 s49, s101, 5
  s_add_u32 s48, s48, s49
  s_lshl_b32 s49, s38, 12
  s_waitcnt lgkmcnt(12)
  v_mfma_f32_32x32x16_bf16 v[16:31], a[100:103], v[160:163], v[16:31]
  ds_read_b128 a[108:111], v185 offset:36864
  ds_read_b64_tr_b16 v[172:173], v192 offset:59392
  s_add_u32 s48, s48, s49
  s_lshl_b32 s49, s41, 9
  s_add_u32 s48, s48, s49
  s_lshl_b32 s49, s37, 8
  s_add_u32 s48, s48, s49
  s_waitcnt lgkmcnt(12)
  v_mfma_f32_32x32x16_bf16 v[32:47], v[164:167], a[96:99], v[32:47]
  ds_read_b64_tr_b16 v[174:175], v192 offset:59904
  s_add_u32 s96, s48, 12713984
  v_mov_b32 v133, s36
  s_waitcnt lgkmcnt(11)
  v_mfma_f32_32x32x16_bf16 v[96:111], v[128:131], v[112:115], 0
  s_waitcnt lgkmcnt(9)
  v_mfma_f32_32x32x16_bf16 v[96:111], v[128:131], v[116:119], v[96:111]
  v_mfma_f32_32x32x16_bf16 v[48:63], v[164:167], a[100:103], v[48:63]
  buffer_load_dwordx4 v199, s[8:11], s47 offen offset:3072 lds
  s_waitcnt lgkmcnt(7)
  v_mfma_f32_32x32x16_bf16 v[96:111], v[128:131], v[120:123], v[96:111]
  s_waitcnt lgkmcnt(5)
  v_mfma_f32_32x32x16_bf16 v[96:111], v[128:131], v[124:127], v[96:111]
  s_nop 11
  v_mov_b32 v132, v96
  s_waitcnt lgkmcnt(3)
  v_mfma_f32_32x32x16_bf16 v[0:15], a[104:107], v[168:171], v[0:15]
  ds_read_b128 v[160:163], v190 offset:32768
  ds_read_b128 a[112:115], v186 offset:32768
  s_add_u32 s47, s43, s46
  s_add_u32 m0, s52, 49152
  s_nop 0
  buffer_load_dwordx4 v204, s[24:27], s47 offen offset:0 lds
  buffer_store_dwordx2 v[132:133], v134, s[20:23], s96 offen sc1
  s_waitcnt lgkmcnt(4)
  v_mfma_f32_32x32x16_bf16 v[16:31], a[108:111], v[168:171], v[16:31]
  ds_read_b128 a[116:119], v186 offset:36864
  ds_read_b64_tr_b16 v[164:165], v192 offset:61440
  s_waitcnt lgkmcnt(4)
  v_mfma_f32_32x32x16_bf16 v[32:47], v[172:175], a[104:107], v[32:47]
  ds_read_b64_tr_b16 v[166:167], v192 offset:61952
  v_mfma_f32_32x32x16_bf16 v[48:63], v[172:175], a[108:111], v[48:63]
  buffer_load_dwordx4 v205, s[24:27], s47 offen offset:1024 lds
  s_waitcnt lgkmcnt(3)
  v_mfma_f32_32x32x16_bf16 v[0:15], a[112:115], v[160:163], v[0:15]
  ds_read_b128 v[168:171], v191 offset:32768
  ds_read_b128 a[120:123], v187 offset:32768
  s_mul_i32 s47, s45, 229376
  s_add_u32 s47, s47, s44
  s_add_u32 m0, s52, 57344
  s_nop 0
  buffer_load_dwordx4 v200, s[12:15], s47 offen offset:0 lds
  s_waitcnt lgkmcnt(4)
  v_mfma_f32_32x32x16_bf16 v[16:31], a[116:119], v[160:163], v[16:31]
  ds_read_b128 a[124:127], v187 offset:36864
  ds_read_b64_tr_b16 v[172:173], v192 offset:63488
  s_waitcnt lgkmcnt(4)
  v_mfma_f32_32x32x16_bf16 v[32:47], v[164:167], a[112:115], v[32:47]
  ds_read_b64_tr_b16 v[174:175], v192 offset:64000
  v_mfma_f32_32x32x16_bf16 v[48:63], v[164:167], a[116:119], v[48:63]
  buffer_load_dwordx4 v201, s[12:15], s47 offen offset:1024 lds
  s_waitcnt lgkmcnt(3)
  v_mfma_f32_32x32x16_bf16 v[0:15], a[120:123], v[168:171], v[0:15]
  s_waitcnt vmcnt(9)
  s_waitcnt lgkmcnt(0)
  s_barrier
  v_subrev_u32 v188, 65536, v188
  ds_read_b128 v[160:163], v188 offset:0
  v_subrev_u32 v184, 65536, v184
  ds_read_b128 a[128:131], v184 offset:0
  s_add_u32 s45, s35, 6
  s_and_b32 s45, s45, 7
  s_lshl_b32 s46, s45, 7
  s_add_u32 s47, s42, s46
  s_add_u32 m0, s51, 65536
  s_nop 0
  buffer_load_dwordx4 v196, s[8:11], s47 offen offset:0 lds
  v_mfma_f32_32x32x16_bf16 v[16:31], a[124:127], v[168:171], v[16:31]
  ds_read_b128 a[132:135], v184 offset:4096
  v_subrev_u32 v192, 65536, v192
  ds_read_b64_tr_b16 v[164:165], v192 offset:24576
  v_mfma_f32_32x32x16_bf16 v[32:47], v[172:175], a[120:123], v[32:47]
  ds_read_b64_tr_b16 v[166:167], v192 offset:25088
  v_mfma_f32_32x32x16_bf16 v[48:63], v[172:175], a[124:127], v[48:63]
  buffer_load_dwordx4 v197, s[8:11], s47 offen offset:1024 lds
  s_waitcnt lgkmcnt(3)
  v_mfma_f32_32x32x16_bf16 v[0:15], a[128:131], v[160:163], v[0:15]
  v_subrev_u32 v189, 65536, v189
  ds_read_b128 v[168:171], v189 offset:0
  v_subrev_u32 v185, 65536, v185
  ds_read_b128 a[136:139], v185 offset:0
  buffer_load_dwordx4 v198, s[8:11], s47 offen offset:2048 lds
  s_waitcnt lgkmcnt(4)
  v_mfma_f32_32x32x16_bf16 v[16:31], a[132:135], v[160:163], v[16:31]
  ds_read_b128 a[140:143], v185 offset:4096
  ds_read_b64_tr_b16 v[172:173], v192 offset:26624
  s_waitcnt lgkmcnt(4)
  v_mfma_f32_32x32x16_bf16 v[32:47], v[164:167], a[128:131], v[32:47]
  ds_read_b64_tr_b16 v[174:175], v192 offset:27136
  v_mfma_f32_32x32x16_bf16 v[48:63], v[164:167], a[132:135], v[48:63]
  buffer_load_dwordx4 v199, s[8:11], s47 offen offset:3072 lds
  s_waitcnt lgkmcnt(3)
  v_mfma_f32_32x32x16_bf16 v[0:15], a[136:139], v[168:171], v[0:15]
  v_subrev_u32 v190, 65536, v190
  ds_read_b128 v[160:163], v190 offset:0
  v_subrev_u32 v186, 65536, v186
  ds_read_b128 a[144:147], v186 offset:0
  s_add_u32 s47, s43, s46
  s_add_u32 m0, s52, 81920
  s_nop 0
  buffer_load_dwordx4 v204, s[24:27], s47 offen offset:0 lds
  s_waitcnt lgkmcnt(4)
  v_mfma_f32_32x32x16_bf16 v[16:31], a[140:143], v[168:171], v[16:31]
  ds_read_b128 a[148:151], v186 offset:4096
  ds_read_b64_tr_b16 v[164:165], v192 offset:28672
  s_waitcnt lgkmcnt(4)
  v_mfma_f32_32x32x16_bf16 v[32:47], v[172:175], a[136:139], v[32:47]
  ds_read_b64_tr_b16 v[166:167], v192 offset:29184
  v_mfma_f32_32x32x16_bf16 v[48:63], v[172:175], a[140:143], v[48:63]
  buffer_load_dwordx4 v205, s[24:27], s47 offen offset:1024 lds
  s_waitcnt lgkmcnt(3)
  v_mfma_f32_32x32x16_bf16 v[0:15], a[144:147], v[160:163], v[0:15]
  v_subrev_u32 v191, 65536, v191
  ds_read_b128 v[168:171], v191 offset:0
  v_subrev_u32 v187, 65536, v187
  ds_read_b128 a[152:155], v187 offset:0
  s_mul_i32 s47, s45, 229376
  s_add_u32 s47, s47, s44
  s_add_u32 m0, s52, 90112
  s_nop 0
  buffer_load_dwordx4 v200, s[12:15], s47 offen offset:0 lds
  s_waitcnt lgkmcnt(4)
  v_mfma_f32_32x32x16_bf16 v[16:31], a[148:151], v[160:163], v[16:31]
  ds_read_b128 a[156:159], v187 offset:4096
  ds_read_b64_tr_b16 v[172:173], v192 offset:30720
  s_waitcnt lgkmcnt(4)
  v_mfma_f32_32x32x16_bf16 v[32:47], v[164:167], a[144:147], v[32:47]
  ds_read_b64_tr_b16 v[174:175], v192 offset:31232
  v_mfma_f32_32x32x16_bf16 v[48:63], v[164:167], a[148:151], v[48:63]
  buffer_load_dwordx4 v201, s[12:15], s47 offen offset:1024 lds
  s_waitcnt lgkmcnt(3)
  v_mfma_f32_32x32x16_bf16 v[0:15], a[152:155], v[168:171], v[0:15]
  s_waitcnt vmcnt(8)
  s_waitcnt lgkmcnt(0)
  s_barrier
  ds_read_b128 v[160:163], v188 offset:32768
  ds_read_b128 a[160:163], v184 offset:32768
  s_add_u32 s45, s35, 7
  s_and_b32 s45, s45, 7
  s_lshl_b32 s46, s45, 7
  s_add_u32 s47, s42, s46
  s_add_u32 m0, s51, 98304
  s_nop 0
  buffer_load_dwordx4 v196, s[8:11], s47 offen offset:0 lds
  v_mfma_f32_32x32x16_bf16 v[16:31], a[156:159], v[168:171], v[16:31]
  ds_read_b128 a[164:167], v184 offset:36864
  ds_read_b64_tr_b16 v[164:165], v192 offset:57344
  v_bfe_u32 v142, v193, 2, 1
  v_lshlrev_b32 v142, 4, v142
  v_and_b32 v143, 1, v193
  v_lshl_add_u32 v142, v143, 3, v142
  v_bfe_u32 v143, v193, 3, 2
  v_mfma_f32_32x32x16_bf16 v[32:47], v[172:175], a[152:155], v[32:47]
  ds_read_b64_tr_b16 v[166:167], v192 offset:57856
  v_lshl_add_u32 v142, v143, 1, v142
  v_bfe_u32 v143, v193, 1, 1
  v_add_u32 v142, v142, v143
  v_lshlrev_b32 v143, 3, v142
  s_lshl_b32 s48, s33, 10
  s_lshl_b32 s49, s37, 9
  v_mfma_f32_32x32x16_bf16 v[48:63], v[172:175], a[156:159], v[48:63]
  buffer_load_dwordx4 v197, s[8:11], s47 offen offset:1024 lds
  s_add_u32 s48, s48, s49
  s_add_u32 s96, s48, 12582912
  v_and_b32 v144, 31, v193
  v_lshlrev_b32 v144, 3, v144
  s_lshl_b32 s48, s34, 9
  s_lshl_b32 s49, s38, 8
  s_waitcnt lgkmcnt(3)
  v_mfma_f32_32x32x16_bf16 v[0:15], a[160:163], v[160:163], v[0:15]
  ds_read_b128 v[168:171], v189 offset:32768
  ds_read_b128 a[168:171], v185 offset:32768
  buffer_load_dwordx4 v198, s[8:11], s47 offen offset:2048 lds
  s_add_u32 s48, s48, s49
  s_add_u32 s97, s48, 12648448
  buffer_load_dwordx2 v[136:137], v143, s[20:23], s96 offen sc1
  buffer_load_dwordx2 v[138:139], v143, s[20:23], s96 offen offset:256 sc1
  s_waitcnt lgkmcnt(4)
  v_mfma_f32_32x32x16_bf16 v[16:31], a[164:167], v[160:163], v[16:31]
  ds_read_b128 a[172:175], v185 offset:36864
  ds_read_b64_tr_b16 v[172:173], v192 offset:59392
  buffer_load_dwordx2 v[140:141], v144, s[20:23], s97 offen sc1
  s_waitcnt lgkmcnt(4)
  v_mfma_f32_32x32x16_bf16 v[32:47], v[164:167], a[160:163], v[32:47]
  ds_read_b64_tr_b16 v[174:175], v192 offset:59904
  v_mfma_f32_32x32x16_bf16 v[48:63], v[164:167], a[164:167], v[48:63]
  buffer_load_dwordx4 v199, s[8:11], s47 offen offset:3072 lds
  s_waitcnt lgkmcnt(3)
  v_mfma_f32_32x32x16_bf16 v[0:15], a[168:171], v[168:171], v[0:15]
  ds_read_b128 v[160:163], v190 offset:32768
  ds_read_b128 a[176:179], v186 offset:32768
  s_add_u32 s47, s43, s46
  s_add_u32 m0, s52, 114688
  s_nop 0
  buffer_load_dwordx4 v204, s[24:27], s47 offen offset:0 lds
  s_waitcnt lgkmcnt(4)
  v_mfma_f32_32x32x16_bf16 v[16:31], a[172:175], v[168:171], v[16:31]
  ds_read_b128 a[180:183], v186 offset:36864
  ds_read_b64_tr_b16 v[164:165], v192 offset:61440
  s_waitcnt lgkmcnt(4)
  v_mfma_f32_32x32x16_bf16 v[32:47], v[172:175], a[168:171], v[32:47]
  ds_read_b64_tr_b16 v[166:167], v192 offset:61952
  v_mfma_f32_32x32x16_bf16 v[48:63], v[172:175], a[172:175], v[48:63]
  buffer_load_dwordx4 v205, s[24:27], s47 offen offset:1024 lds
  s_waitcnt lgkmcnt(3)
  v_mfma_f32_32x32x16_bf16 v[0:15], a[176:179], v[160:163], v[0:15]
  ds_read_b128 v[168:171], v191 offset:32768
  ds_read_b128 a[184:187], v187 offset:32768
  s_mul_i32 s47, s45, 229376
  s_add_u32 s47, s47, s44
  s_add_u32 m0, s52, 122880
  s_nop 0
  buffer_load_dwordx4 v200, s[12:15], s47 offen offset:0 lds
  s_waitcnt lgkmcnt(4)
  v_mfma_f32_32x32x16_bf16 v[16:31], a[180:183], v[160:163], v[16:31]
  ds_read_b128 a[188:191], v187 offset:36864
  ds_read_b64_tr_b16 v[172:173], v192 offset:63488
  s_waitcnt lgkmcnt(4)
  v_mfma_f32_32x32x16_bf16 v[32:47], v[164:167], a[176:179], v[32:47]
  ds_read_b64_tr_b16 v[174:175], v192 offset:64000
  v_mfma_f32_32x32x16_bf16 v[48:63], v[164:167], a[180:183], v[48:63]
  buffer_load_dwordx4 v201, s[12:15], s47 offen offset:1024 lds
  s_waitcnt lgkmcnt(3)
  v_mfma_f32_32x32x16_bf16 v[0:15], a[184:187], v[168:171], v[0:15]
  s_waitcnt vmcnt(11)
  s_waitcnt lgkmcnt(0)
  s_barrier
  v_add_u32 v188, 65536, v188
  ds_read_b128 v[160:163], v188 offset:0
  v_add_u32 v184, 65536, v184
  ds_read_b128 a[192:195], v184 offset:0
  s_add_u32 s45, s35, s32
  s_add_u32 s45, s45, 0
  s_and_b32 s45, s45, 7
  s_mul_i32 s47, s45, 229376
  s_add_u32 s47, s47, s101
  s_add_u32 m0, s53, 0
  s_nop 0
  buffer_load_dwordx4 v200, s[16:19], s47 offen offset:0 lds
  v_mfma_f32_32x32x16_bf16 v[16:31], a[188:191], v[168:171], v[16:31]
  ds_read_b128 a[196:199], v184 offset:4096
  v_add_u32 v192, 65536, v192
  ds_read_b64_tr_b16 v[164:165], v192 offset:24576
  s_mul_i32 s50, s37, 114688
  s_lshl_b32 s49, s101, 5
  s_add_u32 s50, s50, s49
  s_lshl_b32 s49, s38, 12
  v_mfma_f32_32x32x16_bf16 v[32:47], v[172:175], a[184:187], v[32:47]
  ds_read_b64_tr_b16 v[166:167], v192 offset:25088
  s_add_u32 s50, s50, s49
  s_add_u32 s50, s50, 12713984
  s_mov_b32 s62, s50
  buffer_load_dwordx4 v[96:99], v194, s[20:23], s62 offen offset:0 sc1
  buffer_load_dwordx4 v[100:103], v194, s[20:23], s62 offen offset:1024 sc1
  buffer_load_dwordx4 v[104:107], v194, s[20:23], s62 offen offset:2048 sc1
  v_mfma_f32_32x32x16_bf16 v[48:63], v[172:175], a[188:191], v[48:63]
  buffer_load_dwordx4 v201, s[16:19], s47 offen offset:1024 lds
  buffer_load_dwordx4 v[108:111], v194, s[20:23], s62 offen offset:3072 sc1
  s_waitcnt lgkmcnt(3)
  v_mfma_f32_32x32x16_bf16 v[0:15], a[192:195], v[160:163], v[0:15]
  v_add_u32 v189, 65536, v189
  ds_read_b128 v[168:171], v189 offset:0
  v_add_u32 v185, 65536, v185
  ds_read_b128 a[200:203], v185 offset:0
  buffer_load_dwordx4 v202, s[16:19], s47 offen offset:2048 lds
  s_waitcnt lgkmcnt(4)
  v_mfma_f32_32x32x16_bf16 v[16:31], a[196:199], v[160:163], v[16:31]
  ds_read_b128 a[204:207], v185 offset:4096
  ds_read_b64_tr_b16 v[172:173], v192 offset:26624
  s_waitcnt lgkmcnt(4)
  v_mfma_f32_32x32x16_bf16 v[32:47], v[164:167], a[192:195], v[32:47]
  ds_read_b64_tr_b16 v[174:175], v192 offset:27136
  v_mfma_f32_32x32x16_bf16 v[48:63], v[164:167], a[196:199], v[48:63]
  buffer_load_dwordx4 v203, s[16:19], s47 offen offset:3072 lds
  s_waitcnt lgkmcnt(3)
  v_mfma_f32_32x32x16_bf16 v[0:15], a[200:203], v[168:171], v[0:15]
  v_add_u32 v190, 65536, v190
  ds_read_b128 v[160:163], v190 offset:0
  v_add_u32 v186, 65536, v186
  ds_read_b128 a[208:211], v186 offset:0
  s_add_u32 s47, s47, 114688
  s_add_u32 m0, s53, 4096
  s_nop 0
  buffer_load_dwordx4 v200, s[16:19], s47 offen offset:0 lds
  s_waitcnt lgkmcnt(4)
  v_mfma_f32_32x32x16_bf16 v[16:31], a[204:207], v[168:171], v[16:31]
  ds_read_b128 a[212:215], v186 offset:4096
  ds_read_b64_tr_b16 v[164:165], v192 offset:28672
  s_waitcnt lgkmcnt(4)
  v_mfma_f32_32x32x16_bf16 v[32:47], v[172:175], a[200:203], v[32:47]
  ds_read_b64_tr_b16 v[166:167], v192 offset:29184
  v_mfma_f32_32x32x16_bf16 v[48:63], v[172:175], a[204:207], v[48:63]
  buffer_load_dwordx4 v201, s[16:19], s47 offen offset:1024 lds
  s_waitcnt lgkmcnt(3)
  v_mfma_f32_32x32x16_bf16 v[0:15], a[208:211], v[160:163], v[0:15]
  v_add_u32 v191, 65536, v191
  ds_read_b128 v[168:171], v191 offset:0
  v_add_u32 v187, 65536, v187
  ds_read_b128 a[216:219], v187 offset:0
  buffer_load_dwordx4 v202, s[16:19], s47 offen offset:2048 lds
  s_waitcnt lgkmcnt(4)
  v_mfma_f32_32x32x16_bf16 v[16:31], a[212:215], v[160:163], v[16:31]
  ds_read_b128 a[220:223], v187 offset:4096
  ds_read_b64_tr_b16 v[172:173], v192 offset:30720
  s_waitcnt lgkmcnt(4)
  v_mfma_f32_32x32x16_bf16 v[32:47], v[164:167], a[208:211], v[32:47]
  ds_read_b64_tr_b16 v[174:175], v192 offset:31232
  v_mfma_f32_32x32x16_bf16 v[48:63], v[164:167], a[212:215], v[48:63]
  buffer_load_dwordx4 v203, s[16:19], s47 offen offset:3072 lds
  s_waitcnt lgkmcnt(3)
  v_mfma_f32_32x32x16_bf16 v[0:15], a[216:219], v[168:171], v[0:15]
  s_waitcnt vmcnt(12)
  s_waitcnt lgkmcnt(0)
  s_barrier
  ds_read_b128 v[160:163], v188 offset:32768
  ds_read_b128 a[224:227], v184 offset:32768
  s_add_u32 s45, s35, s32
  s_add_u32 s45, s45, 4
  s_and_b32 s45, s45, 7
  s_mul_i32 s47, s45, 229376
  s_add_u32 s47, s47, s101
  s_add_u32 m0, s53, 32768
  s_nop 0
  buffer_load_dwordx4 v200, s[16:19], s47 offen offset:0 lds
  v_mfma_f32_32x32x16_bf16 v[16:31], a[220:223], v[168:171], v[16:31]
  ds_read_b128 a[228:231], v184 offset:36864
  ds_read_b64_tr_b16 v[164:165], v192 offset:57344
  v_cmp_ne_u32 s[60:61], s36, v137
  v_cmp_ne_u32 vcc, s36, v139
  s_nop 0
  s_or_b64 s[60:61], s[60:61], vcc
  v_mfma_f32_32x32x16_bf16 v[32:47], v[172:175], a[216:219], v[32:47]
  ds_read_b64_tr_b16 v[166:167], v192 offset:57856
  v_cmp_ne_u32 vcc, s36, v141
  s_nop 0
  s_or_b64 s[60:61], s[60:61], vcc
  s_cmp_lg_u64 s[60:61], 0
  s_cbranch_scc1 FZH_slow4
FZH_ret5:
  v_lshlrev_b32 v149, 2, v142
  v_mfma_f32_32x32x16_bf16 v[48:63], v[172:175], a[220:223], v[48:63]
  buffer_load_dwordx4 v201, s[16:19], s47 offen offset:1024 lds
  s_lshl_b32 s48, s37, 8
  s_add_u32 s48, s48, 131072
  v_add_u32 v149, s48, v149
  s_mov_b32 s49, 0xbfb8aa3b
  v_lshlrev_b32 v145, 16, v136
  v_and_b32 v146, 0xffff0000, v136
  s_waitcnt lgkmcnt(3)
  v_mfma_f32_32x32x16_bf16 v[0:15], a[224:227], v[160:163], v[0:15]
  ds_read_b128 v[168:171], v189 offset:32768
  ds_read_b128 a[232:235], v185 offset:32768
  buffer_load_dwordx4 v202, s[16:19], s47 offen offset:2048 lds
  v_xor_b32 v146, 0x80000000, v146
  v_rcp_f32 v147, v145
  v_mul_f32 v216, v145, v145
  s_waitcnt lgkmcnt(4)
  v_mfma_f32_32x32x16_bf16 v[16:31], a[228:231], v[160:163], v[16:31]
  ds_read_b128 a[236:239], v185 offset:36864
  ds_read_b64_tr_b16 v[172:173], v192 offset:59392
  v_lshrrev_b32 v148, 16, v146
  v_or_b32 v146, v146, v148
  v_cndmask_b32 v206, v146, 0, s[56:57]
  v_cndmask_b32 v207, v148, 0, s[56:57]
  v_mov_b32 v208, 0
  s_waitcnt lgkmcnt(4)
  v_mfma_f32_32x32x16_bf16 v[32:47], v[164:167], a[224:227], v[32:47]
  ds_read_b64_tr_b16 v[174:175], v192 offset:59904
  v_mov_b32 v209, 0
  v_mul_f32 v214, s49, v147
  ds_write_b32 v149, v147 offset:0
  v_lshlrev_b32 v145, 16, v138
  v_and_b32 v146, 0xffff0000, v138
  v_xor_b32 v146, 0x80000000, v146
  v_mfma_f32_32x32x16_bf16 v[48:63], v[164:167], a[228:231], v[48:63]
  buffer_load_dwordx4 v203, s[16:19], s47 offen offset:3072 lds
  v_rcp_f32 v147, v145
  v_mul_f32 v217, v145, v145
  v_lshrrev_b32 v148, 16, v146
  v_or_b32 v146, v146, v148
  v_cndmask_b32 v210, v146, 0, s[56:57]
  s_waitcnt lgkmcnt(4)
  v_mfma_f32_32x32x16_bf16 v[0:15], a[232:235], v[168:171], v[0:15]
  ds_read_b128 v[160:163], v190 offset:32768
  ds_read_b128 a[240:243], v186 offset:32768
  s_add_u32 s47, s47, 114688
  s_add_u32 m0, s53, 36864
  s_nop 0
  buffer_load_dwordx4 v200, s[16:19], s47 offen offset:0 lds
  v_cndmask_b32 v211, v148, 0, s[56:57]
  s_waitcnt lgkmcnt(5)
  v_mfma_f32_32x32x16_bf16 v[16:31], a[236:239], v[168:171], v[16:31]
  ds_read_b128 a[244:247], v186 offset:36864
  ds_read_b64_tr_b16 v[164:165], v192 offset:61440
  v_mov_b32 v212, 0
  v_mov_b32 v213, 0
  v_mul_f32 v215, s49, v147
  ds_write_b32 v149, v147 offset:128
  v_cvt_pk_bf16_f32 v145, v140, v140
  s_waitcnt lgkmcnt(6)
  v_mfma_f32_32x32x16_bf16 v[32:47], v[172:175], a[232:235], v[32:47]
  ds_read_b64_tr_b16 v[166:167], v192 offset:61952
  v_and_b32 v145, 0xffff0000, v145
  v_sub_f32 v146, v140, v145
  v_cvt_pk_bf16_f32 v147, v146, v146
  v_and_b32 v147, 0xffff0000, v147
  v_sub_f32 v146, v146, v147
  v_mfma_f32_32x32x16_bf16 v[48:63], v[172:175], a[236:239], v[48:63]
  buffer_load_dwordx4 v201, s[16:19], s47 offen offset:1024 lds
  v_cvt_pk_bf16_f32 v219, v146, 0
  v_lshrrev_b32 v145, 16, v145
  v_or_b32 v218, v145, v147
  v_mov_b32 v220, 0
  v_mov_b32 v221, 0
  s_waitcnt vmcnt(16)
  v_cmp_ne_u32 s[60:61], s36, v97
  s_waitcnt lgkmcnt(4)
  v_mfma_f32_32x32x16_bf16 v[0:15], a[240:243], v[160:163], v[0:15]
  ds_read_b128 v[168:171], v191 offset:32768
  ds_read_b128 a[248:251], v187 offset:32768
  buffer_load_dwordx4 v202, s[16:19], s47 offen offset:2048 lds
  v_cmp_ne_u32 vcc, s36, v99
  s_nop 0
  s_or_b64 s[60:61], s[60:61], vcc
  s_waitcnt lgkmcnt(5)
  v_mfma_f32_32x32x16_bf16 v[16:31], a[244:247], v[160:163], v[16:31]
  ds_read_b128 a[252:255], v187 offset:36864
  ds_read_b64_tr_b16 v[172:173], v192 offset:63488
  s_waitcnt vmcnt(16)
  v_cmp_ne_u32 vcc, s36, v101
  s_nop 0
  s_or_b64 s[60:61], s[60:61], vcc
  s_waitcnt lgkmcnt(4)
  v_mfma_f32_32x32x16_bf16 v[32:47], v[164:167], a[240:243], v[32:47]
  ds_read_b64_tr_b16 v[174:175], v192 offset:64000
  v_cmp_ne_u32 vcc, s36, v103
  s_nop 0
  s_or_b64 s[60:61], s[60:61], vcc
  s_waitcnt vmcnt(15)
  v_cmp_ne_u32 vcc, s36, v105
  s_nop 0
  s_or_b64 s[60:61], s[60:61], vcc
  v_mfma_f32_32x32x16_bf16 v[48:63], v[164:167], a[244:247], v[48:63]
  buffer_load_dwordx4 v203, s[16:19], s47 offen offset:3072 lds
  v_cmp_ne_u32 vcc, s36, v107
  s_nop 0
  s_or_b64 s[60:61], s[60:61], vcc
  s_waitcnt vmcnt(14)
  v_cmp_ne_u32 vcc, s36, v109
  s_nop 0
  s_or_b64 s[60:61], s[60:61], vcc
  s_waitcnt lgkmcnt(3)
  v_mfma_f32_32x32x16_bf16 v[0:15], a[248:251], v[168:171], v[0:15]
  v_cmp_ne_u32 vcc, s36, v111
  s_nop 0
  s_or_b64 s[60:61], s[60:61], vcc
  s_cmp_lg_u64 s[60:61], 0
  s_cbranch_scc1 FZH_slow6
FZH_ret7:
  v_add_f32 v96, v96, v100
  v_add_f32 v98, v98, v102
  v_add_f32 v104, v104, v108
  v_add_f32 v106, v106, v110
  v_add_f32 v96, v96, v104
  v_add_f32 v98, v98, v106
  s_nop 1
  v_permlane32_swap_b32 v96, v98
  v_add_f32 v96, v96, v98
  v_cvt_pk_bf16_f32 v112, v96, v96
  v_and_b32 v112, 0xffff0000, v112
  v_sub_f32 v113, v96, v112
  v_cvt_pk_bf16_f32 v114, v113, v113
  v_and_b32 v114, 0xffff0000, v114
  v_sub_f32 v113, v113, v114
  v_cvt_pk_bf16_f32 v117, v113, 0
  v_lshrrev_b32 v112, 16, v112
  v_or_b32 v116, v112, v114
  v_and_b32 v115, 31, v193
  v_lshlrev_b32 v115, 4, v115
  v_lshrrev_b32 v112, 5, v193
  v_lshl_add_u32 v115, v112, 3, v115
  s_lshl_b32 s48, s38, 10
  s_lshl_b32 s49, s37, 9
  s_add_u32 s48, s48, s49
  s_add_u32 s48, s48, 137472
  v_add_u32 v115, s48, v115
  ds_write_b64 v115, v[116:117]
  s_waitcnt vmcnt(8)
  s_waitcnt lgkmcnt(0)
  s_barrier
  v_subrev_u32 v192, 65536, v192
  ds_read_b64_tr_b16 v[160:161], v192 offset:0
  ds_read_b64_tr_b16 v[162:163], v192 offset:512
  s_add_u32 s45, s35, s32
  s_add_u32 s45, s45, 0
  s_and_b32 s45, s45, 7
  s_mul_i32 s47, s45, 229376
  s_add_u32 s47, s47, s101
  s_add_u32 s47, s47, 128
  s_add_u32 m0, s53, 65536
  s_nop 0
  buffer_load_dwordx4 v200, s[12:15], s47 offen offset:0 lds
  v_mfma_f32_32x32x16_bf16 v[16:31], a[252:255], v[168:171], v[16:31]
  ds_read_b64_tr_b16 v[164:165], v192 offset:2048
  ds_read_b64_tr_b16 v[166:167], v192 offset:2560
  buffer_load_dwordx4 v201, s[12:15], s47 offen offset:1024 lds
  v_mfma_f32_32x32x16_bf16 v[32:47], v[172:175], a[248:251], v[32:47]
  buffer_load_dwordx4 v202, s[12:15], s47 offen offset:2048 lds
  v_mfma_f32_32x32x16_bf16 v[48:63], v[172:175], a[252:255], v[48:63]
  buffer_load_dwordx4 v203, s[12:15], s47 offen offset:3072 lds
  ds_read_b64_tr_b16 v[168:169], v192 offset:4096
  ds_read_b64_tr_b16 v[170:171], v192 offset:4608
  s_waitcnt lgkmcnt(4)
  v_mfma_f32_32x32x16_bf16 v[64:79], v[160:163], a[0:3], 0
  ds_read_b64_tr_b16 v[172:173], v192 offset:6144
  v_mfma_f32_32x32x16_bf16 v[0:15], v[206:209], v[218:221], v[0:15]
  v_mfma_f32_32x32x16_bf16 v[16:31], v[210:213], v[218:221], v[16:31]
  ds_read_b128 v[128:131], v224 offset:0
  ds_read_b128 v[132:135], v224 offset:16
  ds_read_b64 v[136:137], v222 offset:1536
  ds_read_b64 v[138:139], v222 offset:128
  ds_read_b64 v[140:141], v222 offset:256
  s_nop 5
  v_permlane16_swap_b32 v0, v1
  v_mfma_f32_32x32x16_bf16 v[80:95], v[160:163], a[4:7], 0
  ds_read_b64_tr_b16 v[174:175], v192 offset:6656
  s_add_u32 s47, s47, 114688
  s_add_u32 m0, s53, 69632
  s_nop 0
  buffer_load_dwordx4 v200, s[12:15], s47 offen offset:0 lds
  v_permlane16_swap_b32 v2, v3
  v_permlane16_swap_b32 v4, v5
  v_permlane16_swap_b32 v6, v7
  s_waitcnt lgkmcnt(9)
  v_mfma_f32_32x32x16_bf16 v[64:79], v[164:167], a[8:11], v[64:79]
  ds_read_b64_tr_b16 v[160:161], v192 offset:8192
  v_permlane16_swap_b32 v8, v9
  v_permlane16_swap_b32 v10, v11
  v_permlane16_swap_b32 v12, v13
  v_permlane16_swap_b32 v14, v15
  s_waitcnt lgkmcnt(6)
  v_mul_f32 v0, v128, v0
  v_mul_f32 v1, v128, v1
  v_mfma_f32_32x32x16_bf16 v[80:95], v[164:167], a[12:15], v[80:95]
  ds_read_b64_tr_b16 v[162:163], v192 offset:8704
  buffer_load_dwordx4 v201, s[12:15], s47 offen offset:1024 lds
  v_mul_f32 v2, v129, v2
  v_mul_f32 v3, v129, v3
  v_mul_f32 v4, v130, v4
  v_mul_f32 v5, v130, v5
  v_mul_f32 v6, v131, v6
  v_mul_f32 v7, v131, v7
  s_waitcnt lgkmcnt(6)
  v_mul_f32 v8, v132, v8
  v_mul_f32 v9, v132, v9
  v_mul_f32 v10, v133, v10
  v_mfma_f32_32x32x16_bf16 v[64:79], v[168:171], a[16:19], v[64:79]
  ds_read_b64_tr_b16 v[164:165], v192 offset:10240
  v_mul_f32 v11, v133, v11
  v_mul_f32 v12, v134, v12
  v_mul_f32 v13, v134, v13
  v_mul_f32 v14, v135, v14
  v_mul_f32 v15, v135, v15
  s_waitcnt lgkmcnt(6)
  v_fma_f32 v142, v136, v0, v2
  v_fma_f32 v143, v136, v1, v3
  v_fma_f32 v142, -v137, v1, v142
  v_fmac_f32 v143, v137, v0
  v_mfma_f32_32x32x16_bf16 v[80:95], v[168:171], a[20:23], v[80:95]
  ds_read_b64_tr_b16 v[166:167], v192 offset:10752
  buffer_load_dwordx4 v202, s[12:15], s47 offen offset:2048 lds
  v_fma_f32 v144, v136, v142, v4
  v_fma_f32 v145, v136, v143, v5
  v_fma_f32 v144, -v137, v143, v144
  v_fmac_f32 v145, v137, v142
  v_fma_f32 v142, v136, v144, v6
  v_fma_f32 v143, v136, v145, v7
  v_fma_f32 v142, -v137, v145, v142
  v_fmac_f32 v143, v137, v144
  s_waitcnt lgkmcnt(4)
  v_mfma_f32_32x32x16_bf16 v[64:79], v[172:175], a[24:27], v[64:79]
  ds_read_b64_tr_b16 v[168:169], v192 offset:12288
  v_fma_f32 v144, v136, v142, v8
  v_fma_f32 v145, v136, v143, v9
  v_fma_f32 v144, -v137, v143, v144
  v_fmac_f32 v145, v137, v142
  v_fma_f32 v142, v136, v144, v10
  v_fma_f32 v143, v136, v145, v11
  v_fma_f32 v142, -v137, v145, v142
  v_fmac_f32 v143, v137, v144
  v_fma_f32 v144, v136, v142, v12
  v_mfma_f32_32x32x16_bf16 v[80:95], v[172:175], a[28:31], v[80:95]
  ds_read_b64_tr_b16 v[170:171], v192 offset:12800
  buffer_load_dwordx4 v203, s[12:15], s47 offen offset:3072 lds
  v_fma_f32 v145, v136, v143, v13
  v_fma_f32 v144, -v137, v143, v144
  v_fmac_f32 v145, v137, v142
  v_fma_f32 v142, v136, v144, v14
  v_fma_f32 v143, v136, v145, v15
  v_fma_f32 v142, -v137, v145, v142
  v_fmac_f32 v143, v137, v144
  v_mov_b32 v144, 0
  v_mov_b32 v145, 0
  s_waitcnt lgkmcnt(4)
  v_mfma_f32_32x32x16_bf16 v[64:79], v[160:163], a[32:35], v[64:79]
  ds_read_b64_tr_b16 v[172:173], v192 offset:14336
  v_mov_b32 v146, v142
  v_mov_b32 v147, v143
  v_cndmask_b32 v148, 1.0, v138, s[58:59]
  v_cndmask_b32 v149, 0, v139, s[58:59]
  v_permlane16_swap_b32 v144, v146
  v_permlane16_swap_b32 v145, v147
  v_fmac_f32 v142, v138, v144
  v_fmac_f32 v143, v138, v145
  v_mfma_f32_32x32x16_bf16 v[80:95], v[160:163], a[36:39], v[80:95]
  ds_read_b64_tr_b16 v[174:175], v192 offset:14848
  s_add_u32 s45, s35, s32
  s_add_u32 s45, s45, 4
  s_and_b32 s45, s45, 7
  s_mul_i32 s47, s45, 229376
  s_add_u32 s47, s47, s101
  s_add_u32 s47, s47, 128
  s_add_u32 m0, s53, 98304
  s_nop 0
  buffer_load_dwordx4 v200, s[12:15], s47 offen offset:0 lds
  v_fma_f32 v142, -v139, v145, v142
  v_fmac_f32 v143, v139, v144
  s_waitcnt lgkmcnt(4)
  v_mfma_f32_32x32x16_bf16 v[64:79], v[164:167], a[40:43], v[64:79]
  ds_read_b64_tr_b16 v[160:161], v192 offset:16384
  v_mov_b32 v146, v142
  v_mov_b32 v147, v143
  v_mov_b32 v150, 0
  v_mov_b32 v151, 0
  v_permlane16_swap_b32 v142, v146
  v_permlane16_swap_b32 v143, v147
  s_nop 0
  v_permlane32_swap_b32 v150, v146
  v_mfma_f32_32x32x16_bf16 v[80:95], v[164:167], a[44:47], v[80:95]
  ds_read_b64_tr_b16 v[162:163], v192 offset:16896
  buffer_load_dwordx4 v201, s[12:15], s47 offen offset:1024 lds
  v_permlane32_swap_b32 v151, v147
  v_fmac_f32 v146, v140, v150
  v_fmac_f32 v147, v140, v151
  v_fma_f32 v146, -v141, v151, v146
  v_fmac_f32 v147, v141, v150
  v_fma_f32 v230, v148, v150, v144
  v_fma_f32 v231, v148, v151, v145
  v_fma_f32 v230, -v149, v151, v230
  s_waitcnt lgkmcnt(4)
  v_mfma_f32_32x32x16_bf16 v[64:79], v[168:171], a[48:51], v[64:79]
  ds_read_b64_tr_b16 v[164:165], v192 offset:18432
  v_fmac_f32 v231, v149, v150
  s_mov_b64 exec, s[56:57]
  ds_write_b64 v225, v[146:147] offset:768
  s_mov_b64 exec, -1
  ds_read_b128 v[128:131], v224 offset:128
  ds_read_b128 v[132:135], v224 offset:144
  ds_read_b64 v[136:137], v222 offset:1536
  ds_read_b64 v[138:139], v222 offset:128
  ds_read_b64 v[140:141], v222 offset:256
  v_permlane16_swap_b32 v16, v17
  v_mfma_f32_32x32x16_bf16 v[80:95], v[168:171], a[52:55], v[80:95]
  ds_read_b64_tr_b16 v[166:167], v192 offset:18944
  v_permlane16_swap_b32 v18, v19
  v_permlane16_swap_b32 v20, v21
  v_permlane16_swap_b32 v22, v23
  v_permlane16_swap_b32 v24, v25
  v_permlane16_swap_b32 v26, v27
  s_waitcnt lgkmcnt(10)
  v_mfma_f32_32x32x16_bf16 v[64:79], v[172:175], a[56:59], v[64:79]
  ds_read_b64_tr_b16 v[168:169], v192 offset:20480
  buffer_load_dwordx4 v202, s[12:15], s47 offen offset:2048 lds
  v_permlane16_swap_b32 v28, v29
  v_permlane16_swap_b32 v30, v31
  s_waitcnt lgkmcnt(6)
  v_mul_f32 v16, v128, v16
  v_mul_f32 v17, v128, v17
  v_mul_f32 v18, v129, v18
  v_mul_f32 v19, v129, v19
  v_mul_f32 v20, v130, v20
  v_mfma_f32_32x32x16_bf16 v[80:95], v[172:175], a[60:63], v[80:95]
  ds_read_b64_tr_b16 v[170:171], v192 offset:20992
  v_mul_f32 v21, v130, v21
  v_mul_f32 v22, v131, v22
  v_mul_f32 v23, v131, v23
  s_waitcnt lgkmcnt(6)
  v_mul_f32 v24, v132, v24
  v_mul_f32 v25, v132, v25
  v_mul_f32 v26, v133, v26
  v_mul_f32 v27, v133, v27
  v_mul_f32 v28, v134, v28
  v_mul_f32 v29, v134, v29
  v_mul_f32 v30, v135, v30
  v_mfma_f32_32x32x16_bf16 v[64:79], v[160:163], a[64:67], v[64:79]
  ds_read_b64_tr_b16 v[172:173], v192 offset:22528
  buffer_load_dwordx4 v203, s[12:15], s47 offen offset:3072 lds
  v_mul_f32 v31, v135, v31
  s_waitcnt lgkmcnt(6)
  v_fma_f32 v142, v136, v16, v18
  v_fma_f32 v143, v136, v17, v19
  v_fma_f32 v142, -v137, v17, v142
  v_fmac_f32 v143, v137, v16
  v_fma_f32 v144, v136, v142, v20
  v_fma_f32 v145, v136, v143, v21
  v_fma_f32 v144, -v137, v143, v144
  v_mfma_f32_32x32x16_bf16 v[80:95], v[160:163], a[68:71], v[80:95]
  ds_read_b64_tr_b16 v[174:175], v192 offset:23040
  v_fmac_f32 v145, v137, v142
  v_fma_f32 v142, v136, v144, v22
  v_fma_f32 v143, v136, v145, v23
  v_fma_f32 v142, -v137, v145, v142
  v_fmac_f32 v143, v137, v144
  v_fma_f32 v144, v136, v142, v24
  v_fma_f32 v145, v136, v143, v25
  v_fma_f32 v144, -v137, v143, v144
  v_fmac_f32 v145, v137, v142
  s_waitcnt lgkmcnt(4)
  v_mfma_f32_32x32x16_bf16 v[64:79], v[164:167], a[72:75], v[64:79]
  ds_read_b64_tr_b16 v[160:161], v192 offset:24576
  s_add_u32 s47, s47, 114688
  s_add_u32 m0, s53, 102400
  s_nop 0
  buffer_load_dwordx4 v200, s[12:15], s47 offen offset:0 lds
  v_fma_f32 v142, v136, v144, v26
  v_fma_f32 v143, v136, v145, v27
  v_fma_f32 v142, -v137, v145, v142
  v_fmac_f32 v143, v137, v144
  v_fma_f32 v144, v136, v142, v28
  v_fma_f32 v145, v136, v143, v29
  v_mfma_f32_32x32x16_bf16 v[80:95], v[164:167], a[76:79], v[80:95]
  ds_read_b64_tr_b16 v[162:163], v192 offset:25088
  v_fma_f32 v144, -v137, v143, v144
  v_fmac_f32 v145, v137, v142
  v_fma_f32 v142, v136, v144, v30
  v_fma_f32 v143, v136, v145, v31
  v_fma_f32 v142, -v137, v145, v142
  v_fmac_f32 v143, v137, v144
  v_mov_b32 v144, 0
  v_mov_b32 v145, 0
  v_mov_b32 v146, v142
  v_mov_b32 v147, v143
  s_waitcnt lgkmcnt(4)
  v_mfma_f32_32x32x16_bf16 v[64:79], v[168:171], a[80:83], v[64:79]
  ds_read_b64_tr_b16 v[164:165], v192 offset:26624
  buffer_load_dwordx4 v201, s[12:15], s47 offen offset:1024 lds
  v_cndmask_b32 v148, 1.0, v138, s[58:59]
  v_cndmask_b32 v149, 0, v139, s[58:59]
  v_permlane16_swap_b32 v144, v146
  v_permlane16_swap_b32 v145, v147
  v_fmac_f32 v142, v138, v144
  v_fmac_f32 v143, v138, v145
  v_fma_f32 v142, -v139, v145, v142
  v_mfma_f32_32x32x16_bf16 v[80:95], v[168:171], a[84:87], v[80:95]
  ds_read_b64_tr_b16 v[166:167], v192 offset:27136
  v_fmac_f32 v143, v139, v144
  v_mov_b32 v146, v142
  v_mov_b32 v147, v143
  v_mov_b32 v150, 0
  v_mov_b32 v151, 0
  v_permlane16_swap_b32 v142, v146
  v_permlane16_swap_b32 v143, v147
  s_nop 0
  v_permlane32_swap_b32 v150, v146
  s_waitcnt lgkmcnt(4)
  v_mfma_f32_32x32x16_bf16 v[64:79], v[172:175], a[88:91], v[64:79]
  ds_read_b64_tr_b16 v[168:169], v192 offset:28672
  buffer_load_dwordx4 v202, s[12:15], s47 offen offset:2048 lds
  v_permlane32_swap_b32 v151, v147
  v_fmac_f32 v146, v140, v150
  v_fmac_f32 v147, v140, v151
  v_fma_f32 v146, -v141, v151, v146
  v_fmac_f32 v147, v141, v150
  v_fma_f32 v232, v148, v150, v144
  v_fma_f32 v233, v148, v151, v145
  v_fma_f32 v232, -v149, v151, v232
  v_mfma_f32_32x32x16_bf16 v[80:95], v[172:175], a[92:95], v[80:95]
  ds_read_b64_tr_b16 v[170:171], v192 offset:29184
  v_fmac_f32 v233, v149, v150
  s_mov_b64 exec, s[56:57]
  ds_write_b64 v225, v[146:147] offset:1024
  s_mov_b64 exec, -1
  s_waitcnt lgkmcnt(5)
  v_mfma_f32_32x32x16_bf16 v[64:79], v[160:163], a[96:99], v[64:79]
  ds_read_b64_tr_b16 v[172:173], v192 offset:30720
  buffer_load_dwordx4 v203, s[12:15], s47 offen offset:3072 lds
  v_mfma_f32_32x32x16_bf16 v[80:95], v[160:163], a[100:103], v[80:95]
  ds_read_b64_tr_b16 v[174:175], v192 offset:31232
  s_waitcnt vmcnt(16)
  s_waitcnt lgkmcnt(0)
  s_barrier
  v_mfma_f32_32x32x16_bf16 v[64:79], v[164:167], a[104:107], v[64:79]
  ds_read_b64_tr_b16 v[160:161], v192 offset:32768
  v_mfma_f32_32x32x16_bf16 v[80:95], v[164:167], a[108:111], v[80:95]
  ds_read_b64_tr_b16 v[162:163], v192 offset:33280
  s_add_u32 s45, s35, s32
  s_add_u32 s45, s45, 0
  s_and_b32 s45, s45, 7
  s_mul_i32 s47, s45, 229376
  s_add_u32 s47, s47, s101
  s_add_u32 s47, s47, 128
  s_add_u32 m0, s53, 0
  s_nop 0
  buffer_load_dwordx4 v200, s[16:19], s47 offen offset:0 lds
  v_mfma_f32_32x32x16_bf16 v[64:79], v[168:171], a[112:115], v[64:79]
  ds_read_b64_tr_b16 v[164:165], v192 offset:34816
  v_mfma_f32_32x32x16_bf16 v[80:95], v[168:171], a[116:119], v[80:95]
  ds_read_b64_tr_b16 v[166:167], v192 offset:35328
  v_mfma_f32_32x32x16_bf16 v[64:79], v[172:175], a[120:123], v[64:79]
  ds_read_b64_tr_b16 v[168:169], v192 offset:36864
  v_mfma_f32_32x32x16_bf16 v[80:95], v[172:175], a[124:127], v[80:95]
  ds_read_b64_tr_b16 v[170:171], v192 offset:37376
  s_waitcnt lgkmcnt(4)
  v_mfma_f32_32x32x16_bf16 v[64:79], v[160:163], a[128:131], v[64:79]
  ds_read_b64_tr_b16 v[172:173], v192 offset:38912
  buffer_load_dwordx4 v201, s[16:19], s47 offen offset:1024 lds
  v_mfma_f32_32x32x16_bf16 v[80:95], v[160:163], a[132:135], v[80:95]
  ds_read_b64_tr_b16 v[174:175], v192 offset:39424
  s_waitcnt lgkmcnt(4)
  v_mfma_f32_32x32x16_bf16 v[64:79], v[164:167], a[136:139], v[64:79]
  ds_read_b64_tr_b16 v[160:161], v192 offset:40960
  v_mfma_f32_32x32x16_bf16 v[80:95], v[164:167], a[140:143], v[80:95]
  ds_read_b64_tr_b16 v[162:163], v192 offset:41472
  buffer_load_dwordx4 v202, s[16:19], s47 offen offset:2048 lds
  s_waitcnt lgkmcnt(4)
  v_mfma_f32_32x32x16_bf16 v[64:79], v[168:171], a[144:147], v[64:79]
  ds_read_b64_tr_b16 v[164:165], v192 offset:43008
  v_mfma_f32_32x32x16_bf16 v[80:95], v[168:171], a[148:151], v[80:95]
  ds_read_b64_tr_b16 v[166:167], v192 offset:43520
  s_waitcnt lgkmcnt(4)
  v_mfma_f32_32x32x16_bf16 v[64:79], v[172:175], a[152:155], v[64:79]
  ds_read_b64_tr_b16 v[168:169], v192 offset:45056
  v_mfma_f32_32x32x16_bf16 v[80:95], v[172:175], a[156:159], v[80:95]
  ds_read_b64_tr_b16 v[170:171], v192 offset:45568
  s_waitcnt lgkmcnt(0)
  s_barrier
  v_mfma_f32_32x32x16_bf16 v[64:79], v[160:163], a[160:163], v[64:79]
  ds_read_b64_tr_b16 v[172:173], v192 offset:47104
  buffer_load_dwordx4 v203, s[16:19], s47 offen offset:3072 lds
  ds_read_b64 v[240:241], v225 offset:0
  ds_read_b64 v[242:243], v225 offset:256
  ds_read_b64 v[244:245], v225 offset:512
  ds_read_b64 v[246:247], v225 offset:768
  ds_read_b64 v[248:249], v225 offset:1024
  ds_read_b64 v[250:251], v222 offset:640
  s_lshl_b32 s48, s34, 13
  s_lshl_b32 s49, s38, 12
  s_add_u32 s48, s48, s49
  s_add_u32 s96, s48, 13631488
  v_mfma_f32_32x32x16_bf16 v[80:95], v[160:163], a[164:167], v[80:95]
  ds_read_b64_tr_b16 v[174:175], v192 offset:47616
  s_waitcnt lgkmcnt(1)
  v_fmac_f32 v242, v250, v240
  v_fmac_f32 v243, v250, v241
  v_fma_f32 v242, -v251, v241, v242
  v_fmac_f32 v243, v251, v240
  v_fma_f32 v234, v250, v242, v244
  v_fma_f32 v235, v250, v243, v245
  v_fma_f32 v234, -v251, v243, v234
  v_fmac_f32 v235, v251, v242
  v_fma_f32 v236, v250, v234, v246
  v_mfma_f32_32x32x16_bf16 v[64:79], v[164:167], a[168:171], v[64:79]
  ds_read_b64_tr_b16 v[160:161], v192 offset:49152
  v_fma_f32 v237, v250, v235, v247
  v_fma_f32 v236, -v251, v235, v236
  v_fmac_f32 v237, v251, v234
  v_fmac_f32 v248, v250, v236
  v_fmac_f32 v249, v250, v237
  v_fma_f32 v248, -v251, v237, v248
  v_fmac_f32 v249, v251, v236
  v_mov_b32 v240, v248
  v_mov_b32 v241, s36
  v_mov_b32 v242, v249
  v_mfma_f32_32x32x16_bf16 v[80:95], v[164:167], a[172:175], v[80:95]
  ds_read_b64_tr_b16 v[162:163], v192 offset:49664
  s_add_u32 s47, s47, 114688
  s_add_u32 m0, s53, 4096
  s_nop 0
  buffer_load_dwordx4 v200, s[16:19], s47 offen offset:0 lds
  v_mov_b32 v243, s36
  buffer_store_dwordx4 v[240:243], v228, s[20:23], s96 offen sc1
  v_and_b32 v246, 31, v193
  v_lshlrev_b32 v246, 3, v246
  s_lshl_b32 s48, s38, 8
  s_add_u32 s48, s48, 137472
  v_add_u32 v246, s48, v246
  v_mfma_f32_32x32x16_bf16 v[64:79], v[168:171], a[176:179], v[64:79]
  ds_read_b64_tr_b16 v[164:165], v192 offset:51200
  ds_read_b64 v[244:245], v246
  v_mov_b32 v247, 0
  v_mov_b32 v246, 0
  s_waitcnt lgkmcnt(0)
  s_nop 0
  v_mfma_f32_32x32x16_bf16 v[32:47], v[244:247], v[206:209], v[32:47]
  v_mfma_f32_32x32x16_bf16 v[48:63], v[244:247], v[210:213], v[48:63]
  s_nop 10
  v_mul_f32 v152, v214, v32
  v_mfma_f32_32x32x16_bf16 v[80:95], v[168:171], a[180:183], v[80:95]
  ds_read_b64_tr_b16 v[166:167], v192 offset:51712
  v_mul_f32 v153, v214, v33
  v_mul_f32 v154, v214, v34
  v_mul_f32 v155, v214, v35
  v_mul_f32 v156, v214, v36
  v_mul_f32 v157, v214, v37
  v_mul_f32 v158, v214, v38
  v_mul_f32 v159, v214, v39
  v_exp_f32 v152, v152
  v_exp_f32 v153, v153
  v_mfma_f32_32x32x16_bf16 v[64:79], v[172:175], a[184:187], v[64:79]
  ds_read_b64_tr_b16 v[168:169], v192 offset:53248
  v_exp_f32 v154, v154
  v_exp_f32 v155, v155
  v_exp_f32 v156, v156
  v_exp_f32 v157, v157
  v_exp_f32 v158, v158
  v_mfma_f32_32x32x16_bf16 v[80:95], v[172:175], a[188:191], v[80:95]
  ds_read_b64_tr_b16 v[170:171], v192 offset:53760
  v_exp_f32 v159, v159
  v_fma_f32 v152, v216, v152, v216
  v_fma_f32 v153, v216, v153, v216
  v_fma_f32 v154, v216, v154, v216
  v_fma_f32 v155, v216, v155, v216
  v_fma_f32 v156, v216, v156, v216
  v_fma_f32 v157, v216, v157, v216
  v_fma_f32 v158, v216, v158, v216
  v_mfma_f32_32x32x16_bf16 v[64:79], v[160:163], a[192:195], v[64:79]
  ds_read_b64_tr_b16 v[172:173], v192 offset:55296
  buffer_load_dwordx4 v201, s[16:19], s47 offen offset:1024 lds
  v_fma_f32 v159, v216, v159, v216
  v_rcp_f32 v152, v152
  v_rcp_f32 v153, v153
  v_rcp_f32 v154, v154
  v_rcp_f32 v155, v155
  v_mfma_f32_32x32x16_bf16 v[80:95], v[160:163], a[196:199], v[80:95]
  ds_read_b64_tr_b16 v[174:175], v192 offset:55808
  v_rcp_f32 v156, v156
  v_rcp_f32 v157, v157
  v_rcp_f32 v158, v158
  v_rcp_f32 v159, v159
  v_mul_f32 v32, v32, v152
  v_mul_f32 v33, v33, v153
  v_mul_f32 v34, v34, v154
  s_waitcnt lgkmcnt(4)
  v_mfma_f32_32x32x16_bf16 v[64:79], v[164:167], a[200:203], v[64:79]
  ds_read_b64_tr_b16 v[160:161], v192 offset:57344
  v_mul_f32 v35, v35, v155
  v_mul_f32 v36, v36, v156
  v_mul_f32 v37, v37, v157
  v_mul_f32 v38, v38, v158
  v_mul_f32 v39, v39, v159
  v_mul_f32 v152, v214, v40
  v_mul_f32 v153, v214, v41
  v_mul_f32 v154, v214, v42
  v_mul_f32 v155, v214, v43
  v_mul_f32 v156, v214, v44
  v_mul_f32 v157, v214, v45
  v_mfma_f32_32x32x16_bf16 v[80:95], v[164:167], a[204:207], v[80:95]
  ds_read_b64_tr_b16 v[162:163], v192 offset:57856
  buffer_load_dwordx4 v202, s[16:19], s47 offen offset:2048 lds
  v_mul_f32 v158, v214, v46
  v_mul_f32 v159, v214, v47
  v_exp_f32 v152, v152
  v_exp_f32 v153, v153
  v_exp_f32 v154, v154
  v_exp_f32 v155, v155
  s_waitcnt lgkmcnt(4)
  v_mfma_f32_32x32x16_bf16 v[64:79], v[168:171], a[208:211], v[64:79]
  ds_read_b64_tr_b16 v[164:165], v192 offset:59392
  v_exp_f32 v156, v156
  v_exp_f32 v157, v157
  v_exp_f32 v158, v158
  v_exp_f32 v159, v159
  v_fma_f32 v152, v216, v152, v216
  v_fma_f32 v153, v216, v153, v216
  v_mfma_f32_32x32x16_bf16 v[80:95], v[168:171], a[212:215], v[80:95]
  ds_read_b64_tr_b16 v[166:167], v192 offset:59904
  v_fma_f32 v154, v216, v154, v216
  v_fma_f32 v155, v216, v155, v216
  v_fma_f32 v156, v216, v156, v216
  v_fma_f32 v157, v216, v157, v216
  v_fma_f32 v158, v216, v158, v216
  v_fma_f32 v159, v216, v159, v216
  v_rcp_f32 v152, v152
  s_waitcnt lgkmcnt(4)
  v_mfma_f32_32x32x16_bf16 v[64:79], v[172:175], a[216:219], v[64:79]
  ds_read_b64_tr_b16 v[168:169], v192 offset:61440
  v_rcp_f32 v153, v153
  v_rcp_f32 v154, v154
  v_rcp_f32 v155, v155
  v_rcp_f32 v156, v156
  v_rcp_f32 v157, v157
  v_mfma_f32_32x32x16_bf16 v[80:95], v[172:175], a[220:223], v[80:95]
  ds_read_b64_tr_b16 v[170:171], v192 offset:61952
  v_rcp_f32 v158, v158
  v_rcp_f32 v159, v159
  v_mul_f32 v40, v40, v152
  v_mul_f32 v41, v41, v153
  v_mul_f32 v42, v42, v154
  v_mul_f32 v43, v43, v155
  v_mul_f32 v44, v44, v156
  v_mul_f32 v45, v45, v157
  v_mul_f32 v46, v46, v158
  s_waitcnt lgkmcnt(4)
  v_mfma_f32_32x32x16_bf16 v[64:79], v[160:163], a[224:227], v[64:79]
  ds_read_b64_tr_b16 v[172:173], v192 offset:63488
  buffer_load_dwordx4 v203, s[16:19], s47 offen offset:3072 lds
  v_mul_f32 v47, v47, v159
  v_mul_f32 v152, v215, v48
  v_mul_f32 v153, v215, v49
  v_mul_f32 v154, v215, v50
  v_mul_f32 v155, v215, v51
  v_mul_f32 v156, v215, v52
  v_mul_f32 v157, v215, v53
  v_mul_f32 v158, v215, v54
  v_mul_f32 v159, v215, v55
  v_mfma_f32_32x32x16_bf16 v[80:95], v[160:163], a[228:231], v[80:95]
  ds_read_b64_tr_b16 v[174:175], v192 offset:64000
  v_exp_f32 v152, v152
  v_exp_f32 v153, v153
  v_exp_f32 v154, v154
  v_exp_f32 v155, v155
  v_exp_f32 v156, v156
  s_waitcnt vmcnt(17)
  s_waitcnt lgkmcnt(0)
  s_barrier
  v_mfma_f32_32x32x16_bf16 v[64:79], v[164:167], a[232:235], v[64:79]
  v_add_u32 v192, 65536, v192
  ds_read_b64_tr_b16 v[160:161], v192 offset:0
  v_exp_f32 v157, v157
  v_exp_f32 v158, v158
  v_exp_f32 v159, v159
  v_fma_f32 v152, v217, v152, v217
  v_fma_f32 v153, v217, v153, v217
  v_fma_f32 v154, v217, v154, v217
  v_mfma_f32_32x32x16_bf16 v[80:95], v[164:167], a[236:239], v[80:95]
  ds_read_b64_tr_b16 v[162:163], v192 offset:512
  s_add_u32 s45, s35, s32
  s_add_u32 s45, s45, 4
  s_and_b32 s45, s45, 7
  s_mul_i32 s47, s45, 229376
  s_add_u32 s47, s47, s101
  s_add_u32 s47, s47, 128
  s_add_u32 m0, s53, 32768
  s_nop 0
  buffer_load_dwordx4 v200, s[16:19], s47 offen offset:0 lds
  v_fma_f32 v155, v217, v155, v217
  v_mfma_f32_32x32x16_bf16 v[64:79], v[168:171], a[240:243], v[64:79]
  ds_read_b64_tr_b16 v[164:165], v192 offset:2048
  v_fma_f32 v156, v217, v156, v217
  v_fma_f32 v157, v217, v157, v217
  v_fma_f32 v158, v217, v158, v217
  v_fma_f32 v159, v217, v159, v217
  v_rcp_f32 v152, v152
  v_rcp_f32 v153, v153
  v_rcp_f32 v154, v154
  v_mfma_f32_32x32x16_bf16 v[80:95], v[168:171], a[244:247], v[80:95]
  ds_read_b64_tr_b16 v[166:167], v192 offset:2560
  v_rcp_f32 v155, v155
  v_rcp_f32 v156, v156
  v_rcp_f32 v157, v157
  v_rcp_f32 v158, v158
  v_rcp_f32 v159, v159
  v_mul_f32 v48, v48, v152
  v_mfma_f32_32x32x16_bf16 v[64:79], v[172:175], a[248:251], v[64:79]
  ds_read_b64_tr_b16 v[168:169], v192 offset:4096
  v_mul_f32 v49, v49, v153
  v_mul_f32 v50, v50, v154
  v_mul_f32 v51, v51, v155
  v_mul_f32 v52, v52, v156
  v_mul_f32 v53, v53, v157
  v_mul_f32 v54, v54, v158
  v_mul_f32 v55, v55, v159
  v_mul_f32 v152, v215, v56
  v_mul_f32 v153, v215, v57
  v_mul_f32 v154, v215, v58
  v_mul_f32 v155, v215, v59
  v_mfma_f32_32x32x16_bf16 v[80:95], v[172:175], a[252:255], v[80:95]
  ds_read_b64_tr_b16 v[170:171], v192 offset:4608
  v_mul_f32 v156, v215, v60
  v_mul_f32 v157, v215, v61
  v_mul_f32 v158, v215, v62
  v_mul_f32 v159, v215, v63
  v_exp_f32 v152, v152
  v_exp_f32 v153, v153
  v_exp_f32 v154, v154
  s_waitcnt lgkmcnt(4)
  v_mfma_f32_32x32x16_bf16 v[96:111], v[160:163], a[0:3], 0
  ds_read_b64_tr_b16 v[172:173], v192 offset:6144
  buffer_load_dwordx4 v201, s[16:19], s47 offen offset:1024 lds
  v_exp_f32 v155, v155
  v_exp_f32 v156, v156
  v_exp_f32 v157, v157
  v_mfma_f32_32x32x16_bf16 v[112:127], v[160:163], a[4:7], 0
  ds_read_b64_tr_b16 v[174:175], v192 offset:6656
  v_exp_f32 v158, v158
  v_exp_f32 v159, v159
  v_fma_f32 v152, v217, v152, v217
  v_fma_f32 v153, v217, v153, v217
  s_waitcnt lgkmcnt(4)
  v_mfma_f32_32x32x16_bf16 v[96:111], v[164:167], a[8:11], v[96:111]
  ds_read_b64_tr_b16 v[160:161], v192 offset:8192
  v_fma_f32 v154, v217, v154, v217
  v_fma_f32 v155, v217, v155, v217
  v_fma_f32 v156, v217, v156, v217
  v_fma_f32 v157, v217, v157, v217
  v_fma_f32 v158, v217, v158, v217
  v_mfma_f32_32x32x16_bf16 v[112:127], v[164:167], a[12:15], v[112:127]
  ds_read_b64_tr_b16 v[162:163], v192 offset:8704
  buffer_load_dwordx4 v202, s[16:19], s47 offen offset:2048 lds
  v_fma_f32 v159, v217, v159, v217
  v_rcp_f32 v152, v152
  v_rcp_f32 v153, v153
  s_waitcnt lgkmcnt(4)
  v_mfma_f32_32x32x16_bf16 v[96:111], v[168:171], a[16:19], v[96:111]
  ds_read_b64_tr_b16 v[164:165], v192 offset:10240
  v_rcp_f32 v154, v154
  v_rcp_f32 v155, v155
  v_rcp_f32 v156, v156
  v_mfma_f32_32x32x16_bf16 v[112:127], v[168:171], a[20:23], v[112:127]
  ds_read_b64_tr_b16 v[166:167], v192 offset:10752
  v_rcp_f32 v157, v157
  v_rcp_f32 v158, v158
  v_rcp_f32 v159, v159
  v_mul_f32 v56, v56, v152
  s_waitcnt lgkmcnt(4)
  v_mfma_f32_32x32x16_bf16 v[96:111], v[172:175], a[24:27], v[96:111]
  ds_read_b64_tr_b16 v[168:169], v192 offset:12288
  v_mul_f32 v57, v57, v153
  v_mul_f32 v58, v58, v154
  v_mul_f32 v59, v59, v155
  v_mul_f32 v60, v60, v156
  v_mul_f32 v61, v61, v157
  v_mul_f32 v62, v62, v158
  v_mul_f32 v63, v63, v159
  v_mfma_f32_32x32x16_bf16 v[112:127], v[172:175], a[28:31], v[112:127]
  ds_read_b64_tr_b16 v[170:171], v192 offset:12800
  v_and_b32 v246, 31, v193
  v_lshlrev_b32 v246, 3, v246
  s_lshl_b32 s48, s38, 8
  s_add_u32 s48, s48, 137984
  v_add_u32 v246, s48, v246
  ds_read_b64 v[244:245], v246
  v_mov_b32 v247, 0
  s_waitcnt lgkmcnt(5)
  v_mfma_f32_32x32x16_bf16 v[96:111], v[160:163], a[32:35], v[96:111]
  ds_read_b64_tr_b16 v[172:173], v192 offset:14336
  buffer_load_dwordx4 v203, s[16:19], s47 offen offset:3072 lds
  v_mov_b32 v246, 0
  s_waitcnt lgkmcnt(1)
  s_nop 0
  v_mfma_f32_32x32x16_bf16 v[64:79], v[244:247], v[206:209], v[64:79]
  v_mfma_f32_32x32x16_bf16 v[80:95], v[244:247], v[210:213], v[80:95]
  v_mfma_f32_32x32x16_bf16 v[112:127], v[160:163], a[36:39], v[112:127]
  ds_read_b64_tr_b16 v[174:175], v192 offset:14848
  s_nop 8
  v_mul_f32 v64, v64, v32
  v_mfma_f32_32x32x16_bf16 v[96:111], v[164:167], a[40:43], v[96:111]
  ds_read_b64_tr_b16 v[160:161], v192 offset:16384
  v_mul_f32 v65, v65, v33
  v_mul_f32 v66, v66, v34
  v_mul_f32 v67, v67, v35
  v_mul_f32 v68, v68, v36
  v_mul_f32 v69, v69, v37
  v_mul_f32 v70, v70, v38
  v_mul_f32 v71, v71, v39
  v_mfma_f32_32x32x16_bf16 v[112:127], v[164:167], a[44:47], v[112:127]
  ds_read_b64_tr_b16 v[162:163], v192 offset:16896
  s_add_u32 s47, s47, 114688
  s_add_u32 m0, s53, 36864
  s_nop 0
  buffer_load_dwordx4 v200, s[16:19], s47 offen offset:0 lds
  v_cvt_pk_bf16_f32 v64, v64, v65
  v_cvt_pk_bf16_f32 v65, v66, v67
  v_mfma_f32_32x32x16_bf16 v[96:111], v[168:171], a[48:51], v[96:111]
  ds_read_b64_tr_b16 v[164:165], v192 offset:18432
  v_cvt_pk_bf16_f32 v66, v68, v69
  v_cvt_pk_bf16_f32 v67, v70, v71
  s_mov_b32 s97, s55
  buffer_store_dwordx4 v[64:67], v194, s[20:23], s97 offen offset:0 sc1
  v_mul_f32 v72, v72, v40
  v_mul_f32 v73, v73, v41
  v_mfma_f32_32x32x16_bf16 v[112:127], v[168:171], a[52:55], v[112:127]
  ds_read_b64_tr_b16 v[166:167], v192 offset:18944
  v_mul_f32 v74, v74, v42
  v_mul_f32 v75, v75, v43
  v_mul_f32 v76, v76, v44
  v_mul_f32 v77, v77, v45
  v_mul_f32 v78, v78, v46
  v_mul_f32 v79, v79, v47
  v_cvt_pk_bf16_f32 v72, v72, v73
  s_waitcnt lgkmcnt(4)
  v_mfma_f32_32x32x16_bf16 v[96:111], v[172:175], a[56:59], v[96:111]
  ds_read_b64_tr_b16 v[168:169], v192 offset:20480
  v_cvt_pk_bf16_f32 v73, v74, v75
  v_cvt_pk_bf16_f32 v74, v76, v77
  v_cvt_pk_bf16_f32 v75, v78, v79
  s_mov_b32 s97, s55
  buffer_store_dwordx4 v[72:75], v194, s[20:23], s97 offen offset:1024 sc1
  v_mul_f32 v80, v80, v48
  v_mfma_f32_32x32x16_bf16 v[112:127], v[172:175], a[60:63], v[112:127]
  ds_read_b64_tr_b16 v[170:171], v192 offset:20992
  v_mul_f32 v81, v81, v49
  v_mul_f32 v82, v82, v50
  v_mul_f32 v83, v83, v51
  v_mul_f32 v84, v84, v52
  v_mul_f32 v85, v85, v53
  v_mul_f32 v86, v86, v54
  v_mul_f32 v87, v87, v55
  s_waitcnt lgkmcnt(4)
  v_mfma_f32_32x32x16_bf16 v[96:111], v[160:163], a[64:67], v[96:111]
  ds_read_b64_tr_b16 v[172:173], v192 offset:22528
  buffer_load_dwordx4 v201, s[16:19], s47 offen offset:1024 lds
  v_cvt_pk_bf16_f32 v80, v80, v81
  v_cvt_pk_bf16_f32 v81, v82, v83
  v_cvt_pk_bf16_f32 v82, v84, v85
  v_cvt_pk_bf16_f32 v83, v86, v87
  v_mfma_f32_32x32x16_bf16 v[112:127], v[160:163], a[68:71], v[112:127]
  ds_read_b64_tr_b16 v[174:175], v192 offset:23040
  s_add_u32 s97, s55, 180224
  buffer_store_dwordx4 v[80:83], v194, s[20:23], s97 offen offset:0 sc1
  v_mul_f32 v88, v88, v56
  v_mul_f32 v89, v89, v57
  v_mul_f32 v90, v90, v58
  v_mul_f32 v91, v91, v59
  v_mul_f32 v92, v92, v60
  s_waitcnt lgkmcnt(4)
  v_mfma_f32_32x32x16_bf16 v[96:111], v[164:167], a[72:75], v[96:111]
  ds_read_b64_tr_b16 v[160:161], v192 offset:24576
  v_mul_f32 v93, v93, v61
  v_mul_f32 v94, v94, v62
  v_mul_f32 v95, v95, v63
  v_cvt_pk_bf16_f32 v88, v88, v89
  v_cvt_pk_bf16_f32 v89, v90, v91
  v_cvt_pk_bf16_f32 v90, v92, v93
  v_mfma_f32_32x32x16_bf16 v[112:127], v[164:167], a[76:79], v[112:127]
  ds_read_b64_tr_b16 v[162:163], v192 offset:25088
  buffer_load_dwordx4 v202, s[16:19], s47 offen offset:2048 lds
  v_cvt_pk_bf16_f32 v91, v94, v95
  s_add_u32 s97, s55, 180224
  buffer_store_dwordx4 v[88:91], v194, s[20:23], s97 offen offset:1024 sc1
  v_and_b32 v56, 15, v193
  v_lshlrev_b32 v56, 4, v56
  v_lshrrev_b32 v57, 4, v193
  s_waitcnt lgkmcnt(4)
  v_mfma_f32_32x32x16_bf16 v[96:111], v[168:171], a[80:83], v[96:111]
  ds_read_b64_tr_b16 v[164:165], v192 offset:26624
  v_sub_u32 v57, s33, v57
  v_add_u32 v57, -1, v57
  v_lshl_add_u32 v48, v57, 8, v56
  v_mov_b32 v52, 1073741824
  v_cmp_le_i32 vcc, 0, v57
  s_nop 1
  v_cndmask_b32 v48, v52, v48, vcc
  v_cndmask_b32 v52, 0, v252, vcc
  v_mfma_f32_32x32x16_bf16 v[112:127], v[168:171], a[84:87], v[112:127]
  ds_read_b64_tr_b16 v[166:167], v192 offset:27136
  v_add_u32 v57, -4, v57
  v_lshl_add_u32 v49, v57, 8, v56
  v_mov_b32 v53, 1073741824
  v_cmp_le_i32 vcc, 0, v57
  s_nop 1
  v_cndmask_b32 v49, v53, v49, vcc
  v_cndmask_b32 v53, 0, v252, vcc
  s_waitcnt lgkmcnt(4)
  v_mfma_f32_32x32x16_bf16 v[96:111], v[172:175], a[88:91], v[96:111]
  ds_read_b64_tr_b16 v[168:169], v192 offset:28672
  v_add_u32 v57, -4, v57
  v_lshl_add_u32 v50, v57, 8, v56
  v_mov_b32 v54, 1073741824
  v_cmp_le_i32 vcc, 0, v57
  s_nop 1
  v_cndmask_b32 v50, v54, v50, vcc
  v_cndmask_b32 v54, 0, v252, vcc
  v_mfma_f32_32x32x16_bf16 v[112:127], v[172:175], a[92:95], v[112:127]
  ds_read_b64_tr_b16 v[170:171], v192 offset:29184
  v_add_u32 v57, -4, v57
  v_lshl_add_u32 v51, v57, 8, v56
  v_mov_b32 v55, 1073741824
  v_cmp_le_i32 vcc, 0, v57
  s_nop 1
  v_cndmask_b32 v51, v55, v51, vcc
  v_cndmask_b32 v55, 0, v252, vcc
  s_waitcnt lgkmcnt(4)
  v_mfma_f32_32x32x16_bf16 v[96:111], v[160:163], a[96:99], v[96:111]
  ds_read_b64_tr_b16 v[172:173], v192 offset:30720
  buffer_load_dwordx4 v203, s[16:19], s47 offen offset:3072 lds
  buffer_load_dwordx4 v[32:35], v48, s[20:23], s96 offen sc1
  buffer_load_dwordx4 v[36:39], v49, s[20:23], s96 offen sc1
  buffer_load_dwordx4 v[40:43], v50, s[20:23], s96 offen sc1
  buffer_load_dwordx4 v[44:47], v51, s[20:23], s96 offen sc1
  v_mfma_f32_32x32x16_bf16 v[112:127], v[160:163], a[100:103], v[112:127]
  ds_read_b64_tr_b16 v[174:175], v192 offset:31232
  s_waitcnt vmcnt(25)
  s_waitcnt lgkmcnt(0)
  s_barrier
  v_mfma_f32_32x32x16_bf16 v[96:111], v[164:167], a[104:107], v[96:111]
  ds_read_b64_tr_b16 v[160:161], v192 offset:32768
  v_mfma_f32_32x32x16_bf16 v[112:127], v[164:167], a[108:111], v[112:127]
  ds_read_b64_tr_b16 v[162:163], v192 offset:33280
  s_add_u32 m0, s53, 65536
  s_add_u32 s47, s78, 0
  buffer_load_dwordx4 v176, s[64:67], s47 offen offset:0 lds
  v_mfma_f32_32x32x16_bf16 v[96:111], v[168:171], a[112:115], v[96:111]
  ds_read_b64_tr_b16 v[164:165], v192 offset:34816
  v_mfma_f32_32x32x16_bf16 v[112:127], v[168:171], a[116:119], v[112:127]
  ds_read_b64_tr_b16 v[166:167], v192 offset:35328
  v_mfma_f32_32x32x16_bf16 v[96:111], v[172:175], a[120:123], v[96:111]
  ds_read_b64_tr_b16 v[168:169], v192 offset:36864
  v_mfma_f32_32x32x16_bf16 v[112:127], v[172:175], a[124:127], v[112:127]
  ds_read_b64_tr_b16 v[170:171], v192 offset:37376
  s_waitcnt lgkmcnt(4)
  v_mfma_f32_32x32x16_bf16 v[96:111], v[160:163], a[128:131], v[96:111]
  ds_read_b64_tr_b16 v[172:173], v192 offset:38912
  buffer_load_dwordx4 v177, s[64:67], s47 offen offset:1024 lds
  v_mfma_f32_32x32x16_bf16 v[112:127], v[160:163], a[132:135], v[112:127]
  ds_read_b64_tr_b16 v[174:175], v192 offset:39424
  s_waitcnt lgkmcnt(4)
  v_mfma_f32_32x32x16_bf16 v[96:111], v[164:167], a[136:139], v[96:111]
  ds_read_b64_tr_b16 v[160:161], v192 offset:40960
  v_mfma_f32_32x32x16_bf16 v[112:127], v[164:167], a[140:143], v[112:127]
  ds_read_b64_tr_b16 v[162:163], v192 offset:41472
  buffer_load_dwordx4 v178, s[64:67], s47 offen offset:2048 lds
  s_waitcnt lgkmcnt(4)
  v_mfma_f32_32x32x16_bf16 v[96:111], v[168:171], a[144:147], v[96:111]
  ds_read_b64_tr_b16 v[164:165], v192 offset:43008
  v_mfma_f32_32x32x16_bf16 v[112:127], v[168:171], a[148:151], v[112:127]
  ds_read_b64_tr_b16 v[166:167], v192 offset:43520
  s_waitcnt lgkmcnt(4)
  v_mfma_f32_32x32x16_bf16 v[96:111], v[172:175], a[152:155], v[96:111]
  ds_read_b64_tr_b16 v[168:169], v192 offset:45056
  v_mfma_f32_32x32x16_bf16 v[112:127], v[172:175], a[156:159], v[112:127]
  ds_read_b64_tr_b16 v[170:171], v192 offset:45568
  s_waitcnt lgkmcnt(4)
  v_mfma_f32_32x32x16_bf16 v[96:111], v[160:163], a[160:163], v[96:111]
  ds_read_b64_tr_b16 v[172:173], v192 offset:47104
  buffer_load_dwordx4 v179, s[64:67], s47 offen offset:3072 lds
  s_waitcnt vmcnt(9)
  buffer_store_dword v252, v229, s[20:23], s100 offen offset:0 sc1
  v_mfma_f32_32x32x16_bf16 v[112:127], v[160:163], a[164:167], v[112:127]
  ds_read_b64_tr_b16 v[174:175], v192 offset:47616
  s_waitcnt lgkmcnt(4)
  v_mfma_f32_32x32x16_bf16 v[96:111], v[164:167], a[168:171], v[96:111]
  ds_read_b64_tr_b16 v[160:161], v192 offset:49152
  v_mfma_f32_32x32x16_bf16 v[112:127], v[164:167], a[172:175], v[112:127]
  ds_read_b64_tr_b16 v[162:163], v192 offset:49664
  s_add_u32 m0, s53, 69632
  s_add_u32 s47, s78, 32768
  buffer_load_dwordx4 v176, s[64:67], s47 offen offset:0 lds
  s_waitcnt lgkmcnt(4)
  v_mfma_f32_32x32x16_bf16 v[96:111], v[168:171], a[176:179], v[96:111]
  ds_read_b64_tr_b16 v[164:165], v192 offset:51200
  v_mfma_f32_32x32x16_bf16 v[112:127], v[168:171], a[180:183], v[112:127]
  ds_read_b64_tr_b16 v[166:167], v192 offset:51712
  s_waitcnt lgkmcnt(4)
  v_mfma_f32_32x32x16_bf16 v[96:111], v[172:175], a[184:187], v[96:111]
  ds_read_b64_tr_b16 v[168:169], v192 offset:53248
  v_mfma_f32_32x32x16_bf16 v[112:127], v[172:175], a[188:191], v[112:127]
  ds_read_b64_tr_b16 v[170:171], v192 offset:53760
  s_waitcnt lgkmcnt(4)
  v_mfma_f32_32x32x16_bf16 v[96:111], v[160:163], a[192:195], v[96:111]
  ds_read_b64_tr_b16 v[172:173], v192 offset:55296
  buffer_load_dwordx4 v177, s[64:67], s47 offen offset:1024 lds
  v_mfma_f32_32x32x16_bf16 v[112:127], v[160:163], a[196:199], v[112:127]
  ds_read_b64_tr_b16 v[174:175], v192 offset:55808
  s_waitcnt lgkmcnt(4)
  v_mfma_f32_32x32x16_bf16 v[96:111], v[164:167], a[200:203], v[96:111]
  ds_read_b64_tr_b16 v[160:161], v192 offset:57344
  v_mfma_f32_32x32x16_bf16 v[112:127], v[164:167], a[204:207], v[112:127]
  ds_read_b64_tr_b16 v[162:163], v192 offset:57856
  buffer_load_dwordx4 v178, s[64:67], s47 offen offset:2048 lds
  s_waitcnt lgkmcnt(4)
  v_mfma_f32_32x32x16_bf16 v[96:111], v[168:171], a[208:211], v[96:111]
  ds_read_b64_tr_b16 v[164:165], v192 offset:59392
  ds_read_b64 v[56:57], v222 offset:1664
  ds_read_b64 v[58:59], v223 offset:1024
  s_waitcnt vmcnt(11)
  v_cmp_ne_u32 s[60:61], v52, v33
  v_cmp_ne_u32 vcc, v52, v35
  s_nop 0
  s_or_b64 s[60:61], s[60:61], vcc
  v_mfma_f32_32x32x16_bf16 v[112:127], v[168:171], a[212:215], v[112:127]
  ds_read_b64_tr_b16 v[166:167], v192 offset:59904
  s_waitcnt vmcnt(10)
  v_cmp_ne_u32 vcc, v53, v37
  s_nop 0
  s_or_b64 s[60:61], s[60:61], vcc
  v_cmp_ne_u32 vcc, v53, v39
  s_nop 0
  s_or_b64 s[60:61], s[60:61], vcc
  s_waitcnt lgkmcnt(6)
  v_mfma_f32_32x32x16_bf16 v[96:111], v[172:175], a[216:219], v[96:111]
  ds_read_b64_tr_b16 v[168:169], v192 offset:61440
  s_waitcnt vmcnt(9)
  v_cmp_ne_u32 vcc, v54, v41
  s_nop 0
  s_or_b64 s[60:61], s[60:61], vcc
  v_cmp_ne_u32 vcc, v54, v43
  s_nop 0
  s_or_b64 s[60:61], s[60:61], vcc
  v_mfma_f32_32x32x16_bf16 v[112:127], v[172:175], a[220:223], v[112:127]
  ds_read_b64_tr_b16 v[170:171], v192 offset:61952
  s_waitcnt vmcnt(8)
  v_cmp_ne_u32 vcc, v55, v45
  s_nop 0
  s_or_b64 s[60:61], s[60:61], vcc
  v_cmp_ne_u32 vcc, v55, v47
  s_nop 0
  s_or_b64 s[60:61], s[60:61], vcc
  s_waitcnt lgkmcnt(6)
  v_mfma_f32_32x32x16_bf16 v[96:111], v[160:163], a[224:227], v[96:111]
  ds_read_b64_tr_b16 v[172:173], v192 offset:63488
  buffer_load_dwordx4 v179, s[64:67], s47 offen offset:3072 lds
  s_cmp_lg_u64 s[60:61], 0
  s_cbranch_scc1 FZH_slow8
FZH_ret9:
  s_waitcnt lgkmcnt(5)
  v_fmac_f32 v40, v56, v44
  v_fmac_f32 v42, v56, v46
  v_fma_f32 v40, -v57, v46, v40
  v_mfma_f32_32x32x16_bf16 v[112:127], v[160:163], a[228:231], v[112:127]
  ds_read_b64_tr_b16 v[174:175], v192 offset:64000
  v_fmac_f32 v42, v57, v44
  v_fmac_f32 v36, v56, v40
  v_fmac_f32 v38, v56, v42
  v_fma_f32 v36, -v57, v42, v36
  v_fmac_f32 v38, v57, v40
  v_fmac_f32 v32, v56, v36
  v_fmac_f32 v34, v56, v38
  s_waitcnt lgkmcnt(0)
  s_barrier
  v_mfma_f32_32x32x16_bf16 v[96:111], v[164:167], a[232:235], v[96:111]
  v_subrev_u32 v192, 65536, v192
  ds_read_b64_tr_b16 v[160:161], v192 offset:0
  v_fma_f32 v32, -v57, v38, v32
  v_fmac_f32 v34, v57, v36
  v_mul_f32 v36, v58, v32
  v_mul_f32 v37, v58, v34
  v_fma_f32 v36, -v59, v34, v36
  v_mfma_f32_32x32x16_bf16 v[112:127], v[164:167], a[236:239], v[112:127]
  ds_read_b64_tr_b16 v[162:163], v192 offset:512
  s_add_u32 m0, s53, 98304
  s_add_u32 s47, s78, 131072
  buffer_load_dwordx4 v176, s[64:67], s47 offen offset:0 lds
  v_fmac_f32 v37, v59, v32
  s_nop 1
  v_permlane16_swap_b32 v36, v37
  v_mfma_f32_32x32x16_bf16 v[96:111], v[168:171], a[240:243], v[96:111]
  ds_read_b64_tr_b16 v[164:165], v192 offset:2048
  v_add_f32 v36, v36, v37
  v_mov_b32 v37, v36
  s_nop 1
  v_permlane32_swap_b32 v36, v37
  v_add_f32 v238, v36, v37
  v_mov_b32 v239, v238
  v_mfma_f32_32x32x16_bf16 v[112:127], v[168:171], a[244:247], v[112:127]
  ds_read_b64_tr_b16 v[166:167], v192 offset:2560
  v_permlane16_swap_b32 v238, v239
  s_lshl_b32 s48, s37, 8
  v_add_u32 v184, s48, v222
  ds_read_b64 v[242:243], v184 offset:512
  ds_read_b64 v[244:245], v223
  ds_read_b64 v[240:241], v222 offset:1536
  v_mfma_f32_32x32x16_bf16 v[96:111], v[172:175], a[248:251], v[96:111]
  ds_read_b64_tr_b16 v[168:169], v192 offset:4096
  ds_read_b64 v[246:247], v222 offset:1792
  s_lshl_b32 s48, s34, 1
  s_add_u32 s48, s48, s38
  s_lshr_b32 s49, s48, 2
  s_lshl_b32 s49, s49, 3
  s_and_b32 s48, s48, 3
  s_add_u32 s48, s48, s49
  v_mfma_f32_32x32x16_bf16 v[112:127], v[172:175], a[252:255], v[112:127]
  ds_read_b64_tr_b16 v[170:171], v192 offset:4608
  s_add_u32 s48, s48, 112
  s_lshl_b32 s48, s48, 10
  s_add_u32 s50, s48, s54
  s_waitcnt lgkmcnt(5)
  v_fmac_f32 v234, v242, v238
  v_fmac_f32 v235, v242, v239
  v_fma_f32 v234, -v243, v239, v234
  v_mfma_f32_32x32x16_bf16 v[128:143], v[160:163], a[0:3], 0
  ds_read_b64_tr_b16 v[172:173], v192 offset:6144
  buffer_load_dwordx4 v177, s[64:67], s47 offen offset:1024 lds
  v_fmac_f32 v235, v243, v238
  s_waitcnt lgkmcnt(5)
  v_fmac_f32 v230, v244, v234
  v_fmac_f32 v231, v244, v235
  v_fma_f32 v230, -v245, v235, v230
  v_fmac_f32 v231, v245, v234
  s_waitcnt lgkmcnt(4)
  v_fmac_f32 v0, v240, v230
  v_mfma_f32_32x32x16_bf16 v[144:159], v[160:163], a[4:7], 0
  ds_read_b64_tr_b16 v[174:175], v192 offset:6656
  v_fmac_f32 v1, v240, v231
  v_fma_f32 v0, -v241, v231, v0
  v_fmac_f32 v1, v241, v230
  v_fmac_f32 v2, v240, v0
  v_fmac_f32 v3, v240, v1
  v_fma_f32 v2, -v241, v1, v2
  v_fmac_f32 v3, v241, v0
  s_waitcnt lgkmcnt(3)
  v_mul_f32 v248, v0, v246
  v_mfma_f32_32x32x16_bf16 v[128:143], v[164:167], a[8:11], v[128:143]
  ds_read_b64_tr_b16 v[160:161], v192 offset:8192
  v_mul_f32 v249, v0, v247
  v_fma_f32 v0, -v1, v247, v248
  v_fma_f32 v1, -v1, v246, -v249
  v_fmac_f32 v4, v240, v2
  v_fmac_f32 v5, v240, v3
  v_fma_f32 v4, -v241, v3, v4
  v_fmac_f32 v5, v241, v2
  v_mul_f32 v250, v2, v246
  v_mfma_f32_32x32x16_bf16 v[144:159], v[164:167], a[12:15], v[144:159]
  ds_read_b64_tr_b16 v[162:163], v192 offset:8704
  buffer_load_dwordx4 v178, s[64:67], s47 offen offset:2048 lds
  v_mul_f32 v251, v2, v247
  v_fma_f32 v2, -v3, v247, v250
  v_fma_f32 v3, -v3, v246, -v251
  v_fmac_f32 v6, v240, v4
  v_fmac_f32 v7, v240, v5
  v_fma_f32 v6, -v241, v5, v6
  v_fmac_f32 v7, v241, v4
  s_waitcnt lgkmcnt(4)
  v_mfma_f32_32x32x16_bf16 v[128:143], v[168:171], a[16:19], v[128:143]
  ds_read_b64_tr_b16 v[164:165], v192 offset:10240
  v_mul_f32 v248, v4, v246
  v_mul_f32 v249, v4, v247
  v_fma_f32 v4, -v5, v247, v248
  v_fma_f32 v5, -v5, v246, -v249
  v_fmac_f32 v8, v240, v6
  v_fmac_f32 v9, v240, v7
  v_fma_f32 v8, -v241, v7, v8
  v_fmac_f32 v9, v241, v6
  v_mfma_f32_32x32x16_bf16 v[144:159], v[168:171], a[20:23], v[144:159]
  ds_read_b64_tr_b16 v[166:167], v192 offset:10752
  v_mul_f32 v250, v6, v246
  v_mul_f32 v251, v6, v247
  v_fma_f32 v6, -v7, v247, v250
  v_fma_f32 v7, -v7, v246, -v251
  v_fmac_f32 v10, v240, v8
  v_fmac_f32 v11, v240, v9
  v_fma_f32 v10, -v241, v9, v10
  v_fmac_f32 v11, v241, v8
  s_waitcnt lgkmcnt(4)
  v_mfma_f32_32x32x16_bf16 v[128:143], v[172:175], a[24:27], v[128:143]
  ds_read_b64_tr_b16 v[168:169], v192 offset:12288
  v_mul_f32 v248, v8, v246
  v_mul_f32 v249, v8, v247
  v_fma_f32 v8, -v9, v247, v248
  v_fma_f32 v9, -v9, v246, -v249
  v_fmac_f32 v12, v240, v10
  v_fmac_f32 v13, v240, v11
  v_fma_f32 v12, -v241, v11, v12
  v_fmac_f32 v13, v241, v10
  v_mfma_f32_32x32x16_bf16 v[144:159], v[172:175], a[28:31], v[144:159]
  ds_read_b64_tr_b16 v[170:171], v192 offset:12800
  v_mul_f32 v250, v10, v246
  v_mul_f32 v251, v10, v247
  v_fma_f32 v10, -v11, v247, v250
  v_fma_f32 v11, -v11, v246, -v251
  v_fmac_f32 v14, v240, v12
  v_fmac_f32 v15, v240, v13
  v_fma_f32 v14, -v241, v13, v14
  v_fmac_f32 v15, v241, v12
  s_waitcnt lgkmcnt(4)
  v_mfma_f32_32x32x16_bf16 v[128:143], v[160:163], a[32:35], v[128:143]
  ds_read_b64_tr_b16 v[172:173], v192 offset:14336
  buffer_load_dwordx4 v179, s[64:67], s47 offen offset:3072 lds
  v_mul_f32 v248, v12, v246
  v_mul_f32 v249, v12, v247
  v_fma_f32 v12, -v13, v247, v248
  v_fma_f32 v13, -v13, v246, -v249
  v_mul_f32 v250, v14, v246
  v_mul_f32 v251, v14, v247
  v_fma_f32 v14, -v15, v247, v250
  v_mfma_f32_32x32x16_bf16 v[144:159], v[160:163], a[36:39], v[144:159]
  ds_read_b64_tr_b16 v[174:175], v192 offset:14848
  v_fma_f32 v15, -v15, v246, -v251
  v_cvt_pk_bf16_f32 v184, v0, v2
  v_cvt_pk_bf16_f32 v185, v4, v6
  v_cvt_pk_bf16_f32 v186, v8, v10
  v_cvt_pk_bf16_f32 v187, v12, v14
  v_cvt_pk_bf16_f32 v188, v1, v3
  v_cvt_pk_bf16_f32 v189, v5, v7
  s_waitcnt lgkmcnt(4)
  v_mfma_f32_32x32x16_bf16 v[128:143], v[164:167], a[40:43], v[128:143]
  ds_read_b64_tr_b16 v[160:161], v192 offset:16384
  v_cvt_pk_bf16_f32 v190, v9, v11
  v_cvt_pk_bf16_f32 v191, v13, v15
  ds_write_b128 v226, v[184:187]
  ds_write_b128 v226, v[188:191] offset:1280
  ds_read_b64_tr_b16 v[0:1], v227 offset:0
  ds_read_b64_tr_b16 v[2:3], v227 offset:320
  ds_read_b64_tr_b16 v[4:5], v227 offset:1280
  ds_read_b64_tr_b16 v[6:7], v227 offset:1600
  v_mfma_f32_32x32x16_bf16 v[144:159], v[164:167], a[44:47], v[144:159]
  ds_read_b64_tr_b16 v[162:163], v192 offset:16896
  s_add_u32 m0, s53, 102400
  s_add_u32 s47, s78, 163840
  buffer_load_dwordx4 v176, s[64:67], s47 offen offset:0 lds
  s_waitcnt lgkmcnt(3)
  buffer_store_dwordx4 v[0:3], v194, s[20:23], s50 offen sc1
  s_add_u32 s50, s50, 4096
  s_waitcnt lgkmcnt(1)
  buffer_store_dwordx4 v[4:7], v194, s[20:23], s50 offen sc1
  s_lshl_b32 s48, s37, 8
  v_mfma_f32_32x32x16_bf16 v[128:143], v[168:171], a[48:51], v[128:143]
  ds_read_b64_tr_b16 v[164:165], v192 offset:18432
  v_add_u32 v184, s48, v222
  ds_read_b64 v[242:243], v184 offset:640
  ds_read_b64 v[244:245], v223
  ds_read_b64 v[240:241], v222 offset:1536
  ds_read_b64 v[246:247], v222 offset:1792
  s_lshl_b32 s48, s34, 1
  s_add_u32 s48, s48, s38
  s_lshr_b32 s49, s48, 2
  s_lshl_b32 s49, s49, 3
  v_mfma_f32_32x32x16_bf16 v[144:159], v[168:171], a[52:55], v[144:159]
  ds_read_b64_tr_b16 v[166:167], v192 offset:18944
  s_and_b32 s48, s48, 3
  s_add_u32 s48, s48, s49
  s_add_u32 s48, s48, 112
  s_lshl_b32 s48, s48, 10
  s_add_u32 s50, s48, s54
  s_add_u32 s50, s50, 180224
  s_waitcnt lgkmcnt(4)
  v_fmac_f32 v236, v242, v238
  v_fmac_f32 v237, v242, v239
  v_mfma_f32_32x32x16_bf16 v[128:143], v[172:175], a[56:59], v[128:143]
  ds_read_b64_tr_b16 v[168:169], v192 offset:20480
  v_fma_f32 v236, -v243, v239, v236
  v_fmac_f32 v237, v243, v238
  s_waitcnt lgkmcnt(4)
  v_fmac_f32 v232, v244, v236
  v_fmac_f32 v233, v244, v237
  v_fma_f32 v232, -v245, v237, v232
  v_fmac_f32 v233, v245, v236
  s_waitcnt lgkmcnt(3)
  v_fmac_f32 v16, v240, v232
  v_mfma_f32_32x32x16_bf16 v[144:159], v[172:175], a[60:63], v[144:159]
  ds_read_b64_tr_b16 v[170:171], v192 offset:20992
  buffer_load_dword v253, v183, s[20:23], s74 offen sc1
  v_fmac_f32 v17, v240, v233
  v_fma_f32 v16, -v241, v233, v16
  v_fmac_f32 v17, v241, v232
  v_fmac_f32 v18, v240, v16
  v_fmac_f32 v19, v240, v17
  v_fma_f32 v18, -v241, v17, v18
  v_fmac_f32 v19, v241, v16
  v_mfma_f32_32x32x16_bf16 v[128:143], v[160:163], a[64:67], v[128:143]
  ds_read_b64_tr_b16 v[172:173], v192 offset:22528
  s_waitcnt lgkmcnt(4)
  v_mul_f32 v248, v16, v246
  v_mul_f32 v249, v16, v247
  v_fma_f32 v16, -v17, v247, v248
  v_fma_f32 v17, -v17, v246, -v249
  v_fmac_f32 v20, v240, v18
  v_fmac_f32 v21, v240, v19
  v_fma_f32 v20, -v241, v19, v20
  v_mfma_f32_32x32x16_bf16 v[144:159], v[160:163], a[68:71], v[144:159]
  ds_read_b64_tr_b16 v[174:175], v192 offset:23040
  v_fmac_f32 v21, v241, v18
  v_mul_f32 v250, v18, v246
  v_mul_f32 v251, v18, v247
  v_fma_f32 v18, -v19, v247, v250
  v_fma_f32 v19, -v19, v246, -v251
  v_fmac_f32 v22, v240, v20
  v_fmac_f32 v23, v240, v21
  v_fma_f32 v22, -v241, v21, v22
  s_waitcnt lgkmcnt(4)
  v_mfma_f32_32x32x16_bf16 v[128:143], v[164:167], a[72:75], v[128:143]
  ds_read_b64_tr_b16 v[160:161], v192 offset:24576
  buffer_load_dwordx4 v177, s[64:67], s47 offen offset:1024 lds
  v_fmac_f32 v23, v241, v20
  v_mul_f32 v248, v20, v246
  v_mul_f32 v249, v20, v247
  v_fma_f32 v20, -v21, v247, v248
  v_fma_f32 v21, -v21, v246, -v249
  v_fmac_f32 v24, v240, v22
  v_fmac_f32 v25, v240, v23
  v_mfma_f32_32x32x16_bf16 v[144:159], v[164:167], a[76:79], v[144:159]
  ds_read_b64_tr_b16 v[162:163], v192 offset:25088
  v_fma_f32 v24, -v241, v23, v24
  v_fmac_f32 v25, v241, v22
  v_mul_f32 v250, v22, v246
  v_mul_f32 v251, v22, v247
  v_fma_f32 v22, -v23, v247, v250
  v_fma_f32 v23, -v23, v246, -v251
  v_fmac_f32 v26, v240, v24
  v_fmac_f32 v27, v240, v25
  s_waitcnt lgkmcnt(4)
  v_mfma_f32_32x32x16_bf16 v[128:143], v[168:171], a[80:83], v[128:143]
  ds_read_b64_tr_b16 v[164:165], v192 offset:26624
  v_fma_f32 v26, -v241, v25, v26
  v_fmac_f32 v27, v241, v24
  v_mul_f32 v248, v24, v246
  v_mul_f32 v249, v24, v247
  v_fma_f32 v24, -v25, v247, v248
  v_fma_f32 v25, -v25, v246, -v249
  v_fmac_f32 v28, v240, v26
  v_fmac_f32 v29, v240, v27
  v_mfma_f32_32x32x16_bf16 v[144:159], v[168:171], a[84:87], v[144:159]
  ds_read_b64_tr_b16 v[166:167], v192 offset:27136
  buffer_load_dwordx4 v178, s[64:67], s47 offen offset:2048 lds
  v_fma_f32 v28, -v241, v27, v28
  v_fmac_f32 v29, v241, v26
  v_mul_f32 v250, v26, v246
  v_mul_f32 v251, v26, v247
  v_fma_f32 v26, -v27, v247, v250
  v_fma_f32 v27, -v27, v246, -v251
  v_fmac_f32 v30, v240, v28
  s_waitcnt lgkmcnt(4)
  v_mfma_f32_32x32x16_bf16 v[128:143], v[172:175], a[88:91], v[128:143]
  ds_read_b64_tr_b16 v[168:169], v192 offset:28672
  v_fmac_f32 v31, v240, v29
  v_fma_f32 v30, -v241, v29, v30
  v_fmac_f32 v31, v241, v28
  v_mul_f32 v248, v28, v246
  v_mul_f32 v249, v28, v247
  v_fma_f32 v28, -v29, v247, v248
  v_fma_f32 v29, -v29, v246, -v249
  v_mul_f32 v250, v30, v246
  v_mfma_f32_32x32x16_bf16 v[144:159], v[172:175], a[92:95], v[144:159]
  ds_read_b64_tr_b16 v[170:171], v192 offset:29184
  v_mul_f32 v251, v30, v247
  v_fma_f32 v30, -v31, v247, v250
  v_fma_f32 v31, -v31, v246, -v251
  v_cvt_pk_bf16_f32 v184, v16, v18
  v_cvt_pk_bf16_f32 v185, v20, v22
  v_cvt_pk_bf16_f32 v186, v24, v26
  v_cvt_pk_bf16_f32 v187, v28, v30
  s_waitcnt lgkmcnt(4)
  v_mfma_f32_32x32x16_bf16 v[128:143], v[160:163], a[96:99], v[128:143]
  ds_read_b64_tr_b16 v[172:173], v192 offset:30720
  buffer_load_dwordx4 v179, s[64:67], s47 offen offset:3072 lds
  v_cvt_pk_bf16_f32 v188, v17, v19
  v_cvt_pk_bf16_f32 v189, v21, v23
  v_cvt_pk_bf16_f32 v190, v25, v27
  v_cvt_pk_bf16_f32 v191, v29, v31
  ds_write_b128 v226, v[184:187]
  ds_write_b128 v226, v[188:191] offset:1280
  ds_read_b64_tr_b16 v[16:17], v227 offset:0
  v_mfma_f32_32x32x16_bf16 v[144:159], v[160:163], a[100:103], v[144:159]
  ds_read_b64_tr_b16 v[174:175], v192 offset:31232
  ds_read_b64_tr_b16 v[18:19], v227 offset:320
  ds_read_b64_tr_b16 v[20:21], v227 offset:1280
  ds_read_b64_tr_b16 v[22:23], v227 offset:1600
  s_waitcnt lgkmcnt(2)
  buffer_store_dwordx4 v[16:19], v194, s[20:23], s50 offen sc1
  s_add_u32 s50, s50, 4096
  s_waitcnt lgkmcnt(0)
  buffer_store_dwordx4 v[20:23], v194, s[20:23], s50 offen sc1
  v_lshrrev_b32 v240, 3, v193
  s_barrier
  v_mfma_f32_32x32x16_bf16 v[128:143], v[164:167], a[104:107], v[128:143]
  ds_read_b64_tr_b16 v[160:161], v192 offset:32768
  v_lshlrev_b32 v240, 10, v240
  v_lshrrev_b32 v241, 4, v193
  v_and_b32 v242, 7, v193
  v_xor_b32 v241, v241, v242
  v_lshl_add_u32 v196, v241, 4, v240
  v_xor_b32 v197, 64, v196
  v_add_u32 v197, 7168, v197
  v_add_u32 v198, 14336, v196
  v_add_u32 v199, 14336, v197
  v_mfma_f32_32x32x16_bf16 v[144:159], v[164:167], a[108:111], v[144:159]
  ds_read_b64_tr_b16 v[162:163], v192 offset:33280
  s_add_u32 m0, s53, 0
  s_add_u32 s47, s78, 262144
  buffer_load_dwordx4 v176, s[64:67], s47 offen offset:0 lds
  v_and_b32 v240, 31, v193
  v_lshlrev_b32 v240, 7, v240
  v_bfe_u32 v242, v193, 1, 3
  v_lshrrev_b32 v241, 5, v193
  v_xor_b32 v242, v242, v241
  v_mfma_f32_32x32x16_bf16 v[128:143], v[168:171], a[112:115], v[128:143]
  ds_read_b64_tr_b16 v[164:165], v192 offset:34816
  v_lshl_add_u32 v240, v242, 4, v240
  v_add_u32 v184, s53, v240
  v_xor_b32 v185, 32, v184
  v_xor_b32 v186, 64, v184
  v_xor_b32 v187, 96, v184
  v_and_b32 v246, 31, v193
  v_lshlrev_b32 v246, 3, v246
  s_lshl_b32 s48, s38, 8
  s_add_u32 s48, s48, 138496
  v_mfma_f32_32x32x16_bf16 v[144:159], v[168:171], a[116:119], v[144:159]
  ds_read_b64_tr_b16 v[166:167], v192 offset:35328
  buffer_load_dwordx4 v177, s[64:67], s47 offen offset:1024 lds
  v_add_u32 v246, s48, v246
  ds_read_b64 v[244:245], v246
  v_mov_b32 v247, 0
  v_mov_b32 v246, 0
  s_waitcnt lgkmcnt(0)
  s_nop 0
  v_mfma_f32_32x32x16_bf16 v[96:111], v[244:247], v[206:209], v[96:111]
  v_mfma_f32_32x32x16_bf16 v[128:143], v[172:175], a[120:123], v[128:143]
  ds_read_b64_tr_b16 v[168:169], v192 offset:36864
  buffer_load_dwordx4 v178, s[64:67], s47 offen offset:2048 lds
  v_mfma_f32_32x32x16_bf16 v[112:127], v[244:247], v[210:213], v[112:127]
  s_nop 7
  v_mul_f32 v64, v214, v96
  v_mfma_f32_32x32x16_bf16 v[144:159], v[172:175], a[124:127], v[144:159]
  ds_read_b64_tr_b16 v[170:171], v192 offset:37376
  buffer_load_dwordx4 v179, s[64:67], s47 offen offset:3072 lds
  v_mul_f32 v65, v214, v97
  v_mul_f32 v66, v214, v98
  v_mul_f32 v67, v214, v99
  v_mul_f32 v68, v214, v100
  v_mul_f32 v69, v214, v101
  v_mul_f32 v70, v214, v102
  v_mul_f32 v71, v214, v103
  v_mfma_f32_32x32x16_bf16 v[128:143], v[160:163], a[128:131], v[128:143]
  ds_read_b64_tr_b16 v[172:173], v192 offset:38912
  s_add_u32 m0, s53, 4096
  s_add_u32 s47, s78, 294912
  buffer_load_dwordx4 v176, s[64:67], s47 offen offset:0 lds
  v_exp_f32 v64, v64
  v_exp_f32 v65, v65
  v_exp_f32 v66, v66
  v_mfma_f32_32x32x16_bf16 v[144:159], v[160:163], a[132:135], v[144:159]
  ds_read_b64_tr_b16 v[174:175], v192 offset:39424
  buffer_load_dwordx4 v177, s[64:67], s47 offen offset:1024 lds
  v_exp_f32 v67, v67
  v_exp_f32 v68, v68
  v_exp_f32 v69, v69
  v_exp_f32 v70, v70
  v_mfma_f32_32x32x16_bf16 v[128:143], v[164:167], a[136:139], v[128:143]
  ds_read_b64_tr_b16 v[160:161], v192 offset:40960
  buffer_load_dwordx4 v178, s[64:67], s47 offen offset:2048 lds
  v_exp_f32 v71, v71
  v_fma_f32 v64, v216, v64, v216
  v_fma_f32 v65, v216, v65, v216
  v_fma_f32 v66, v216, v66, v216
  v_fma_f32 v67, v216, v67, v216
  v_fma_f32 v68, v216, v68, v216
  v_mfma_f32_32x32x16_bf16 v[144:159], v[164:167], a[140:143], v[144:159]
  ds_read_b64_tr_b16 v[162:163], v192 offset:41472
  buffer_load_dwordx4 v179, s[64:67], s47 offen offset:3072 lds
  v_fma_f32 v69, v216, v69, v216
  v_fma_f32 v70, v216, v70, v216
  v_fma_f32 v71, v216, v71, v216
  v_rcp_f32 v64, v64
  v_rcp_f32 v65, v65
  s_waitcnt lgkmcnt(4)
  v_mfma_f32_32x32x16_bf16 v[128:143], v[168:171], a[144:147], v[128:143]
  ds_read_b64_tr_b16 v[164:165], v192 offset:43008
  v_rcp_f32 v66, v66
  v_rcp_f32 v67, v67
  v_rcp_f32 v68, v68
  v_rcp_f32 v69, v69
  v_mfma_f32_32x32x16_bf16 v[144:159], v[168:171], a[148:151], v[144:159]
  ds_read_b64_tr_b16 v[166:167], v192 offset:43520
  v_rcp_f32 v70, v70
  v_rcp_f32 v71, v71
  v_mul_f32 v96, v96, v64
  v_mul_f32 v97, v97, v65
  v_mul_f32 v98, v98, v66
  v_mul_f32 v99, v99, v67
  v_mul_f32 v100, v100, v68
  s_waitcnt lgkmcnt(4)
  v_mfma_f32_32x32x16_bf16 v[128:143], v[172:175], a[152:155], v[128:143]
  ds_read_b64_tr_b16 v[168:169], v192 offset:45056
  s_waitcnt vmcnt(13)
  v_cmp_eq_u32 vcc, s36, v253
  s_nop 0
  s_and_b32 s45, vcc_lo, 0xff
  s_cmp_eq_u32 s45, 0xff
  s_cbranch_scc0 FZH_pslow10
FZH_pret11:
  v_mul_f32 v101, v101, v69
  v_mul_f32 v102, v102, v70
  v_mul_f32 v103, v103, v71
  v_mfma_f32_32x32x16_bf16 v[144:159], v[172:175], a[156:159], v[144:159]
  ds_read_b64_tr_b16 v[170:171], v192 offset:45568
  v_mul_f32 v64, v214, v104
  v_mul_f32 v65, v214, v105
  v_mul_f32 v66, v214, v106
  v_mul_f32 v67, v214, v107
  v_mul_f32 v68, v214, v108
  v_mul_f32 v69, v214, v109
  v_mul_f32 v70, v214, v110
  v_mul_f32 v71, v214, v111
  s_waitcnt lgkmcnt(4)
  v_mfma_f32_32x32x16_bf16 v[128:143], v[160:163], a[160:163], v[128:143]
  ds_read_b64_tr_b16 v[172:173], v192 offset:47104
  v_lshrrev_b32 v201, 3, v193
  v_cmp_gt_u32 vcc, 1, v201
  v_mov_b32 v201, 0
  v_and_b32 v200, 7, v193
  v_lshl_add_u32 v200, v200, 7, v201
  v_mov_b32 v201, 1073741824
  v_cndmask_b32 v200, v201, v200, vcc
  s_lshr_b32 s45, s41, 2
  s_mul_i32 s45, s45, 180224
  s_and_b32 s46, s41, 3
  s_lshl_b32 s46, s46, 10
  s_add_u32 s45, s45, s46
  s_add_u32 s45, s45, s72
  s_add_u32 s45, s45, 16384
  buffer_load_dword v255, v200, s[20:23], s45 offen sc1
  v_mfma_f32_32x32x16_bf16 v[144:159], v[160:163], a[164:167], v[144:159]
  ds_read_b64_tr_b16 v[174:175], v192 offset:47616
  s_add_u32 s46, s72, 0
  buffer_load_dwordx4 a[0:3], v194, s[20:23], s46 offen offset:0 sc1
  v_exp_f32 v64, v64
  v_exp_f32 v65, v65
  v_exp_f32 v66, v66
  s_waitcnt lgkmcnt(4)
  v_mfma_f32_32x32x16_bf16 v[128:143], v[164:167], a[168:171], v[128:143]
  ds_read_b64_tr_b16 v[160:161], v192 offset:49152
  buffer_load_dwordx4 a[4:7], v182, s[20:23], s46 offen offset:0 sc1
  v_exp_f32 v67, v67
  v_exp_f32 v68, v68
  v_exp_f32 v69, v69
  v_exp_f32 v70, v70
  v_mfma_f32_32x32x16_bf16 v[144:159], v[164:167], a[172:175], v[144:159]
  ds_read_b64_tr_b16 v[162:163], v192 offset:49664
  buffer_load_dwordx4 a[8:11], v194, s[20:23], s46 offen offset:1024 sc1
  v_exp_f32 v71, v71
  v_fma_f32 v64, v216, v64, v216
  v_fma_f32 v65, v216, v65, v216
  v_fma_f32 v66, v216, v66, v216
  v_fma_f32 v67, v216, v67, v216
  v_fma_f32 v68, v216, v68, v216
  s_waitcnt lgkmcnt(4)
  v_mfma_f32_32x32x16_bf16 v[128:143], v[168:171], a[176:179], v[128:143]
  ds_read_b64_tr_b16 v[164:165], v192 offset:51200
  buffer_load_dwordx4 a[12:15], v182, s[20:23], s46 offen offset:1024 sc1
  s_waitcnt vmcnt(13)
  buffer_store_dword v252, v229, s[20:23], s100 offen offset:32 sc1
  v_fma_f32 v69, v216, v69, v216
  v_fma_f32 v70, v216, v70, v216
  v_fma_f32 v71, v216, v71, v216
  v_rcp_f32 v64, v64
  v_mfma_f32_32x32x16_bf16 v[144:159], v[168:171], a[180:183], v[144:159]
  ds_read_b64_tr_b16 v[166:167], v192 offset:51712
  v_rcp_f32 v65, v65
  v_rcp_f32 v66, v66
  v_rcp_f32 v67, v67
  v_rcp_f32 v68, v68
  s_waitcnt lgkmcnt(4)
  v_mfma_f32_32x32x16_bf16 v[128:143], v[172:175], a[184:187], v[128:143]
  ds_read_b64_tr_b16 v[168:169], v192 offset:53248
  buffer_load_dwordx4 a[16:19], v194, s[20:23], s46 offen offset:2048 sc1
  v_rcp_f32 v69, v69
  v_rcp_f32 v70, v70
  v_rcp_f32 v71, v71
  v_mul_f32 v104, v104, v64
  v_mul_f32 v105, v105, v65
  v_mfma_f32_32x32x16_bf16 v[144:159], v[172:175], a[188:191], v[144:159]
  ds_read_b64_tr_b16 v[170:171], v192 offset:53760
  buffer_load_dwordx4 a[20:23], v182, s[20:23], s46 offen offset:2048 sc1
  v_mul_f32 v106, v106, v66
  v_mul_f32 v107, v107, v67
  v_mul_f32 v108, v108, v68
  v_mul_f32 v109, v109, v69
  v_mul_f32 v110, v110, v70
  v_mul_f32 v111, v111, v71
  v_mul_f32 v64, v215, v112
  v_mul_f32 v65, v215, v113
  s_waitcnt lgkmcnt(4)
  v_mfma_f32_32x32x16_bf16 v[128:143], v[160:163], a[192:195], v[128:143]
  ds_read_b64_tr_b16 v[172:173], v192 offset:55296
  buffer_load_dwordx4 a[24:27], v194, s[20:23], s46 offen offset:3072 sc1
  v_mul_f32 v66, v215, v114
  v_mul_f32 v67, v215, v115
  v_mul_f32 v68, v215, v116
  v_mul_f32 v69, v215, v117
  v_mul_f32 v70, v215, v118
  v_mul_f32 v71, v215, v119
  v_exp_f32 v64, v64
  v_mfma_f32_32x32x16_bf16 v[144:159], v[160:163], a[196:199], v[144:159]
  ds_read_b64_tr_b16 v[174:175], v192 offset:55808
  buffer_load_dwordx4 a[28:31], v182, s[20:23], s46 offen offset:3072 sc1
  v_exp_f32 v65, v65
  v_exp_f32 v66, v66
  v_exp_f32 v67, v67
  v_exp_f32 v68, v68
  s_waitcnt lgkmcnt(4)
  v_mfma_f32_32x32x16_bf16 v[128:143], v[164:167], a[200:203], v[128:143]
  ds_read_b64_tr_b16 v[160:161], v192 offset:57344
  s_add_u32 s46, s72, 8192
  buffer_load_dwordx4 a[32:35], v194, s[20:23], s46 offen offset:0 sc1
  v_exp_f32 v69, v69
  v_exp_f32 v70, v70
  v_exp_f32 v71, v71
  v_fma_f32 v64, v217, v64, v217
  v_mfma_f32_32x32x16_bf16 v[144:159], v[164:167], a[204:207], v[144:159]
  ds_read_b64_tr_b16 v[162:163], v192 offset:57856
  buffer_load_dwordx4 a[36:39], v182, s[20:23], s46 offen offset:0 sc1
  v_fma_f32 v65, v217, v65, v217
  v_fma_f32 v66, v217, v66, v217
  v_fma_f32 v67, v217, v67, v217
  v_fma_f32 v68, v217, v68, v217
  v_fma_f32 v69, v217, v69, v217
  v_fma_f32 v70, v217, v70, v217
  s_waitcnt lgkmcnt(4)
  v_mfma_f32_32x32x16_bf16 v[128:143], v[168:171], a[208:211], v[128:143]
  ds_read_b64_tr_b16 v[164:165], v192 offset:59392
  buffer_load_dwordx4 a[40:43], v194, s[20:23], s46 offen offset:1024 sc1
  v_fma_f32 v71, v217, v71, v217
  v_rcp_f32 v64, v64
  v_rcp_f32 v65, v65
  v_rcp_f32 v66, v66
  v_mfma_f32_32x32x16_bf16 v[144:159], v[168:171], a[212:215], v[144:159]
  ds_read_b64_tr_b16 v[166:167], v192 offset:59904
  buffer_load_dwordx4 a[44:47], v182, s[20:23], s46 offen offset:1024 sc1
  v_rcp_f32 v67, v67
  v_rcp_f32 v68, v68
  v_rcp_f32 v69, v69
  v_rcp_f32 v70, v70
  s_waitcnt lgkmcnt(4)
  v_mfma_f32_32x32x16_bf16 v[128:143], v[172:175], a[216:219], v[128:143]
  ds_read_b64_tr_b16 v[168:169], v192 offset:61440
  buffer_load_dwordx4 a[48:51], v194, s[20:23], s46 offen offset:2048 sc1
  v_rcp_f32 v71, v71
  v_mul_f32 v112, v112, v64
  v_mul_f32 v113, v113, v65
  v_mul_f32 v114, v114, v66
  v_mul_f32 v115, v115, v67
  v_mul_f32 v116, v116, v68
  v_mul_f32 v117, v117, v69
  v_mfma_f32_32x32x16_bf16 v[144:159], v[172:175], a[220:223], v[144:159]
  ds_read_b64_tr_b16 v[170:171], v192 offset:61952
  v_mul_f32 v118, v118, v70
  v_mul_f32 v119, v119, v71
  v_mul_f32 v64, v215, v120
  v_mul_f32 v65, v215, v121
  v_mul_f32 v66, v215, v122
  v_mul_f32 v67, v215, v123
  v_mul_f32 v68, v215, v124
  v_mul_f32 v69, v215, v125
  v_mul_f32 v70, v215, v126
  s_waitcnt lgkmcnt(4)
  v_mfma_f32_32x32x16_bf16 v[128:143], v[160:163], a[224:227], v[128:143]
  ds_read_b64_tr_b16 v[172:173], v192 offset:63488
  buffer_load_dwordx4 a[52:55], v182, s[20:23], s46 offen offset:2048 sc1
  v_mul_f32 v71, v215, v127
  v_exp_f32 v64, v64
  v_exp_f32 v65, v65
  v_exp_f32 v66, v66
  v_mfma_f32_32x32x16_bf16 v[144:159], v[160:163], a[228:231], v[144:159]
  ds_read_b64_tr_b16 v[174:175], v192 offset:64000
  buffer_load_dwordx4 a[56:59], v194, s[20:23], s46 offen offset:3072 sc1
  v_exp_f32 v67, v67
  v_exp_f32 v68, v68
  v_exp_f32 v69, v69
  v_exp_f32 v70, v70
  s_waitcnt lgkmcnt(0)
  s_barrier
  v_mfma_f32_32x32x16_bf16 v[128:143], v[164:167], a[232:235], v[128:143]
  buffer_load_dwordx4 a[60:63], v182, s[20:23], s46 offen offset:3072 sc1
  v_exp_f32 v71, v71
  v_fma_f32 v64, v217, v64, v217
  v_fma_f32 v65, v217, v65, v217
  v_fma_f32 v66, v217, v66, v217
  v_fma_f32 v67, v217, v67, v217
  v_fma_f32 v68, v217, v68, v217
  v_mfma_f32_32x32x16_bf16 v[144:159], v[164:167], a[236:239], v[144:159]
  v_lshrrev_b32 v219, 4, v193
  v_and_b32 v220, 15, v193
  v_lshlrev_b32 v204, 10, v219
  v_lshl_add_u32 v204, v220, 3, v204
  v_lshlrev_b32 v205, 3, v219
  v_lshlrev_b32 v218, 3, v220
  v_add_u32 v218, s77, v218
  s_add_u32 s45, s75, 0
  buffer_load_dwordx2 v[32:33], v204, s[8:11], s45 offen
  s_add_u32 s45, s75, 4096
  buffer_load_dwordx2 v[34:35], v204, s[8:11], s45 offen
  s_add_u32 s45, s75, 8192
  buffer_load_dwordx2 v[36:37], v204, s[8:11], s45 offen
  s_add_u32 s45, s75, 12288
  buffer_load_dwordx2 v[38:39], v204, s[8:11], s45 offen
  buffer_load_dwordx2 v[40:41], v205, s[20:23], s76 offen offset:0 sc1
  buffer_load_dwordx2 v[42:43], v205, s[20:23], s76 offen offset:32 sc1
  buffer_load_dwordx2 v[44:45], v205, s[20:23], s76 offen offset:64 sc1
  buffer_load_dwordx2 v[46:47], v205, s[20:23], s76 offen offset:96 sc1
  global_load_dwordx2 v[48:49], v218, s[80:81]
  v_mfma_f32_32x32x16_bf16 v[128:143], v[168:171], a[240:243], v[128:143]
  v_fma_f32 v69, v217, v69, v217
  v_fma_f32 v70, v217, v70, v217
  v_fma_f32 v71, v217, v71, v217
  v_rcp_f32 v64, v64
  v_rcp_f32 v65, v65
  v_rcp_f32 v66, v66
  v_mfma_f32_32x32x16_bf16 v[144:159], v[168:171], a[244:247], v[144:159]
  v_rcp_f32 v67, v67
  v_rcp_f32 v68, v68
  v_rcp_f32 v69, v69
  v_rcp_f32 v70, v70
  v_rcp_f32 v71, v71
  v_mfma_f32_32x32x16_bf16 v[128:143], v[172:175], a[248:251], v[128:143]
  v_mul_f32 v120, v120, v64
  v_mul_f32 v121, v121, v65
  v_mul_f32 v122, v122, v66
  v_mul_f32 v123, v123, v67
  v_mul_f32 v124, v124, v68
  v_mul_f32 v125, v125, v69
  v_mul_f32 v126, v126, v70
  v_mul_f32 v127, v127, v71
  v_mfma_f32_32x32x16_bf16 v[144:159], v[172:175], a[252:255], v[144:159]
  v_add_u32 v180, 65536, v180
  ds_read_b64_tr_b16 v[160:161], v180 offset:0
  ds_read_b64_tr_b16 v[162:163], v180 offset:1024
  v_add_u32 v181, 65536, v181
  ds_read_b64_tr_b16 v[164:165], v181 offset:0
  ds_read_b64_tr_b16 v[166:167], v181 offset:1024
  s_waitcnt vmcnt(25) lgkmcnt(2)
  v_mfma_f32_32x32x16_bf16 a[128:143], v[160:163], a[0:3], 0
  ds_read_b64_tr_b16 v[168:169], v180 offset:2048
  s_add_u32 m0, s53, 32768
  s_add_u32 s47, s79, 0
  buffer_load_dwordx4 v196, s[68:71], s47 offen offset:0 lds
  v_and_b32 v246, 31, v193
  v_lshlrev_b32 v246, 3, v246
  s_lshl_b32 s48, s38, 8
  s_add_u32 s48, s48, 139008
  v_add_u32 v246, s48, v246
  ds_read_b64 v[244:245], v246
  v_mov_b32 v247, 0
  v_mov_b32 v246, 0
  s_waitcnt lgkmcnt(0)
  s_nop 0
  v_mfma_f32_32x32x16_bf16 v[128:143], v[244:247], v[206:209], v[128:143]
  s_waitcnt vmcnt(25)
  v_mfma_f32_32x32x16_bf16 a[144:159], v[160:163], a[4:7], 0
  ds_read_b64_tr_b16 v[170:171], v180 offset:3072
  buffer_load_dwordx4 v197, s[68:71], s47 offen offset:1024 lds
  v_mfma_f32_32x32x16_bf16 v[144:159], v[244:247], v[210:213], v[144:159]
  s_nop 6
  v_mul_f32 v128, v128, v96
  v_mul_f32 v129, v129, v97
  v_mul_f32 v130, v130, v98
  v_mul_f32 v131, v131, v99
  v_mul_f32 v132, v132, v100
  v_mfma_f32_32x32x16_bf16 a[160:175], v[164:167], a[0:3], 0
  ds_read_b64_tr_b16 v[172:173], v181 offset:2048
  buffer_load_dwordx4 v198, s[68:71], s47 offen offset:2048 lds
  v_mul_f32 v133, v133, v101
  v_mul_f32 v134, v134, v102
  v_mul_f32 v135, v135, v103
  v_cvt_pk_bf16_f32 v128, v128, v129
  v_cvt_pk_bf16_f32 v129, v130, v131
  v_cvt_pk_bf16_f32 v130, v132, v133
  v_cvt_pk_bf16_f32 v131, v134, v135
  s_add_u32 s97, s55, 4096
  buffer_store_dwordx4 v[128:131], v194, s[20:23], s97 offen offset:0 sc1
  v_mul_f32 v136, v136, v104
  v_mul_f32 v137, v137, v105
  v_mul_f32 v138, v138, v106
  v_mul_f32 v139, v139, v107
  v_mfma_f32_32x32x16_bf16 a[176:191], v[164:167], a[4:7], 0
  ds_read_b64_tr_b16 v[174:175], v181 offset:3072
  buffer_load_dwordx4 v199, s[68:71], s47 offen offset:3072 lds
  v_mul_f32 v140, v140, v108
  v_mul_f32 v141, v141, v109
  v_mul_f32 v142, v142, v110
  v_mul_f32 v143, v143, v111
  v_cvt_pk_bf16_f32 v136, v136, v137
  v_cvt_pk_bf16_f32 v137, v138, v139
  v_cvt_pk_bf16_f32 v138, v140, v141
  v_cvt_pk_bf16_f32 v139, v142, v143
  s_add_u32 s97, s55, 4096
  buffer_store_dwordx4 v[136:139], v194, s[20:23], s97 offen offset:1024 sc1
  v_mul_f32 v144, v144, v112
  v_mul_f32 v145, v145, v113
  v_mul_f32 v146, v146, v114
  s_waitcnt vmcnt(29) lgkmcnt(2)
  v_mfma_f32_32x32x16_bf16 a[128:143], v[168:171], a[8:11], a[128:143]
  ds_read_b64_tr_b16 v[160:161], v180 offset:4096
  s_add_u32 m0, s53, 36864
  s_add_u32 s47, s79, 32768
  buffer_load_dwordx4 v196, s[68:71], s47 offen offset:0 lds
  v_mul_f32 v147, v147, v115
  v_mul_f32 v148, v148, v116
  v_mul_f32 v149, v149, v117
  v_mul_f32 v150, v150, v118
  v_mul_f32 v151, v151, v119
  v_cvt_pk_bf16_f32 v144, v144, v145
  v_cvt_pk_bf16_f32 v145, v146, v147
  v_cvt_pk_bf16_f32 v146, v148, v149
  v_cvt_pk_bf16_f32 v147, v150, v151
  s_add_u32 s97, s55, 184320
  buffer_store_dwordx4 v[144:147], v194, s[20:23], s97 offen offset:0 sc1
  s_waitcnt vmcnt(30)
  v_mfma_f32_32x32x16_bf16 a[144:159], v[168:171], a[12:15], a[144:159]
  ds_read_b64_tr_b16 v[162:163], v180 offset:5120
  buffer_load_dwordx4 v197, s[68:71], s47 offen offset:1024 lds
  v_mul_f32 v152, v152, v120
  v_mul_f32 v153, v153, v121
  v_mul_f32 v154, v154, v122
  v_mul_f32 v155, v155, v123
  v_mul_f32 v156, v156, v124
  v_mul_f32 v157, v157, v125
  v_mul_f32 v158, v158, v126
  v_mul_f32 v159, v159, v127
  v_cvt_pk_bf16_f32 v152, v152, v153
  v_cvt_pk_bf16_f32 v153, v154, v155
  v_cvt_pk_bf16_f32 v154, v156, v157
  v_cvt_pk_bf16_f32 v155, v158, v159
  s_waitcnt lgkmcnt(2)
  v_mfma_f32_32x32x16_bf16 a[160:175], v[172:175], a[8:11], a[160:175]
  ds_read_b64_tr_b16 v[164:165], v181 offset:4096
  buffer_load_dwordx4 v198, s[68:71], s47 offen offset:2048 lds
  buffer_load_dwordx4 v199, s[68:71], s47 offen offset:3072 lds
  s_add_u32 s97, s55, 184320
  buffer_store_dwordx4 v[152:155], v194, s[20:23], s97 offen offset:1024 sc1
  v_mfma_f32_32x32x16_bf16 a[176:191], v[172:175], a[12:15], a[176:191]
  ds_read_b64_tr_b16 v[166:167], v181 offset:5120
  s_add_u32 s46, s72, 16384
  buffer_load_dwordx4 a[64:67], v194, s[20:23], s46 offen offset:0 sc1
  s_waitcnt vmcnt(33) lgkmcnt(2)
  v_mfma_f32_32x32x16_bf16 a[128:143], v[160:163], a[16:19], a[128:143]
  ds_read_b64_tr_b16 v[168:169], v180 offset:6144
  buffer_load_dwordx4 a[68:71], v182, s[20:23], s46 offen offset:0 sc1
  s_waitcnt vmcnt(33)
  v_mfma_f32_32x32x16_bf16 a[144:159], v[160:163], a[20:23], a[144:159]
  ds_read_b64_tr_b16 v[170:171], v180 offset:7168
  buffer_load_dwordx4 a[72:75], v194, s[20:23], s46 offen offset:1024 sc1
  s_waitcnt lgkmcnt(2)
  v_mfma_f32_32x32x16_bf16 a[160:175], v[164:167], a[16:19], a[160:175]
  ds_read_b64_tr_b16 v[172:173], v181 offset:6144
  buffer_load_dwordx4 a[76:79], v182, s[20:23], s46 offen offset:1024 sc1
  v_mfma_f32_32x32x16_bf16 a[176:191], v[164:167], a[20:23], a[176:191]
  ds_read_b64_tr_b16 v[174:175], v181 offset:7168
  buffer_load_dwordx4 a[80:83], v194, s[20:23], s46 offen offset:2048 sc1
  s_waitcnt vmcnt(35) lgkmcnt(2)
  v_mfma_f32_32x32x16_bf16 a[128:143], v[168:171], a[24:27], a[128:143]
  ds_read_b64_tr_b16 v[160:161], v180 offset:32768
  buffer_load_dwordx4 a[84:87], v182, s[20:23], s46 offen offset:2048 sc1
  s_waitcnt vmcnt(35)
  v_mfma_f32_32x32x16_bf16 a[144:159], v[168:171], a[28:31], a[144:159]
  ds_read_b64_tr_b16 v[162:163], v180 offset:33792
  buffer_load_dwordx4 a[88:91], v194, s[20:23], s46 offen offset:3072 sc1
  s_waitcnt lgkmcnt(2)
  v_mfma_f32_32x32x16_bf16 a[160:175], v[172:175], a[24:27], a[160:175]
  ds_read_b64_tr_b16 v[164:165], v181 offset:32768
  buffer_load_dwordx4 a[92:95], v182, s[20:23], s46 offen offset:3072 sc1
  v_mfma_f32_32x32x16_bf16 a[176:191], v[172:175], a[28:31], a[176:191]
  ds_read_b64_tr_b16 v[166:167], v181 offset:33792
  buffer_load_dword v253, v183, s[20:23], s74 offen sc1
  s_waitcnt vmcnt(37) lgkmcnt(2)
  v_mfma_f32_32x32x16_bf16 a[128:143], v[160:163], a[32:35], a[128:143]
  ds_read_b64_tr_b16 v[168:169], v180 offset:34816
  s_add_u32 m0, s53, 65536
  s_add_u32 s47, s79, 0
  buffer_load_dwordx4 v196, s[84:87], s47 offen offset:0 lds
  v_bfe_u32 v240, v193, 2, 1
  v_lshlrev_b32 v240, 4, v240
  v_and_b32 v241, 1, v193
  v_lshl_add_u32 v240, v241, 3, v240
  v_bfe_u32 v241, v193, 3, 2
  v_lshl_add_u32 v240, v241, 1, v240
  v_bfe_u32 v241, v193, 1, 1
  v_add_u32 v240, v240, v241
  v_bfe_u32 v241, v240, 3, 2
  v_lshlrev_b32 v241, 1, v241
  s_waitcnt vmcnt(37)
  v_mfma_f32_32x32x16_bf16 a[144:159], v[160:163], a[36:39], a[144:159]
  ds_read_b64_tr_b16 v[170:171], v180 offset:35840
  buffer_load_dwordx4 v197, s[84:87], s47 offen offset:1024 lds
  v_and_b32 v242, 7, v240
  v_xor_b32 v242, v242, v241
  v_lshrrev_b32 v243, 5, v193
  v_xor_b32 v242, v242, v243
  v_lshlrev_b32 v240, 8, v240
  v_lshl_add_u32 v240, v242, 4, v240
  s_add_u32 s48, s53, 65536
  v_add_u32 v89, s48, v240
  v_and_b32 v240, 31, v193
  v_bfe_u32 v241, v240, 3, 2
  v_lshlrev_b32 v241, 1, v241
  v_and_b32 v242, 7, v240
  v_xor_b32 v242, v242, v241
  s_waitcnt lgkmcnt(2)
  v_mfma_f32_32x32x16_bf16 a[160:175], v[164:167], a[32:35], a[160:175]
  ds_read_b64_tr_b16 v[172:173], v181 offset:34816
  buffer_load_dwordx4 v198, s[84:87], s47 offen offset:2048 lds
  v_xor_b32 v242, v242, v243
  v_lshlrev_b32 v240, 8, v240
  v_lshl_add_u32 v240, v242, 4, v240
  s_add_u32 s48, s53, 0
  v_add_u32 v88, s48, v240
  v_add_u32 v96, 131072, v88
  v_lshrrev_b32 v241, 4, v193
  v_and_b32 v242, 15, v193
  v_xor_b32 v240, v241, v242
  s_lshl_b32 s48, s37, 2
  v_xor_b32 v240, s48, v240
  v_lshlrev_b32 v240, 4, v240
  v_lshl_add_u32 v240, v241, 8, v240
  v_mfma_f32_32x32x16_bf16 a[176:191], v[164:167], a[36:39], a[176:191]
  ds_read_b64_tr_b16 v[174:175], v181 offset:35840
  buffer_load_dwordx4 v199, s[84:87], s47 offen offset:3072 lds
  s_add_u32 m0, s53, 69632
  s_add_u32 s47, s79, 32768
  buffer_load_dwordx4 v196, s[84:87], s47 offen offset:0 lds
  s_lshl_b32 s48, s37, 12
  s_mul_i32 s49, s38, 131072
  s_add_u32 s48, s48, s49
  s_add_u32 s48, s48, 0
  v_add_u32 v90, s48, v240
  v_xor_b32 v91, 64, v90
  v_xor_b32 v92, 32, v90
  v_xor_b32 v93, 96, v90
  v_lshlrev_b32 v95, 11, v241
  v_lshl_add_u32 v95, v242, 4, v95
  v_lshlrev_b32 v94, 10, v241
  s_waitcnt vmcnt(40) lgkmcnt(2)
  v_mfma_f32_32x32x16_bf16 a[128:143], v[168:171], a[40:43], a[128:143]
  ds_read_b64_tr_b16 v[160:161], v180 offset:36864
  buffer_load_dwordx4 v197, s[84:87], s47 offen offset:1024 lds
  v_lshl_add_u32 v94, v242, 3, v94
  v_lshlrev_b32 v50, 3, v241
  v_lshlrev_b32 v51, 3, v242
  v_add_u32 v51, s77, v51
  s_waitcnt vmcnt(40)
  v_mfma_f32_32x32x16_bf16 a[144:159], v[168:171], a[44:47], a[144:159]
  ds_read_b64_tr_b16 v[162:163], v180 offset:37888
  buffer_load_dwordx4 v198, s[84:87], s47 offen offset:2048 lds
  s_waitcnt lgkmcnt(2)
  v_mfma_f32_32x32x16_bf16 a[160:175], v[172:175], a[40:43], a[160:175]
  ds_read_b64_tr_b16 v[164:165], v181 offset:36864
  buffer_load_dwordx4 v199, s[84:87], s47 offen offset:3072 lds
  v_mfma_f32_32x32x16_bf16 a[176:191], v[172:175], a[44:47], a[176:191]
  ds_read_b64_tr_b16 v[166:167], v181 offset:37888
  s_waitcnt vmcnt(8)
  v_cmp_eq_u32 vcc, s36, v253
  s_nop 0
  s_and_b32 s45, vcc_lo, 0xff00
  s_cmp_eq_u32 s45, 0xff00
  s_cbranch_scc0 FZH_pslow12
FZH_pret13:
  s_waitcnt lgkmcnt(2)
  v_mfma_f32_32x32x16_bf16 a[128:143], v[160:163], a[48:51], a[128:143]
  ds_read_b64_tr_b16 v[168:169], v180 offset:38912
  v_mfma_f32_32x32x16_bf16 a[144:159], v[160:163], a[52:55], a[144:159]
  ds_read_b64_tr_b16 v[170:171], v180 offset:39936
  s_add_u32 s46, s73, 0
  buffer_load_dwordx4 a[96:99], v194, s[20:23], s46 offen offset:0 sc1
  s_waitcnt lgkmcnt(2)
  v_mfma_f32_32x32x16_bf16 a[160:175], v[164:167], a[48:51], a[160:175]
  ds_read_b64_tr_b16 v[172:173], v181 offset:38912
  buffer_load_dwordx4 a[100:103], v182, s[20:23], s46 offen offset:0 sc1
  v_mfma_f32_32x32x16_bf16 a[176:191], v[164:167], a[52:55], a[176:191]
  ds_read_b64_tr_b16 v[174:175], v181 offset:39936
  buffer_load_dwordx4 a[104:107], v194, s[20:23], s46 offen offset:1024 sc1
  buffer_load_dwordx4 a[108:111], v182, s[20:23], s46 offen offset:1024 sc1
  s_waitcnt lgkmcnt(2)
  v_mfma_f32_32x32x16_bf16 a[128:143], v[168:171], a[56:59], a[128:143]
  v_subrev_u32 v180, 65536, v180
  ds_read_b64_tr_b16 v[160:161], v180 offset:0
  buffer_load_dwordx4 a[112:115], v194, s[20:23], s46 offen offset:2048 sc1
  v_mfma_f32_32x32x16_bf16 a[144:159], v[168:171], a[60:63], a[144:159]
  ds_read_b64_tr_b16 v[162:163], v180 offset:1024
  buffer_load_dwordx4 a[116:119], v182, s[20:23], s46 offen offset:2048 sc1
  s_waitcnt lgkmcnt(2)
  v_mfma_f32_32x32x16_bf16 a[160:175], v[172:175], a[56:59], a[160:175]
  v_subrev_u32 v181, 65536, v181
  ds_read_b64_tr_b16 v[164:165], v181 offset:0
  buffer_load_dwordx4 a[120:123], v194, s[20:23], s46 offen offset:3072 sc1
  v_mfma_f32_32x32x16_bf16 a[176:191], v[172:175], a[60:63], a[176:191]
  ds_read_b64_tr_b16 v[166:167], v181 offset:1024
  buffer_load_dwordx4 a[124:127], v182, s[20:23], s46 offen offset:3072 sc1
  s_waitcnt lgkmcnt(0)
  s_barrier
  v_mfma_f32_32x32x16_bf16 a[128:143], v[160:163], a[64:67], a[128:143]
  ds_read_b64_tr_b16 v[168:169], v180 offset:2048
  s_add_u32 m0, s53, 98304
  s_add_u32 s47, s79, 128
  buffer_load_dwordx4 v196, s[68:71], s47 offen offset:0 lds
  v_mfma_f32_32x32x16_bf16 a[144:159], v[160:163], a[68:71], a[144:159]
  ds_read_b64_tr_b16 v[170:171], v180 offset:3072
  buffer_load_dwordx4 v197, s[68:71], s47 offen offset:1024 lds
  v_mfma_f32_32x32x16_bf16 a[160:175], v[164:167], a[64:67], a[160:175]
  ds_read_b64_tr_b16 v[172:173], v181 offset:2048
  buffer_load_dwordx4 v198, s[68:71], s47 offen offset:2048 lds
  v_mfma_f32_32x32x16_bf16 a[176:191], v[164:167], a[68:71], a[176:191]
  ds_read_b64_tr_b16 v[174:175], v181 offset:3072
  buffer_load_dwordx4 v199, s[68:71], s47 offen offset:3072 lds
  s_waitcnt lgkmcnt(2)
  v_mfma_f32_32x32x16_bf16 a[128:143], v[168:171], a[72:75], a[128:143]
  ds_read_b64_tr_b16 v[160:161], v180 offset:4096
  s_add_u32 m0, s53, 102400
  s_add_u32 s47, s79, 32896
  buffer_load_dwordx4 v196, s[68:71], s47 offen offset:0 lds
  v_mfma_f32_32x32x16_bf16 a[144:159], v[168:171], a[76:79], a[144:159]
  ds_read_b64_tr_b16 v[162:163], v180 offset:5120
  buffer_load_dwordx4 v197, s[68:71], s47 offen offset:1024 lds
  s_waitcnt lgkmcnt(2)
  v_mfma_f32_32x32x16_bf16 a[160:175], v[172:175], a[72:75], a[160:175]
  ds_read_b64_tr_b16 v[164:165], v181 offset:4096
  buffer_load_dwordx4 v198, s[68:71], s47 offen offset:2048 lds
  v_mfma_f32_32x32x16_bf16 a[176:191], v[172:175], a[76:79], a[176:191]
  ds_read_b64_tr_b16 v[166:167], v181 offset:5120
  buffer_load_dwordx4 v199, s[68:71], s47 offen offset:3072 lds
  s_waitcnt lgkmcnt(2)
  v_mfma_f32_32x32x16_bf16 a[128:143], v[160:163], a[80:83], a[128:143]
  ds_read_b64_tr_b16 v[168:169], v180 offset:6144
  s_add_u32 s46, s73, 4096
  buffer_load_dwordx4 a[0:3], v194, s[20:23], s46 offen offset:0 sc1
  v_mfma_f32_32x32x16_bf16 a[144:159], v[160:163], a[84:87], a[144:159]
  ds_read_b64_tr_b16 v[170:171], v180 offset:7168
  buffer_load_dwordx4 a[4:7], v182, s[20:23], s46 offen offset:0 sc1
  s_waitcnt lgkmcnt(2)
  v_mfma_f32_32x32x16_bf16 a[160:175], v[164:167], a[80:83], a[160:175]
  ds_read_b64_tr_b16 v[172:173], v181 offset:6144
  buffer_load_dwordx4 a[8:11], v194, s[20:23], s46 offen offset:1024 sc1
  v_mfma_f32_32x32x16_bf16 a[176:191], v[164:167], a[84:87], a[176:191]
  ds_read_b64_tr_b16 v[174:175], v181 offset:7168
  buffer_load_dwordx4 a[12:15], v182, s[20:23], s46 offen offset:1024 sc1
  s_waitcnt lgkmcnt(2)
  v_mfma_f32_32x32x16_bf16 a[128:143], v[168:171], a[88:91], a[128:143]
  ds_read_b128 v[160:163], v184 offset:32768
  buffer_load_dwordx4 a[16:19], v194, s[20:23], s46 offen offset:2048 sc1
  v_mfma_f32_32x32x16_bf16 a[144:159], v[168:171], a[92:95], a[144:159]
  ds_read_b128 v[164:167], v184 offset:36864
  buffer_load_dwordx4 a[20:23], v182, s[20:23], s46 offen offset:2048 sc1
  s_waitcnt lgkmcnt(2)
  v_mfma_f32_32x32x16_bf16 a[160:175], v[172:175], a[88:91], a[160:175]
  buffer_load_dwordx4 a[24:27], v194, s[20:23], s46 offen offset:3072 sc1
  v_mfma_f32_32x32x16_bf16 a[176:191], v[172:175], a[92:95], a[176:191]
  buffer_load_dwordx4 a[28:31], v182, s[20:23], s46 offen offset:3072 sc1
  s_waitcnt vmcnt(23) lgkmcnt(1)
  v_mfma_f32_32x32x16_bf16 a[192:207], v[160:163], a[96:99], 0
  ds_read_b128 v[168:171], v185 offset:32768
  buffer_store_dword v252, v229, s[20:23], s100 offen offset:64 sc1
  s_waitcnt vmcnt(23)
  v_mfma_f32_32x32x16_bf16 a[208:223], v[160:163], a[100:103], 0
  ds_read_b128 v[172:175], v185 offset:36864
  s_add_u32 m0, s53, 0
  s_add_u32 s47, s79, 128
  buffer_load_dwordx4 v196, s[84:87], s47 offen offset:0 lds
  s_waitcnt lgkmcnt(2)
  v_mfma_f32_32x32x16_bf16 a[224:239], v[164:167], a[96:99], 0
  buffer_load_dwordx4 v197, s[84:87], s47 offen offset:1024 lds
  v_mfma_f32_32x32x16_bf16 a[240:255], v[164:167], a[100:103], 0
  buffer_load_dwordx4 v198, s[84:87], s47 offen offset:2048 lds
  s_waitcnt vmcnt(25) lgkmcnt(1)
  v_mfma_f32_32x32x16_bf16 a[192:207], v[168:171], a[104:107], a[192:207]
  ds_read_b128 v[160:163], v186 offset:32768
  buffer_load_dwordx4 v199, s[84:87], s47 offen offset:3072 lds
  s_waitcnt vmcnt(25)
  v_mfma_f32_32x32x16_bf16 a[208:223], v[168:171], a[108:111], a[208:223]
  ds_read_b128 v[164:167], v186 offset:36864
  s_add_u32 m0, s53, 4096
  s_add_u32 s47, s79, 32896
  buffer_load_dwordx4 v196, s[84:87], s47 offen offset:0 lds
  s_waitcnt lgkmcnt(2)
  v_mfma_f32_32x32x16_bf16 a[224:239], v[172:175], a[104:107], a[224:239]
  buffer_load_dwordx4 v197, s[84:87], s47 offen offset:1024 lds
  buffer_load_dwordx4 v198, s[84:87], s47 offen offset:2048 lds
  v_mfma_f32_32x32x16_bf16 a[240:255], v[172:175], a[108:111], a[240:255]
  buffer_load_dwordx4 v199, s[84:87], s47 offen offset:3072 lds
  s_waitcnt vmcnt(28) lgkmcnt(1)
  v_mfma_f32_32x32x16_bf16 a[192:207], v[160:163], a[112:115], a[192:207]
  ds_read_b128 v[168:171], v187 offset:32768
  s_add_u32 s46, s73, 8192
  buffer_load_dwordx4 a[32:35], v194, s[20:23], s46 offen offset:0 sc1
  s_waitcnt vmcnt(28)
  v_mfma_f32_32x32x16_bf16 a[208:223], v[160:163], a[116:119], a[208:223]
  ds_read_b128 v[172:175], v187 offset:36864
  buffer_load_dwordx4 a[36:39], v182, s[20:23], s46 offen offset:0 sc1
  s_waitcnt lgkmcnt(2)
  v_mfma_f32_32x32x16_bf16 a[224:239], v[164:167], a[112:115], a[224:239]
  buffer_load_dwordx4 a[40:43], v194, s[20:23], s46 offen offset:1024 sc1
  v_mfma_f32_32x32x16_bf16 a[240:255], v[164:167], a[116:119], a[240:255]
  buffer_load_dwordx4 a[44:47], v182, s[20:23], s46 offen offset:1024 sc1
  s_waitcnt vmcnt(30) lgkmcnt(1)
  v_mfma_f32_32x32x16_bf16 a[192:207], v[168:171], a[120:123], a[192:207]
  v_add_u32 v184, 65536, v184
  ds_read_b128 v[160:163], v184 offset:0
  buffer_load_dwordx4 a[48:51], v194, s[20:23], s46 offen offset:2048 sc1
  s_waitcnt vmcnt(30)
  v_mfma_f32_32x32x16_bf16 a[208:223], v[168:171], a[124:127], a[208:223]
  ds_read_b128 v[164:167], v184 offset:4096
  buffer_load_dwordx4 a[52:55], v182, s[20:23], s46 offen offset:2048 sc1
  s_waitcnt lgkmcnt(2)
  v_mfma_f32_32x32x16_bf16 a[224:239], v[172:175], a[120:123], a[224:239]
  buffer_load_dwordx4 a[56:59], v194, s[20:23], s46 offen offset:3072 sc1
  v_mfma_f32_32x32x16_bf16 a[240:255], v[172:175], a[124:127], a[240:255]
  buffer_load_dwordx4 a[60:63], v182, s[20:23], s46 offen offset:3072 sc1
  s_waitcnt vmcnt(24) lgkmcnt(1)
  v_mfma_f32_32x32x16_bf16 a[192:207], v[160:163], a[0:3], a[192:207]
  v_add_u32 v185, 65536, v185
  ds_read_b128 v[168:171], v185 offset:0
  s_add_u32 m0, s53, 32768
  s_add_u32 s47, s78, 393216
  buffer_load_dwordx4 v176, s[64:67], s47 offen offset:0 lds
  v_lshlrev_b32 v52, 16, v48
  v_and_b32 v53, 0xffff0000, v48
  v_lshlrev_b32 v54, 16, v49
  s_waitcnt vmcnt(24)
  v_mfma_f32_32x32x16_bf16 a[208:223], v[160:163], a[4:7], a[208:223]
  ds_read_b128 v[172:175], v185 offset:4096
  buffer_load_dwordx4 v177, s[64:67], s47 offen offset:1024 lds
  v_and_b32 v55, 0xffff0000, v49
  v_lshlrev_b32 v41, 16, v40
  v_rcp_f32 v41, v41
  v_and_b32 v40, 0xffff0000, v40
  s_waitcnt lgkmcnt(2)
  v_mfma_f32_32x32x16_bf16 a[224:239], v[164:167], a[0:3], a[224:239]
  buffer_load_dwordx4 v178, s[64:67], s47 offen offset:2048 lds
  v_lshlrev_b32 v56, 16, v32
  v_and_b32 v57, 0xffff0000, v32
  v_lshlrev_b32 v58, 16, v33
  v_and_b32 v59, 0xffff0000, v33
  v_sub_f32 v72, v56, v40
  v_sub_f32 v73, v57, v40
  v_mfma_f32_32x32x16_bf16 a[240:255], v[164:167], a[4:7], a[240:255]
  buffer_load_dwordx4 v179, s[64:67], s47 offen offset:3072 lds
  v_sub_f32 v74, v58, v40
  v_sub_f32 v75, v59, v40
  v_mul_f32 v72, v72, v41
  v_mul_f32 v73, v73, v41
  v_mul_f32 v74, v74, v41
  v_mul_f32 v75, v75, v41
  v_mul_f32 v72, v72, v52
  s_waitcnt vmcnt(26) lgkmcnt(1)
  v_mfma_f32_32x32x16_bf16 a[192:207], v[168:171], a[8:11], a[192:207]
  v_add_u32 v186, 65536, v186
  ds_read_b128 v[160:163], v186 offset:0
  s_add_u32 m0, s53, 36864
  s_add_u32 s47, s78, 425984
  buffer_load_dwordx4 v176, s[64:67], s47 offen offset:0 lds
  v_mul_f32 v73, v73, v53
  v_mul_f32 v74, v74, v54
  v_mul_f32 v75, v75, v55
  s_waitcnt vmcnt(26)
  v_mfma_f32_32x32x16_bf16 a[208:223], v[168:171], a[12:15], a[208:223]
  ds_read_b128 v[164:167], v186 offset:4096
  buffer_load_dwordx4 v177, s[64:67], s47 offen offset:1024 lds
  v_lshlrev_b32 v43, 16, v42
  v_rcp_f32 v43, v43
  v_and_b32 v42, 0xffff0000, v42
  v_lshlrev_b32 v60, 16, v34
  s_waitcnt lgkmcnt(2)
  v_mfma_f32_32x32x16_bf16 a[224:239], v[172:175], a[8:11], a[224:239]
  buffer_load_dwordx4 v178, s[64:67], s47 offen offset:2048 lds
  v_and_b32 v61, 0xffff0000, v34
  v_lshlrev_b32 v62, 16, v35
  v_and_b32 v63, 0xffff0000, v35
  v_sub_f32 v76, v60, v42
  v_sub_f32 v77, v61, v42
  v_sub_f32 v78, v62, v42
  v_mfma_f32_32x32x16_bf16 a[240:255], v[172:175], a[12:15], a[240:255]
  buffer_load_dwordx4 v179, s[64:67], s47 offen offset:3072 lds
  v_sub_f32 v79, v63, v42
  v_mul_f32 v76, v76, v43
  v_mul_f32 v77, v77, v43
  v_mul_f32 v78, v78, v43
  v_mul_f32 v79, v79, v43
  v_mul_f32 v76, v76, v52
  v_mul_f32 v77, v77, v53
  s_waitcnt vmcnt(28) lgkmcnt(1)
  v_mfma_f32_32x32x16_bf16 a[192:207], v[160:163], a[16:19], a[192:207]
  v_add_u32 v187, 65536, v187
  ds_read_b128 v[168:171], v187 offset:0
  s_add_u32 s46, s73, 12288
  buffer_load_dwordx4 a[64:67], v194, s[20:23], s46 offen offset:0 sc1
  v_mul_f32 v78, v78, v54
  v_mul_f32 v79, v79, v55
  v_lshlrev_b32 v45, 16, v44
  s_waitcnt vmcnt(28)
  v_mfma_f32_32x32x16_bf16 a[208:223], v[160:163], a[20:23], a[208:223]
  ds_read_b128 v[172:175], v187 offset:4096
  buffer_load_dwordx4 a[68:71], v182, s[20:23], s46 offen offset:0 sc1
  v_rcp_f32 v45, v45
  v_and_b32 v44, 0xffff0000, v44
  v_lshlrev_b32 v64, 16, v36
  v_and_b32 v65, 0xffff0000, v36
  s_waitcnt lgkmcnt(2)
  v_mfma_f32_32x32x16_bf16 a[224:239], v[164:167], a[16:19], a[224:239]
  buffer_load_dwordx4 a[72:75], v194, s[20:23], s46 offen offset:1024 sc1
  v_lshlrev_b32 v66, 16, v37
  v_and_b32 v67, 0xffff0000, v37
  v_sub_f32 v80, v64, v44
  v_sub_f32 v81, v65, v44
  v_sub_f32 v82, v66, v44
  v_sub_f32 v83, v67, v44
  v_mul_f32 v80, v80, v45
  v_mfma_f32_32x32x16_bf16 a[240:255], v[164:167], a[20:23], a[240:255]
  buffer_load_dwordx4 a[76:79], v182, s[20:23], s46 offen offset:1024 sc1
  v_mul_f32 v81, v81, v45
  v_mul_f32 v82, v82, v45
  v_mul_f32 v83, v83, v45
  v_mul_f32 v80, v80, v52
  v_mul_f32 v81, v81, v53
  v_mul_f32 v82, v82, v54
  v_mul_f32 v83, v83, v55
  s_waitcnt vmcnt(30) lgkmcnt(1)
  v_mfma_f32_32x32x16_bf16 a[192:207], v[168:171], a[24:27], a[192:207]
  ds_read_b128 v[160:163], v184 offset:32768
  buffer_load_dwordx4 a[80:83], v194, s[20:23], s46 offen offset:2048 sc1
  v_lshlrev_b32 v47, 16, v46
  v_rcp_f32 v47, v47
  v_and_b32 v46, 0xffff0000, v46
  v_lshlrev_b32 v68, 16, v38
  s_waitcnt vmcnt(30)
  v_mfma_f32_32x32x16_bf16 a[208:223], v[168:171], a[28:31], a[208:223]
  ds_read_b128 v[164:167], v184 offset:36864
  buffer_load_dwordx4 a[84:87], v182, s[20:23], s46 offen offset:2048 sc1
  v_and_b32 v69, 0xffff0000, v38
  v_lshlrev_b32 v70, 16, v39
  v_and_b32 v71, 0xffff0000, v39
  v_sub_f32 v84, v68, v46
  v_sub_f32 v85, v69, v46
  s_waitcnt lgkmcnt(2)
  v_mfma_f32_32x32x16_bf16 a[224:239], v[172:175], a[24:27], a[224:239]
  buffer_load_dwordx4 a[88:91], v194, s[20:23], s46 offen offset:3072 sc1
  v_sub_f32 v86, v70, v46
  v_sub_f32 v87, v71, v46
  v_mul_f32 v84, v84, v47
  v_mul_f32 v85, v85, v47
  v_mul_f32 v86, v86, v47
  v_mul_f32 v87, v87, v47
  v_mul_f32 v84, v84, v52
  v_mfma_f32_32x32x16_bf16 a[240:255], v[172:175], a[28:31], a[240:255]
  buffer_load_dwordx4 a[92:95], v182, s[20:23], s46 offen offset:3072 sc1
  v_mul_f32 v85, v85, v53
  v_mul_f32 v86, v86, v54
  v_mul_f32 v87, v87, v55
  s_waitcnt vmcnt(23) lgkmcnt(1)
  v_mfma_f32_32x32x16_bf16 a[192:207], v[160:163], a[32:35], a[192:207]
  ds_read_b128 v[168:171], v185 offset:32768
  s_add_u32 m0, s53, 65536
  s_add_u32 s47, s78, 65536
  buffer_load_dwordx4 v176, s[64:67], s47 offen offset:0 lds
  s_waitcnt vmcnt(23)
  v_mfma_f32_32x32x16_bf16 a[208:223], v[160:163], a[36:39], a[208:223]
  ds_read_b128 v[172:175], v185 offset:36864
  buffer_load_dwordx4 v177, s[64:67], s47 offen offset:1024 lds
  s_waitcnt lgkmcnt(2)
  v_mfma_f32_32x32x16_bf16 a[224:239], v[164:167], a[32:35], a[224:239]
  buffer_load_dwordx4 v178, s[64:67], s47 offen offset:2048 lds
  v_mfma_f32_32x32x16_bf16 a[240:255], v[164:167], a[36:39], a[240:255]
  buffer_load_dwordx4 v179, s[64:67], s47 offen offset:3072 lds
  s_waitcnt vmcnt(25) lgkmcnt(1)
  v_mfma_f32_32x32x16_bf16 a[192:207], v[168:171], a[40:43], a[192:207]
  ds_read_b128 v[160:163], v186 offset:32768
  s_add_u32 m0, s53, 69632
  s_add_u32 s47, s78, 98304
  buffer_load_dwordx4 v176, s[64:67], s47 offen offset:0 lds
  s_waitcnt vmcnt(25)
  v_mfma_f32_32x32x16_bf16 a[208:223], v[168:171], a[44:47], a[208:223]
  ds_read_b128 v[164:167], v186 offset:36864
  buffer_load_dwordx4 v177, s[64:67], s47 offen offset:1024 lds
  s_waitcnt lgkmcnt(2)
  v_mfma_f32_32x32x16_bf16 a[224:239], v[172:175], a[40:43], a[224:239]
  buffer_load_dwordx4 v178, s[64:67], s47 offen offset:2048 lds
  buffer_load_dwordx4 v179, s[64:67], s47 offen offset:3072 lds
  v_mfma_f32_32x32x16_bf16 a[240:255], v[172:175], a[44:47], a[240:255]
  s_add_u32 s46, s72, 24576
  buffer_load_dwordx4 a[96:99], v194, s[20:23], s46 offen offset:0 sc1
  s_waitcnt vmcnt(28) lgkmcnt(1)
  v_mfma_f32_32x32x16_bf16 a[192:207], v[160:163], a[48:51], a[192:207]
  ds_read_b128 v[168:171], v187 offset:32768
  buffer_load_dwordx4 a[100:103], v182, s[20:23], s46 offen offset:0 sc1
  s_waitcnt vmcnt(28)
  v_mfma_f32_32x32x16_bf16 a[208:223], v[160:163], a[52:55], a[208:223]
  ds_read_b128 v[172:175], v187 offset:36864
  buffer_load_dwordx4 a[104:107], v194, s[20:23], s46 offen offset:1024 sc1
  s_waitcnt lgkmcnt(2)
  v_mfma_f32_32x32x16_bf16 a[224:239], v[164:167], a[48:51], a[224:239]
  buffer_load_dwordx4 a[108:111], v182, s[20:23], s46 offen offset:1024 sc1
  v_mfma_f32_32x32x16_bf16 a[240:255], v[164:167], a[52:55], a[240:255]
  buffer_load_dwordx4 a[112:115], v194, s[20:23], s46 offen offset:2048 sc1
  s_waitcnt vmcnt(30) lgkmcnt(1)
  v_mfma_f32_32x32x16_bf16 a[192:207], v[168:171], a[56:59], a[192:207]
  v_subrev_u32 v184, 65536, v184
  ds_read_b128 v[160:163], v184 offset:0
  buffer_load_dwordx4 a[116:119], v182, s[20:23], s46 offen offset:2048 sc1
  s_waitcnt vmcnt(30)
  v_mfma_f32_32x32x16_bf16 a[208:223], v[168:171], a[60:63], a[208:223]
  ds_read_b128 v[164:167], v184 offset:4096
  buffer_load_dwordx4 a[120:123], v194, s[20:23], s46 offen offset:3072 sc1
  s_waitcnt lgkmcnt(2)
  v_mfma_f32_32x32x16_bf16 a[224:239], v[172:175], a[56:59], a[224:239]
  buffer_load_dwordx4 a[124:127], v182, s[20:23], s46 offen offset:3072 sc1
  v_mfma_f32_32x32x16_bf16 a[240:255], v[172:175], a[60:63], a[240:255]
  buffer_load_dword v253, v183, s[20:23], s74 offen sc1
  s_waitcnt vmcnt(24) lgkmcnt(1)
  v_mfma_f32_32x32x16_bf16 a[192:207], v[160:163], a[64:67], a[192:207]
  v_subrev_u32 v185, 65536, v185
  ds_read_b128 v[168:171], v185 offset:0
  s_add_u32 m0, s53, 98304
  s_add_u32 s47, s78, 196608
  buffer_load_dwordx4 v176, s[64:67], s47 offen offset:0 lds
  s_waitcnt vmcnt(24)
  v_mfma_f32_32x32x16_bf16 a[208:223], v[160:163], a[68:71], a[208:223]
  ds_read_b128 v[172:175], v185 offset:4096
  buffer_load_dwordx4 v177, s[64:67], s47 offen offset:1024 lds
  s_waitcnt lgkmcnt(2)
  v_mfma_f32_32x32x16_bf16 a[224:239], v[164:167], a[64:67], a[224:239]
  buffer_load_dwordx4 v178, s[64:67], s47 offen offset:2048 lds
  v_mfma_f32_32x32x16_bf16 a[240:255], v[164:167], a[68:71], a[240:255]
  buffer_load_dwordx4 v179, s[64:67], s47 offen offset:3072 lds
  s_add_u32 m0, s53, 102400
  s_add_u32 s47, s78, 229376
  buffer_load_dwordx4 v176, s[64:67], s47 offen offset:0 lds
  s_waitcnt vmcnt(27) lgkmcnt(1)
  v_mfma_f32_32x32x16_bf16 a[192:207], v[168:171], a[72:75], a[192:207]
  v_subrev_u32 v186, 65536, v186
  ds_read_b128 v[160:163], v186 offset:0
  buffer_load_dwordx4 v177, s[64:67], s47 offen offset:1024 lds
  s_waitcnt vmcnt(27)
  v_mfma_f32_32x32x16_bf16 a[208:223], v[168:171], a[76:79], a[208:223]
  ds_read_b128 v[164:167], v186 offset:4096
  buffer_load_dwordx4 v178, s[64:67], s47 offen offset:2048 lds
  s_waitcnt lgkmcnt(2)
  v_mfma_f32_32x32x16_bf16 a[224:239], v[172:175], a[72:75], a[224:239]
  buffer_load_dwordx4 v179, s[64:67], s47 offen offset:3072 lds
  v_mfma_f32_32x32x16_bf16 a[240:255], v[172:175], a[76:79], a[240:255]
  s_waitcnt vmcnt(8)
  v_cmp_eq_u32 vcc, s36, v253
  s_nop 0
  s_and_b32 s45, vcc_lo, 0x3f0000
  s_cmp_eq_u32 s45, 0x3f0000
  s_cbranch_scc0 FZH_pslow14
FZH_pret15:
  s_waitcnt lgkmcnt(1)
  v_mfma_f32_32x32x16_bf16 a[192:207], v[160:163], a[80:83], a[192:207]
  v_subrev_u32 v187, 65536, v187
  ds_read_b128 v[168:171], v187 offset:0
  v_mfma_f32_32x32x16_bf16 a[208:223], v[160:163], a[84:87], a[208:223]
  ds_read_b128 v[172:175], v187 offset:4096
  s_add_u32 s46, s72, 4096
  buffer_load_dwordx4 a[0:3], v194, s[20:23], s46 offen offset:0 sc1
  s_waitcnt lgkmcnt(2)
  v_mfma_f32_32x32x16_bf16 a[224:239], v[164:167], a[80:83], a[224:239]
  buffer_load_dwordx4 a[4:7], v182, s[20:23], s46 offen offset:0 sc1
  v_mfma_f32_32x32x16_bf16 a[240:255], v[164:167], a[84:87], a[240:255]
  buffer_load_dwordx4 a[8:11], v194, s[20:23], s46 offen offset:1024 sc1
  buffer_load_dwordx4 a[12:15], v182, s[20:23], s46 offen offset:1024 sc1
  s_waitcnt lgkmcnt(1)
  v_mfma_f32_32x32x16_bf16 a[192:207], v[168:171], a[88:91], a[192:207]
  ds_read_b64_tr_b16 v[160:161], v180 offset:32768
  buffer_load_dwordx4 a[16:19], v194, s[20:23], s46 offen offset:2048 sc1
  v_mfma_f32_32x32x16_bf16 a[208:223], v[168:171], a[92:95], a[208:223]
  ds_read_b64_tr_b16 v[162:163], v180 offset:33792
  buffer_load_dwordx4 a[20:23], v182, s[20:23], s46 offen offset:2048 sc1
  s_waitcnt lgkmcnt(2)
  v_mfma_f32_32x32x16_bf16 a[224:239], v[172:175], a[88:91], a[224:239]
  ds_read_b64_tr_b16 v[164:165], v181 offset:32768
  buffer_load_dwordx4 a[24:27], v194, s[20:23], s46 offen offset:3072 sc1
  v_mfma_f32_32x32x16_bf16 a[240:255], v[172:175], a[92:95], a[240:255]
  ds_read_b64_tr_b16 v[166:167], v181 offset:33792
  buffer_load_dwordx4 a[28:31], v182, s[20:23], s46 offen offset:3072 sc1
  s_waitcnt lgkmcnt(2)
  v_mfma_f32_32x32x16_bf16 a[128:143], v[160:163], a[96:99], a[128:143]
  ds_read_b64_tr_b16 v[168:169], v180 offset:34816
  s_add_u32 s46, s72, 12288
  buffer_load_dwordx4 a[32:35], v194, s[20:23], s46 offen offset:0 sc1
  ds_write_b128 v88, a[192:195] offset:0
  v_mfma_f32_32x32x16_bf16 a[144:159], v[160:163], a[100:103], a[144:159]
  ds_read_b64_tr_b16 v[170:171], v180 offset:35840
  ds_write_b128 v96, a[208:211]
  s_waitcnt lgkmcnt(4)
  v_mfma_f32_32x32x16_bf16 a[160:175], v[164:167], a[96:99], a[160:175]
  ds_read_b64_tr_b16 v[172:173], v181 offset:34816
  v_mfma_f32_32x32x16_bf16 a[176:191], v[164:167], a[100:103], a[176:191]
  ds_read_b64_tr_b16 v[174:175], v181 offset:35840
  buffer_load_dwordx4 a[36:39], v182, s[20:23], s46 offen offset:0 sc1
  v_xor_b32 v241, 32, v88
  v_xor_b32 v243, 32, v96
  ds_write_b128 v241, a[196:199] offset:0
  s_waitcnt lgkmcnt(4)
  v_mfma_f32_32x32x16_bf16 a[128:143], v[168:171], a[104:107], a[128:143]
  ds_read_b64_tr_b16 v[160:161], v180 offset:36864
  buffer_load_dwordx4 a[40:43], v194, s[20:23], s46 offen offset:1024 sc1
  ds_write_b128 v243, a[212:215]
  v_mfma_f32_32x32x16_bf16 a[144:159], v[168:171], a[108:111], a[144:159]
  ds_read_b64_tr_b16 v[162:163], v180 offset:37888
  s_waitcnt lgkmcnt(4)
  v_mfma_f32_32x32x16_bf16 a[160:175], v[172:175], a[104:107], a[160:175]
  ds_read_b64_tr_b16 v[164:165], v181 offset:36864
  v_xor_b32 v240, 64, v88
  v_xor_b32 v242, 64, v96
  ds_write_b128 v240, a[200:203] offset:0
  v_mfma_f32_32x32x16_bf16 a[176:191], v[172:175], a[108:111], a[176:191]
  ds_read_b64_tr_b16 v[166:167], v181 offset:37888
  buffer_load_dwordx4 a[44:47], v182, s[20:23], s46 offen offset:1024 sc1
  ds_write_b128 v242, a[216:219]
  s_waitcnt lgkmcnt(4)
  v_mfma_f32_32x32x16_bf16 a[128:143], v[160:163], a[112:115], a[128:143]
  ds_read_b64_tr_b16 v[168:169], v180 offset:38912
  buffer_load_dwordx4 a[48:51], v194, s[20:23], s46 offen offset:2048 sc1
  v_mfma_f32_32x32x16_bf16 a[144:159], v[160:163], a[116:119], a[144:159]
  ds_read_b64_tr_b16 v[170:171], v180 offset:39936
  v_xor_b32 v241, 96, v88
  v_xor_b32 v243, 96, v96
  ds_write_b128 v241, a[204:207] offset:0
  s_waitcnt lgkmcnt(4)
  v_mfma_f32_32x32x16_bf16 a[160:175], v[164:167], a[112:115], a[160:175]
  ds_read_b64_tr_b16 v[172:173], v181 offset:38912
  ds_write_b128 v243, a[220:223]
  v_mfma_f32_32x32x16_bf16 a[176:191], v[164:167], a[116:119], a[176:191]
  ds_read_b64_tr_b16 v[174:175], v181 offset:39936
  buffer_load_dwordx4 a[52:55], v182, s[20:23], s46 offen offset:2048 sc1
  s_waitcnt lgkmcnt(4)
  v_mfma_f32_32x32x16_bf16 a[128:143], v[168:171], a[120:123], a[128:143]
  v_add_u32 v180, 65536, v180
  ds_read_b64_tr_b16 v[160:161], v180 offset:0
  buffer_load_dwordx4 a[56:59], v194, s[20:23], s46 offen offset:3072 sc1
  v_xor_b32 v240, 128, v88
  v_xor_b32 v242, 128, v96
  ds_write_b128 v240, a[224:227] offset:0
  v_mfma_f32_32x32x16_bf16 a[144:159], v[168:171], a[124:127], a[144:159]
  ds_read_b64_tr_b16 v[162:163], v180 offset:1024
  ds_write_b128 v242, a[240:243]
  s_waitcnt lgkmcnt(4)
  v_mfma_f32_32x32x16_bf16 a[160:175], v[172:175], a[120:123], a[160:175]
  v_add_u32 v181, 65536, v181
  ds_read_b64_tr_b16 v[164:165], v181 offset:0
  v_mfma_f32_32x32x16_bf16 a[176:191], v[172:175], a[124:127], a[176:191]
  ds_read_b64_tr_b16 v[166:167], v181 offset:1024
  buffer_load_dwordx4 a[60:63], v182, s[20:23], s46 offen offset:3072 sc1
  v_xor_b32 v241, 160, v88
  v_xor_b32 v243, 160, v96
  ds_write_b128 v241, a[228:231] offset:0
  s_waitcnt vmcnt(15) lgkmcnt(4)
  v_mfma_f32_32x32x16_bf16 a[128:143], v[160:163], a[0:3], a[128:143]
  ds_read_b64_tr_b16 v[168:169], v180 offset:2048
  s_add_u32 m0, s53, 32768
  s_add_u32 s47, s78, 327680
  buffer_load_dwordx4 v176, s[64:67], s47 offen offset:0 lds
  ds_write_b128 v243, a[244:247]
  s_waitcnt vmcnt(15)
  v_mfma_f32_32x32x16_bf16 a[144:159], v[160:163], a[4:7], a[144:159]
  ds_read_b64_tr_b16 v[170:171], v180 offset:3072
  buffer_load_dwordx4 v177, s[64:67], s47 offen offset:1024 lds
  s_waitcnt lgkmcnt(4)
  v_mfma_f32_32x32x16_bf16 a[160:175], v[164:167], a[0:3], a[160:175]
  ds_read_b64_tr_b16 v[172:173], v181 offset:2048
  buffer_load_dwordx4 v178, s[64:67], s47 offen offset:2048 lds
  v_xor_b32 v240, 192, v88
  v_xor_b32 v242, 192, v96
  ds_write_b128 v240, a[232:235] offset:0
  v_mfma_f32_32x32x16_bf16 a[176:191], v[164:167], a[4:7], a[176:191]
  ds_read_b64_tr_b16 v[174:175], v181 offset:3072
  buffer_load_dwordx4 v179, s[64:67], s47 offen offset:3072 lds
  ds_write_b128 v242, a[248:251]
  s_waitcnt vmcnt(17) lgkmcnt(4)
  v_mfma_f32_32x32x16_bf16 a[128:143], v[168:171], a[8:11], a[128:143]
  ds_read_b64_tr_b16 v[160:161], v180 offset:4096
  s_add_u32 m0, s53, 36864
  s_add_u32 s47, s78, 360448
  buffer_load_dwordx4 v176, s[64:67], s47 offen offset:0 lds
  s_waitcnt vmcnt(17)
  v_mfma_f32_32x32x16_bf16 a[144:159], v[168:171], a[12:15], a[144:159]
  ds_read_b64_tr_b16 v[162:163], v180 offset:5120
  buffer_load_dwordx4 v177, s[64:67], s47 offen offset:1024 lds
  v_xor_b32 v241, 224, v88
  v_xor_b32 v243, 224, v96
  ds_write_b128 v241, a[236:239] offset:0
  s_waitcnt lgkmcnt(4)
  v_mfma_f32_32x32x16_bf16 a[160:175], v[172:175], a[8:11], a[160:175]
  ds_read_b64_tr_b16 v[164:165], v181 offset:4096
  buffer_load_dwordx4 v178, s[64:67], s47 offen offset:2048 lds
  ds_write_b128 v243, a[252:255]
  v_mfma_f32_32x32x16_bf16 a[176:191], v[172:175], a[12:15], a[176:191]
  ds_read_b64_tr_b16 v[166:167], v181 offset:5120
  buffer_load_dwordx4 v179, s[64:67], s47 offen offset:3072 lds
  s_waitcnt vmcnt(19) lgkmcnt(4)
  v_mfma_f32_32x32x16_bf16 a[128:143], v[160:163], a[16:19], a[128:143]
  ds_read_b64_tr_b16 v[168:169], v180 offset:6144
  s_add_u32 s46, s72, 20480
  buffer_load_dwordx4 a[64:67], v194, s[20:23], s46 offen offset:0 sc1
  s_waitcnt vmcnt(19)
  v_mfma_f32_32x32x16_bf16 a[144:159], v[160:163], a[20:23], a[144:159]
  ds_read_b64_tr_b16 v[170:171], v180 offset:7168
  buffer_load_dwordx4 a[68:71], v182, s[20:23], s46 offen offset:0 sc1
  s_waitcnt lgkmcnt(2)
  v_mfma_f32_32x32x16_bf16 a[160:175], v[164:167], a[16:19], a[160:175]
  ds_read_b64_tr_b16 v[172:173], v181 offset:6144
  buffer_load_dwordx4 a[72:75], v194, s[20:23], s46 offen offset:1024 sc1
  v_mfma_f32_32x32x16_bf16 a[176:191], v[164:167], a[20:23], a[176:191]
  s_waitcnt lgkmcnt(0)
  s_barrier
  ds_read_b64_tr_b16 v[174:175], v181 offset:7168
  buffer_load_dwordx4 a[76:79], v182, s[20:23], s46 offen offset:1024 sc1
  ds_read_b128 v[96:99], v90 offset:0
  s_waitcnt vmcnt(21)
  v_mfma_f32_32x32x16_bf16 a[128:143], v[168:171], a[24:27], a[128:143]
  ds_read_b64_tr_b16 v[160:161], v180 offset:32768
  buffer_load_dwordx4 a[80:83], v194, s[20:23], s46 offen offset:2048 sc1
  ds_read_b128 v[112:115], v90 offset:8192
  s_waitcnt vmcnt(21)
  v_mfma_f32_32x32x16_bf16 a[144:159], v[168:171], a[28:31], a[144:159]
  ds_read_b64_tr_b16 v[162:163], v180 offset:33792
  buffer_load_dwordx4 a[84:87], v182, s[20:23], s46 offen offset:2048 sc1
  ds_read_b128 v[128:131], v90 offset:16384
  s_waitcnt lgkmcnt(5)
  v_mfma_f32_32x32x16_bf16 a[160:175], v[172:175], a[24:27], a[160:175]
  ds_read_b64_tr_b16 v[164:165], v181 offset:32768
  buffer_load_dwordx4 a[88:91], v194, s[20:23], s46 offen offset:3072 sc1
  ds_read_b128 v[144:147], v90 offset:24576
  v_mfma_f32_32x32x16_bf16 a[176:191], v[172:175], a[28:31], a[176:191]
  ds_read_b64_tr_b16 v[166:167], v181 offset:33792
  buffer_load_dwordx4 a[92:95], v182, s[20:23], s46 offen offset:3072 sc1
  ds_read_b128 v[100:103], v91 offset:1024
  s_waitcnt vmcnt(23) lgkmcnt(5)
  v_mfma_f32_32x32x16_bf16 a[128:143], v[160:163], a[32:35], a[128:143]
  ds_read_b64_tr_b16 v[168:169], v180 offset:34816
  ds_read_b128 v[116:119], v91 offset:9216
  s_waitcnt vmcnt(22)
  v_mfma_f32_32x32x16_bf16 a[144:159], v[160:163], a[36:39], a[144:159]
  ds_read_b64_tr_b16 v[170:171], v180 offset:35840
  ds_read_b128 v[132:135], v91 offset:17408
  s_waitcnt lgkmcnt(5)
  v_mfma_f32_32x32x16_bf16 a[160:175], v[164:167], a[32:35], a[160:175]
  ds_read_b64_tr_b16 v[172:173], v181 offset:34816
  ds_read_b128 v[148:151], v91 offset:25600
  v_mfma_f32_32x32x16_bf16 a[176:191], v[164:167], a[36:39], a[176:191]
  ds_read_b64_tr_b16 v[174:175], v181 offset:35840
  ds_read_b128 v[104:107], v92 offset:2048
  s_waitcnt vmcnt(21) lgkmcnt(5)
  v_mfma_f32_32x32x16_bf16 a[128:143], v[168:171], a[40:43], a[128:143]
  ds_read_b64_tr_b16 v[160:161], v180 offset:36864
  ds_read_b128 v[120:123], v92 offset:10240
  s_waitcnt vmcnt(20)
  v_mfma_f32_32x32x16_bf16 a[144:159], v[168:171], a[44:47], a[144:159]
  ds_read_b64_tr_b16 v[162:163], v180 offset:37888
  ds_read_b128 v[136:139], v92 offset:18432
  s_waitcnt lgkmcnt(5)
  v_mfma_f32_32x32x16_bf16 a[160:175], v[172:175], a[40:43], a[160:175]
  ds_read_b64_tr_b16 v[164:165], v181 offset:36864
  ds_read_b128 v[152:155], v92 offset:26624
  v_mfma_f32_32x32x16_bf16 a[176:191], v[172:175], a[44:47], a[176:191]
  ds_read_b64_tr_b16 v[166:167], v181 offset:37888
  ds_read_b128 v[108:111], v93 offset:3072
  s_waitcnt vmcnt(19) lgkmcnt(5)
  v_mfma_f32_32x32x16_bf16 a[128:143], v[160:163], a[48:51], a[128:143]
  ds_read_b64_tr_b16 v[168:169], v180 offset:38912
  ds_read_b128 v[124:127], v93 offset:11264
  s_waitcnt vmcnt(18)
  v_mfma_f32_32x32x16_bf16 a[144:159], v[160:163], a[52:55], a[144:159]
  ds_read_b64_tr_b16 v[170:171], v180 offset:39936
  ds_read_b128 v[140:143], v93 offset:19456
  s_waitcnt lgkmcnt(5)
  v_mfma_f32_32x32x16_bf16 a[160:175], v[164:167], a[48:51], a[160:175]
  ds_read_b64_tr_b16 v[172:173], v181 offset:38912
  ds_read_b128 v[156:159], v93 offset:27648
  s_mul_i32 s48, s38, 98304
  s_sub_u32 s48, 65536, s48
  v_add_u32 v90, s48, v90
  v_add_u32 v91, s48, v91
  v_add_u32 v92, s48, v92
  v_add_u32 v93, s48, v93
  v_mfma_f32_32x32x16_bf16 a[176:191], v[164:167], a[52:55], a[176:191]
  ds_read_b64_tr_b16 v[174:175], v181 offset:39936
  v_add_f32 v96, v96, v112
  v_add_f32 v128, v128, v144
  v_add_f32 v97, v97, v113
  v_add_f32 v129, v129, v145
  v_add_f32 v98, v98, v114
  v_add_f32 v130, v130, v146
  v_add_f32 v99, v99, v115
  s_waitcnt vmcnt(17) lgkmcnt(4)
  v_mfma_f32_32x32x16_bf16 a[128:143], v[168:171], a[56:59], a[128:143]
  s_waitcnt vmcnt(8)
  v_subrev_u32 v180, 65536, v180
  ds_read_b64_tr_b16 v[0:1], v180 offset:32768
  ds_read_b64_tr_b16 v[2:3], v180 offset:33792
  v_add_f32 v131, v131, v147
  v_add_f32 v96, v96, v128
  v_add_f32 v97, v97, v129
  v_add_f32 v98, v98, v130
  v_mfma_f32_32x32x16_bf16 a[144:159], v[168:171], a[60:63], a[144:159]
  ds_read_b64_tr_b16 v[4:5], v180 offset:34816
  ds_read_b64_tr_b16 v[6:7], v180 offset:35840
  v_add_f32 v99, v99, v131
  v_add_f32 v100, v100, v116
  v_add_f32 v132, v132, v148
  v_add_f32 v101, v101, v117
  v_add_f32 v133, v133, v149
  v_add_f32 v102, v102, v118
  s_waitcnt lgkmcnt(4)
  v_mfma_f32_32x32x16_bf16 a[160:175], v[172:175], a[56:59], a[160:175]
  ds_read_b64_tr_b16 v[8:9], v180 offset:36864
  ds_read_b64_tr_b16 v[10:11], v180 offset:37888
  v_add_f32 v134, v134, v150
  v_add_f32 v103, v103, v119
  v_add_f32 v135, v135, v151
  v_add_f32 v100, v100, v132
  v_add_f32 v101, v101, v133
  v_add_f32 v102, v102, v134
  v_mfma_f32_32x32x16_bf16 a[176:191], v[172:175], a[60:63], a[176:191]
  ds_read_b64_tr_b16 v[12:13], v180 offset:38912
  ds_read_b64_tr_b16 v[14:15], v180 offset:39936
  v_add_f32 v103, v103, v135
  v_add_f32 v104, v104, v120
  v_add_f32 v136, v136, v152
  v_add_f32 v105, v105, v121
  v_add_f32 v137, v137, v153
  v_add_f32 v106, v106, v122
  s_waitcnt vmcnt(7) lgkmcnt(6)
  v_mfma_f32_32x32x16_bf16 a[128:143], v[0:3], a[64:67], a[128:143]
  v_subrev_u32 v181, 65536, v181
  ds_read_b64_tr_b16 v[16:17], v181 offset:32768
  ds_read_b64_tr_b16 v[18:19], v181 offset:33792
  v_add_f32 v138, v138, v154
  v_add_f32 v107, v107, v123
  v_add_f32 v139, v139, v155
  v_add_f32 v104, v104, v136
  v_add_f32 v105, v105, v137
  s_waitcnt vmcnt(5) lgkmcnt(6)
  v_mfma_f32_32x32x16_bf16 a[128:143], v[4:7], a[72:75], a[128:143]
  ds_read_b64_tr_b16 v[20:21], v181 offset:34816
  ds_read_b64_tr_b16 v[22:23], v181 offset:35840
  v_add_f32 v106, v106, v138
  v_add_f32 v107, v107, v139
  v_add_f32 v108, v108, v124
  v_add_f32 v140, v140, v156
  v_add_f32 v109, v109, v125
  v_add_f32 v141, v141, v157
  s_waitcnt vmcnt(3) lgkmcnt(6)
  v_mfma_f32_32x32x16_bf16 a[128:143], v[8:11], a[80:83], a[128:143]
  ds_read_b64_tr_b16 v[24:25], v181 offset:36864
  ds_read_b64_tr_b16 v[26:27], v181 offset:37888
  v_add_f32 v110, v110, v126
  v_add_f32 v142, v142, v158
  v_add_f32 v111, v111, v127
  v_add_f32 v143, v143, v159
  v_add_f32 v108, v108, v140
  v_add_f32 v109, v109, v141
  s_waitcnt vmcnt(1) lgkmcnt(6)
  v_mfma_f32_32x32x16_bf16 a[128:143], v[12:15], a[88:91], a[128:143]
  ds_read_b64_tr_b16 v[28:29], v181 offset:38912
  ds_read_b64_tr_b16 v[30:31], v181 offset:39936
  v_add_f32 v110, v110, v142
  v_add_f32 v111, v111, v143
  v_add_f32 v96, v96, v72
  v_add_f32 v97, v97, v73
  v_add_f32 v98, v98, v74
  v_add_f32 v99, v99, v75
  v_mfma_f32_32x32x16_bf16 a[144:159], v[0:3], a[68:71], a[144:159]
  v_add_f32 v100, v100, v76
  v_add_f32 v101, v101, v77
  v_add_f32 v102, v102, v78
  v_add_f32 v103, v103, v79
  v_add_f32 v104, v104, v80
  v_add_f32 v105, v105, v81
  v_add_f32 v106, v106, v82
  v_add_f32 v107, v107, v83
  v_mfma_f32_32x32x16_bf16 a[144:159], v[4:7], a[76:79], a[144:159]
  ds_write_b128 v89, a[128:131] offset:0
  v_xor_b32 v241, 32, v89
  v_add_f32 v108, v108, v84
  v_add_f32 v109, v109, v85
  v_add_f32 v110, v110, v86
  v_add_f32 v111, v111, v87
  v_mfma_f32_32x32x16_bf16 a[144:159], v[8:11], a[84:87], a[144:159]
  ds_write_b128 v241, a[132:135] offset:0
  v_xor_b32 v240, 64, v89
  s_waitcnt vmcnt(0)
  v_mfma_f32_32x32x16_bf16 a[144:159], v[12:15], a[92:95], a[144:159]
  ds_write_b128 v240, a[136:139] offset:0
  v_xor_b32 v241, 96, v89
  s_waitcnt lgkmcnt(9)
  v_mfma_f32_32x32x16_bf16 a[160:175], v[16:19], a[64:67], a[160:175]
  ds_write_b128 v241, a[140:143] offset:0
  s_waitcnt lgkmcnt(8)
  v_mfma_f32_32x32x16_bf16 a[160:175], v[20:23], a[72:75], a[160:175]
  s_nop 4
  ds_write_b128 v89, a[144:147] offset:32768
  v_xor_b32 v241, 32, v89
  s_waitcnt lgkmcnt(7)
  v_mfma_f32_32x32x16_bf16 a[160:175], v[24:27], a[80:83], a[160:175]
  ds_write_b128 v241, a[148:151] offset:32768
  v_xor_b32 v240, 64, v89
  s_waitcnt lgkmcnt(6)
  v_mfma_f32_32x32x16_bf16 a[160:175], v[28:31], a[88:91], a[160:175]
  ds_write_b128 v240, a[152:155] offset:32768
  v_xor_b32 v241, 96, v89
  v_mfma_f32_32x32x16_bf16 a[176:191], v[16:19], a[68:71], a[176:191]
  ds_write_b128 v241, a[156:159] offset:32768
  v_mfma_f32_32x32x16_bf16 a[176:191], v[20:23], a[76:79], a[176:191]
  v_xor_b32 v240, 128, v89
  s_nop 5
  ds_write_b128 v240, a[160:163] offset:0
  v_mfma_f32_32x32x16_bf16 a[176:191], v[24:27], a[84:87], a[176:191]
  v_xor_b32 v241, 160, v89
  ds_write_b128 v241, a[164:167] offset:0
  v_mfma_f32_32x32x16_bf16 a[176:191], v[28:31], a[92:95], a[176:191]
  v_xor_b32 v240, 192, v89
  ds_write_b128 v240, a[168:171] offset:0
  v_xor_b32 v241, 224, v89
  ds_write_b128 v241, a[172:175] offset:0
  v_xor_b32 v240, 128, v89
  s_nop 6
  ds_write_b128 v240, a[176:179] offset:32768
  v_xor_b32 v241, 160, v89
  ds_write_b128 v241, a[180:183] offset:32768
  v_xor_b32 v240, 192, v89
  ds_write_b128 v240, a[184:187] offset:32768
  v_xor_b32 v241, 224, v89
  ds_write_b128 v241, a[188:191] offset:32768
  v_mov_b32 v160, 0xbfb8aa3b
  v_mov_b32 v162, 1.0
  v_mov_b32 v161, 0xbfb8aa3b
  v_mov_b32 v163, 1.0
  s_waitcnt lgkmcnt(0)
  s_barrier
  ds_read_b128 v[0:3], v90 offset:0
  ds_read_b128 v[112:115], v90 offset:8192
  ds_read_b128 v[128:131], v90 offset:16384
  ds_read_b128 v[144:147], v90 offset:24576
  ds_read_b128 v[4:7], v91 offset:1024
  ds_read_b128 v[116:119], v91 offset:9216
  ds_read_b128 v[132:135], v91 offset:17408
  ds_read_b128 v[148:151], v91 offset:25600
  ds_read_b128 v[8:11], v92 offset:2048
  ds_read_b128 v[120:123], v92 offset:10240
  ds_read_b128 v[136:139], v92 offset:18432
  ds_read_b128 v[152:155], v92 offset:26624
  ds_read_b128 v[12:15], v93 offset:3072
  ds_read_b128 v[124:127], v93 offset:11264
  ds_read_b128 v[140:143], v93 offset:19456
  ds_read_b128 v[156:159], v93 offset:27648
  s_waitcnt lgkmcnt(12)
  v_pk_add_f32 v[0:1], v[0:1], v[144:145]
  v_pk_add_f32 v[112:113], v[112:113], v[128:129]
  v_pk_add_f32 v[2:3], v[2:3], v[146:147]
  v_pk_add_f32 v[114:115], v[114:115], v[130:131]
  v_pk_add_f32 v[0:1], v[0:1], v[112:113]
  v_pk_add_f32 v[2:3], v[2:3], v[114:115]
  v_pk_mul_f32 v[112:113], v[0:1], v[160:161]
  v_pk_mul_f32 v[114:115], v[2:3], v[160:161]
  v_exp_f32 v112, v112
  v_exp_f32 v113, v113
  v_exp_f32 v114, v114
  v_exp_f32 v115, v115
  v_pk_add_f32 v[112:113], v[112:113], v[162:163]
  v_pk_add_f32 v[114:115], v[114:115], v[162:163]
  v_rcp_f32 v112, v112
  v_rcp_f32 v113, v113
  v_rcp_f32 v114, v114
  v_rcp_f32 v115, v115
  v_pk_mul_f32 v[0:1], v[0:1], v[112:113]
  v_pk_mul_f32 v[2:3], v[2:3], v[114:115]
  v_pk_fma_f32 v[0:1], v[0:1], v[96:97], v[56:57]
  v_pk_fma_f32 v[2:3], v[2:3], v[98:99], v[58:59]
  s_add_u32 s48, s88, 0
  buffer_store_dwordx4 v[0:3], v95, s[92:95], s48 offen sc0 sc1
  s_waitcnt lgkmcnt(8)
  v_pk_add_f32 v[4:5], v[4:5], v[148:149]
  v_pk_add_f32 v[116:117], v[116:117], v[132:133]
  v_pk_add_f32 v[6:7], v[6:7], v[150:151]
  v_pk_add_f32 v[118:119], v[118:119], v[134:135]
  v_pk_add_f32 v[4:5], v[4:5], v[116:117]
  v_pk_add_f32 v[6:7], v[6:7], v[118:119]
  v_pk_mul_f32 v[116:117], v[4:5], v[160:161]
  v_pk_mul_f32 v[118:119], v[6:7], v[160:161]
  v_exp_f32 v116, v116
  v_exp_f32 v117, v117
  v_exp_f32 v118, v118
  v_exp_f32 v119, v119
  v_pk_add_f32 v[116:117], v[116:117], v[162:163]
  v_pk_add_f32 v[118:119], v[118:119], v[162:163]
  v_rcp_f32 v116, v116
  v_rcp_f32 v117, v117
  v_rcp_f32 v118, v118
  v_rcp_f32 v119, v119
  v_pk_mul_f32 v[4:5], v[4:5], v[116:117]
  v_pk_mul_f32 v[6:7], v[6:7], v[118:119]
  v_pk_fma_f32 v[4:5], v[4:5], v[100:101], v[60:61]
  v_pk_fma_f32 v[6:7], v[6:7], v[102:103], v[62:63]
  s_add_u32 s48, s88, 8192
  buffer_store_dwordx4 v[4:7], v95, s[92:95], s48 offen sc0 sc1
  s_waitcnt lgkmcnt(4)
  v_pk_add_f32 v[8:9], v[8:9], v[152:153]
  v_pk_add_f32 v[120:121], v[120:121], v[136:137]
  v_pk_add_f32 v[10:11], v[10:11], v[154:155]
  v_pk_add_f32 v[122:123], v[122:123], v[138:139]
  v_pk_add_f32 v[8:9], v[8:9], v[120:121]
  v_pk_add_f32 v[10:11], v[10:11], v[122:123]
  v_pk_mul_f32 v[120:121], v[8:9], v[160:161]
  v_pk_mul_f32 v[122:123], v[10:11], v[160:161]
  v_exp_f32 v120, v120
  v_exp_f32 v121, v121
  v_exp_f32 v122, v122
  v_exp_f32 v123, v123
  v_pk_add_f32 v[120:121], v[120:121], v[162:163]
  v_pk_add_f32 v[122:123], v[122:123], v[162:163]
  v_rcp_f32 v120, v120
  v_rcp_f32 v121, v121
  v_rcp_f32 v122, v122
  v_rcp_f32 v123, v123
  v_pk_mul_f32 v[8:9], v[8:9], v[120:121]
  v_pk_mul_f32 v[10:11], v[10:11], v[122:123]
  v_pk_fma_f32 v[8:9], v[8:9], v[104:105], v[64:65]
  v_pk_fma_f32 v[10:11], v[10:11], v[106:107], v[66:67]
  s_add_u32 s48, s88, 16384
  buffer_store_dwordx4 v[8:11], v95, s[92:95], s48 offen sc0 sc1
  s_waitcnt lgkmcnt(0)
  v_pk_add_f32 v[12:13], v[12:13], v[156:157]
  v_pk_add_f32 v[124:125], v[124:125], v[140:141]
  v_pk_add_f32 v[14:15], v[14:15], v[158:159]
  v_pk_add_f32 v[126:127], v[126:127], v[142:143]
  v_pk_add_f32 v[12:13], v[12:13], v[124:125]
  v_pk_add_f32 v[14:15], v[14:15], v[126:127]
  v_pk_mul_f32 v[124:125], v[12:13], v[160:161]
  v_pk_mul_f32 v[126:127], v[14:15], v[160:161]
  v_exp_f32 v124, v124
  v_exp_f32 v125, v125
  v_exp_f32 v126, v126
  v_exp_f32 v127, v127
  v_pk_add_f32 v[124:125], v[124:125], v[162:163]
  v_pk_add_f32 v[126:127], v[126:127], v[162:163]
  v_rcp_f32 v124, v124
  v_rcp_f32 v125, v125
  v_rcp_f32 v126, v126
  v_rcp_f32 v127, v127
  v_pk_mul_f32 v[12:13], v[12:13], v[124:125]
  v_pk_mul_f32 v[14:15], v[14:15], v[126:127]
  v_pk_fma_f32 v[12:13], v[12:13], v[108:109], v[68:69]
  v_pk_fma_f32 v[14:15], v[14:15], v[110:111], v[70:71]
  s_add_u32 s48, s88, 24576
  buffer_store_dwordx4 v[12:15], v95, s[92:95], s48 offen sc0 sc1
  s_endpgm
FZH_nps2:
  s_mov_b32 s3, 0
FZH_nps2l:
  buffer_load_dword v114, v115, s[28:31], 0 offen sc1
  s_waitcnt vmcnt(0)
  v_readfirstlane_b32 s36, v114
  s_add_u32 s3, s3, 1
  s_cmp_gt_u32 s3, 100000
  s_cbranch_scc1 FZH_npr3
  s_cmp_eq_u32 s36, 0
  s_cbranch_scc1 FZH_nps2l
  s_nop 4
  s_branch FZH_npr3
FZH_slow4:
  s_mov_b32 s3, 0
FZH_slow4l:
  buffer_load_dwordx2 v[136:137], v143, s[20:23], s96 offen sc1
  buffer_load_dwordx2 v[138:139], v143, s[20:23], s96 offen offset:256 sc1
  buffer_load_dwordx2 v[140:141], v144, s[20:23], s97 offen sc1
  s_waitcnt vmcnt(0)
  v_cmp_ne_u32 s[60:61], s36, v137
  v_cmp_ne_u32 vcc, s36, v139
  s_nop 0
  s_or_b64 s[60:61], s[60:61], vcc
  v_cmp_ne_u32 vcc, s36, v141
  s_nop 0
  s_or_b64 s[60:61], s[60:61], vcc
  s_add_u32 s3, s3, 1
  s_cmp_gt_u32 s3, 100000
  s_cbranch_scc1 FZH_ret5
  s_cmp_lg_u64 s[60:61], 0
  s_cbranch_scc1 FZH_slow4l
  s_nop 4
  s_branch FZH_ret5
FZH_slow6:
  s_mov_b32 s3, 0
FZH_slow6l:
  buffer_load_dwordx4 v[96:99], v194, s[20:23], s62 offen offset:0 sc1
  buffer_load_dwordx4 v[100:103], v194, s[20:23], s62 offen offset:1024 sc1
  buffer_load_dwordx4 v[104:107], v194, s[20:23], s62 offen offset:2048 sc1
  buffer_load_dwordx4 v[108:111], v194, s[20:23], s62 offen offset:3072 sc1
  s_waitcnt vmcnt(0)
  v_cmp_ne_u32 s[60:61], s36, v97
  v_cmp_ne_u32 vcc, s36, v99
  s_nop 0
  s_or_b64 s[60:61], s[60:61], vcc
  v_cmp_ne_u32 vcc, s36, v101
  s_nop 0
  s_or_b64 s[60:61], s[60:61], vcc
  v_cmp_ne_u32 vcc, s36, v103
  s_nop 0
  s_or_b64 s[60:61], s[60:61], vcc
  v_cmp_ne_u32 vcc, s36, v105
  s_nop 0
  s_or_b64 s[60:61], s[60:61], vcc
  v_cmp_ne_u32 vcc, s36, v107
  s_nop 0
  s_or_b64 s[60:61], s[60:61], vcc
  v_cmp_ne_u32 vcc, s36, v109
  s_nop 0
  s_or_b64 s[60:61], s[60:61], vcc
  v_cmp_ne_u32 vcc, s36, v111
  s_nop 0
  s_or_b64 s[60:61], s[60:61], vcc
  s_add_u32 s3, s3, 1
  s_cmp_gt_u32 s3, 100000
  s_cbranch_scc1 FZH_ret7
  s_cmp_lg_u64 s[60:61], 0
  s_cbranch_scc1 FZH_slow6l
  s_nop 4
  s_branch FZH_ret7
FZH_slow8:
  s_mov_b32 s3, 0
FZH_slow8l:
  buffer_load_dwordx4 v[32:35], v48, s[20:23], s96 offen sc1
  buffer_load_dwordx4 v[36:39], v49, s[20:23], s96 offen sc1
  buffer_load_dwordx4 v[40:43], v50, s[20:23], s96 offen sc1
  buffer_load_dwordx4 v[44:47], v51, s[20:23], s96 offen sc1
  s_waitcnt vmcnt(0)
  v_cmp_ne_u32 s[60:61], v52, v33
  v_cmp_ne_u32 vcc, v52, v35
  s_nop 0
  s_or_b64 s[60:61], s[60:61], vcc
  v_cmp_ne_u32 vcc, v53, v37
  s_nop 0
  s_or_b64 s[60:61], s[60:61], vcc
  v_cmp_ne_u32 vcc, v53, v39
  s_nop 0
  s_or_b64 s[60:61], s[60:61], vcc
  v_cmp_ne_u32 vcc, v54, v41
  s_nop 0
  s_or_b64 s[60:61], s[60:61], vcc
  v_cmp_ne_u32 vcc, v54, v43
  s_nop 0
  s_or_b64 s[60:61], s[60:61], vcc
  v_cmp_ne_u32 vcc, v55, v45
  s_nop 0
  s_or_b64 s[60:61], s[60:61], vcc
  v_cmp_ne_u32 vcc, v55, v47
  s_nop 0
  s_or_b64 s[60:61], s[60:61], vcc
  s_add_u32 s3, s3, 1
  s_cmp_gt_u32 s3, 100000
  s_cbranch_scc1 FZH_ret9
  s_cmp_lg_u64 s[60:61], 0
  s_cbranch_scc1 FZH_slow8l
  s_nop 4
  s_branch FZH_ret9
FZH_pslow10:
  s_mov_b32 s3, 0
FZH_pslow10l:
  buffer_load_dword v253, v183, s[20:23], s74 offen sc1
  s_waitcnt vmcnt(0)
  v_cmp_eq_u32 vcc, s36, v253
  s_nop 0
  s_and_b32 s45, vcc_lo, 0xff
  s_add_u32 s3, s3, 1
  s_cmp_gt_u32 s3, 100000
  s_cbranch_scc1 FZH_pret11
  s_cmp_eq_u32 s45, 0xff
  s_cbranch_scc0 FZH_pslow10l
  s_nop 4
  s_branch FZH_pret11
FZH_pslow12:
  s_mov_b32 s3, 0
FZH_pslow12l:
  buffer_load_dword v253, v183, s[20:23], s74 offen sc1
  s_waitcnt vmcnt(0)
  v_cmp_eq_u32 vcc, s36, v253
  s_nop 0
  s_and_b32 s45, vcc_lo, 0xff00
  s_add_u32 s3, s3, 1
  s_cmp_gt_u32 s3, 100000
  s_cbranch_scc1 FZH_pret13
  s_cmp_eq_u32 s45, 0xff00
  s_cbranch_scc0 FZH_pslow12l
  s_nop 4
  s_branch FZH_pret13
FZH_pslow14:
  s_mov_b32 s3, 0
FZH_pslow14l:
  buffer_load_dword v253, v183, s[20:23], s74 offen sc1
  s_waitcnt vmcnt(0)
  v_cmp_eq_u32 vcc, s36, v253
  s_nop 0
  s_and_b32 s45, vcc_lo, 0x3f0000
  s_add_u32 s3, s3, 1
  s_cmp_gt_u32 s3, 100000
  s_cbranch_scc1 FZH_pret15
  s_cmp_eq_u32 s45, 0x3f0000
  s_cbranch_scc0 FZH_pslow14l
  s_nop 4
  s_branch FZH_pret15
FZ_L:
  s_nop 1
  s_mov_b64 s[8:9], s[64:65]
  s_mov_b64 s[28:29], s[92:93]
  s_or_b32 s49, s2, s32
  s_cmp_eq_u32 s49, 0
  s_cbranch_scc0 FZL_nn1
  s_or_b32 s48, s24, 1
  v_mov_b32 v240, s48
  v_lshlrev_b32 v241, 10, v193
  buffer_store_dword v240, v241, s[28:31], 0 offen sc1
FZL_nn1:
  buffer_load_dwordx4 v[96:99], v194, s[8:11], s96 offen
  buffer_load_dwordx4 v[100:103], v194, s[8:11], s96 offen offset:1024
  s_mov_b64 s[12:13], s[84:85]
  s_cmp_eq_u32 s38, 0
  s_cselect_b64 s[24:25], s[70:71], s[72:73]
  s_bitcmp1_b32 s33, 2
  s_cselect_b64 s[48:49], s[72:73], s[70:71]
  global_load_dwordx4 v[104:107], v104, s[48:49]
  global_load_ushort v108, v111, s[66:67]
  global_load_ushort v109, v111, s[68:69]
  global_load_ushort v110, v111, s[78:79]
  s_mov_b64 s[20:21], s[94:95]
  s_mov_b64 s[16:17], s[86:87]
  s_and_b32 s48, s33, 1
  s_cmp_eq_u32 s48, 0
  s_cselect_b64 s[4:5], s[84:85], s[86:87]
  s_add_u32 s45, s35, 0
  s_and_b32 s45, s45, 7
  s_lshl_b32 s46, s45, 7
  s_add_u32 s47, s42, s46
  s_add_u32 m0, s51, 0
  s_nop 0
  buffer_load_dwordx4 v196, s[8:11], s47 offen offset:0 lds
  s_mov_b64 s[64:65], s[88:89]
  s_mov_b32 s66, 1835008
  s_mov_b32 s67, 0x00020000
  s_mov_b64 s[68:69], s[74:75]
  s_mov_b32 s70, 524288
  s_mov_b32 s71, 0x00020000
  s_mov_b64 s[84:85], s[76:77]
  s_mov_b32 s86, 524288
  s_mov_b32 s87, 0x00020000
  s_mov_b64 s[92:93], s[90:91]
  s_mov_b32 s94, 4194304
  s_mov_b32 s95, 0x00020000
  s_and_b32 s48, s2, 7
  s_lshl_b32 s48, s48, 2
  buffer_load_dwordx4 v197, s[8:11], s47 offen offset:1024 lds
  s_add_u32 s48, s48, s39
  s_mul_i32 s49, s48, 360448
  s_mul_i32 s72, s32, 28672
  s_add_u32 s72, s72, s49
  s_lshl_b32 s73, s32, 14
  s_add_u32 s73, s73, s49
  s_add_u32 s73, s73, 114688
  s_mul_i32 s78, s32, 458752
  s_lshl_b32 s77, s41, 7
  s_add_u32 s78, s78, s77
  s_lshl_b32 s79, s41, 16
  s_lshl_b32 s49, s32, 8
  s_add_u32 s79, s79, s49
  s_lshl_b32 s74, s48, 2
  buffer_load_dwordx4 v198, s[8:11], s47 offen offset:2048 lds
  s_add_u32 s74, s74, s32
  s_lshl_b32 s74, s74, 7
  s_add_u32 s74, s74, 14155776
  s_lshl_b32 s48, s48, 6
  s_lshl_b32 s49, s32, 4
  s_add_u32 s48, s48, s49
  s_lshl_b32 s75, s48, 10
  s_add_u32 s75, s75, s77
  s_lshl_b32 s88, s75, 1
  s_lshl_b32 s76, s48, 3
  s_add_u32 s76, s76, 12582912
  s_lshl_b32 s100, s33, 1
  s_add_u32 s100, s100, s37
  s_lshl_b32 s100, s100, 2
  buffer_load_dwordx4 v199, s[8:11], s47 offen offset:3072 lds
  s_add_u32 s100, s100, s40
  s_lshl_b32 s100, s100, 7
  s_lshl_b32 s48, s39, 1
  s_add_u32 s48, s48, s38
  s_lshl_b32 s48, s48, 2
  s_add_u32 s100, s100, s48
  s_add_u32 s100, s100, 14155776
  v_bfe_u32 v240, v193, 4, 1
  v_lshlrev_b32 v240, 2, v240
  v_and_b32 v241, 7, v193
  v_xor_b32 v240, v240, v241
  v_lshrrev_b32 v242, 3, v193
  v_lshlrev_b32 v242, 10, v242
  v_lshl_add_u32 v176, v240, 4, v242
  s_add_u32 s47, s43, s46
  s_add_u32 m0, s52, 16384
  s_nop 0
  buffer_load_dwordx4 v204, s[24:27], s47 offen offset:0 lds
  v_add_u32 v177, 7168, v176
  v_add_u32 v178, 14336, v176
  v_add_u32 v179, 21504, v176
  v_lshrrev_b32 v240, 5, v193
  v_lshlrev_b32 v240, 2, v240
  v_bfe_u32 v242, v193, 2, 2
  v_add_u32 v240, v240, v242
  v_lshlrev_b32 v240, 7, v240
  v_lshrrev_b32 v242, 1, v242
  v_lshlrev_b32 v242, 6, v242
  v_add_u32 v240, v240, v242
  v_bfe_u32 v242, v193, 4, 1
  v_lshl_add_u32 v240, v242, 5, v240
  v_and_b32 v242, 3, v193
  buffer_load_dwordx4 v205, s[24:27], s47 offen offset:1024 lds
  v_lshl_add_u32 v240, v242, 3, v240
  v_add_u32 v180, s53, v240
  v_xor_b32 v181, 64, v180
  v_add_u32 v182, 180224, v194
  v_and_b32 v183, 31, v193
  v_lshlrev_b32 v183, 2, v183
  v_and_b32 v240, 15, v193
  v_lshlrev_b32 v241, 3, v240
  s_lshl_b32 s48, s38, 11
  s_add_u32 s48, s48, 133376
  v_add_u32 v222, s48, v241
  v_lshlrev_b32 v223, 3, v193
  v_add_u32 v223, s48, v223
  s_lshl_b32 s48, s38, 7
  s_mul_i32 s47, s45, 229376
  s_add_u32 s47, s47, s44
  s_add_u32 m0, s52, 24576
  s_nop 0
  buffer_load_dwordx4 v200, s[12:15], s47 offen offset:0 lds
  s_lshl_b32 s49, s37, 9
  s_add_u32 s48, s48, s49
  s_add_u32 s48, s48, 131584
  v_add_u32 v225, s48, v241
  v_lshrrev_b32 v241, 4, v193
  v_lshlrev_b32 v224, 5, v241
  s_lshl_b32 s48, s37, 8
  s_add_u32 s48, s48, 131072
  v_add_u32 v224, s48, v224
  s_mul_i32 s48, s32, 2560
  s_add_u32 s48, s48, 147456
  v_mul_u32_u24 v226, 80, v240
  v_lshl_add_u32 v226, v241, 4, v226
  v_add_u32 v226, s48, v226
  buffer_load_dwordx4 v201, s[12:15], s47 offen offset:1024 lds
  v_lshrrev_b32 v227, 5, v193
  v_lshlrev_b32 v227, 3, v227
  v_bfe_u32 v241, v193, 2, 2
  v_add_u32 v227, v227, v241
  v_mul_u32_u24 v227, 80, v227
  v_and_b32 v241, 3, v193
  v_lshl_add_u32 v227, v241, 3, v227
  v_bfe_u32 v241, v193, 4, 1
  v_lshl_add_u32 v227, v241, 5, v227
  v_add_u32 v227, s48, v227
  v_lshlrev_b32 v240, 4, v240
  s_lshl_b32 s48, s33, 8
  s_cmp_eq_u32 s37, 1
  s_cselect_b32 s48, s48, 1073741824
  v_add_u32 v240, s48, v240
  v_mov_b32 v241, 1073741824
  v_cmp_gt_u32 vcc, 16, v193
  s_nop 1
  v_cndmask_b32 v228, v241, v240, vcc
  v_cmp_eq_u32 vcc, 0, v193
  s_nop 1
  v_cndmask_b32 v229, v241, 0, vcc
  s_lshr_b32 s96, s96, 7
  s_add_u32 s96, s96, 12582912
  v_mov_b32 v115, 0
  s_waitcnt vmcnt(12)
  buffer_load_dword v114, v115, s[28:31], 0 offen sc1
  v_lshlrev_b32 v128, 16, v96
  v_and_b32 v129, 0xffff0000, v96
  v_lshlrev_b32 v130, 16, v97
  v_and_b32 v131, 0xffff0000, v97
  v_lshlrev_b32 v132, 16, v98
  v_and_b32 v133, 0xffff0000, v98
  v_lshlrev_b32 v134, 16, v99
  v_and_b32 v135, 0xffff0000, v99
  v_lshlrev_b32 v136, 16, v100
  v_and_b32 v137, 0xffff0000, v100
  v_lshlrev_b32 v138, 16, v101
  v_and_b32 v139, 0xffff0000, v101
  v_lshlrev_b32 v140, 16, v102
  s_add_u32 s45, s35, 1
  s_and_b32 s45, s45, 7
  s_lshl_b32 s46, s45, 7
  s_add_u32 s47, s42, s46
  s_add_u32 m0, s51, 32768
  s_nop 0
  buffer_load_dwordx4 v196, s[8:11], s47 offen offset:0 lds
  v_and_b32 v141, 0xffff0000, v102
  v_lshlrev_b32 v142, 16, v103
  v_and_b32 v143, 0xffff0000, v103
  v_add_f32 v144, v128, v129
  v_add_f32 v145, v136, v137
  v_add_f32 v144, v144, v130
  v_add_f32 v145, v145, v138
  v_add_f32 v144, v144, v131
  v_add_f32 v145, v145, v139
  v_add_f32 v144, v144, v132
  v_add_f32 v145, v145, v140
  v_add_f32 v144, v144, v133
  v_add_f32 v145, v145, v141
  v_add_f32 v144, v144, v134
  buffer_load_dwordx4 v197, s[8:11], s47 offen offset:1024 lds
  v_add_f32 v145, v145, v142
  v_add_f32 v144, v144, v135
  v_add_f32 v145, v145, v143
  s_nop 1
  v_permlane32_swap_b32 v144, v145
  v_add_f32 v144, v144, v145
  v_mov_b32 v145, v144
  s_nop 1
  v_permlane16_swap_b32 v144, v145
  v_add_f32 v144, v144, v145
  s_nop 1
  v_add_f32_dpp v144, v144, v144 row_ror:8 row_mask:0xf bank_mask:0xf
  buffer_load_dwordx4 v198, s[8:11], s47 offen offset:2048 lds
  s_nop 0
  v_add_f32_dpp v144, v144, v144 row_ror:4 row_mask:0xf bank_mask:0xf
  s_nop 1
  v_add_f32_dpp v144, v144, v144 row_ror:2 row_mask:0xf bank_mask:0xf
  s_nop 1
  v_add_f32_dpp v144, v144, v144 row_ror:1 row_mask:0xf bank_mask:0xf
  v_mov_b32 v145, v144
  s_nop 1
  v_permlane32_swap_b32 v144, v145
  v_mul_f32 v146, 0x3b000000, v144
  v_mul_f32 v147, 0x3b000000, v145
  buffer_load_dwordx4 v199, s[8:11], s47 offen offset:3072 lds
  v_sub_f32 v128, v128, v146
  v_sub_f32 v129, v129, v146
  v_sub_f32 v130, v130, v146
  v_sub_f32 v131, v131, v146
  v_sub_f32 v132, v132, v146
  v_sub_f32 v133, v133, v146
  v_sub_f32 v134, v134, v146
  v_sub_f32 v135, v135, v146
  v_sub_f32 v136, v136, v147
  v_sub_f32 v137, v137, v147
  v_sub_f32 v138, v138, v147
  v_sub_f32 v139, v139, v147
  v_sub_f32 v140, v140, v147
  v_sub_f32 v141, v141, v147
  s_add_u32 s47, s43, s46
  s_add_u32 m0, s52, 49152
  s_nop 0
  buffer_load_dwordx4 v204, s[24:27], s47 offen offset:0 lds
  v_sub_f32 v142, v142, v147
  v_sub_f32 v143, v143, v147
  v_mul_f32 v144, v128, v128
  v_mul_f32 v145, v136, v136
  v_fmac_f32 v144, v129, v129
  v_fmac_f32 v145, v137, v137
  v_fmac_f32 v144, v130, v130
  v_fmac_f32 v145, v138, v138
  v_fmac_f32 v144, v131, v131
  v_fmac_f32 v145, v139, v139
  v_fmac_f32 v144, v132, v132
  v_fmac_f32 v145, v140, v140
  v_fmac_f32 v144, v133, v133
  v_fmac_f32 v145, v141, v141
  buffer_load_dwordx4 v205, s[24:27], s47 offen offset:1024 lds
  v_fmac_f32 v144, v134, v134
  v_fmac_f32 v145, v142, v142
  v_fmac_f32 v144, v135, v135
  v_fmac_f32 v145, v143, v143
  s_nop 1
  v_permlane32_swap_b32 v144, v145
  v_add_f32 v144, v144, v145
  v_mov_b32 v145, v144
  s_nop 1
  v_permlane16_swap_b32 v144, v145
  v_add_f32 v144, v144, v145
  s_nop 1
  v_add_f32_dpp v144, v144, v144 row_ror:8 row_mask:0xf bank_mask:0xf
  s_mul_i32 s47, s45, 229376
  s_add_u32 s47, s47, s44
  s_add_u32 m0, s52, 57344
  s_nop 0
  buffer_load_dwordx4 v200, s[12:15], s47 offen offset:0 lds
  v_add_f32_dpp v144, v144, v144 row_ror:4 row_mask:0xf bank_mask:0xf
  s_nop 1
  v_add_f32_dpp v144, v144, v144 row_ror:2 row_mask:0xf bank_mask:0xf
  s_nop 1
  v_add_f32_dpp v144, v144, v144 row_ror:1 row_mask:0xf bank_mask:0xf
  v_mov_b32 v145, v144
  s_nop 1
  v_permlane32_swap_b32 v144, v145
  v_cndmask_b32 v146, v146, v147, s[56:57]
  v_cndmask_b32 v144, v144, v145, s[56:57]
  v_mul_f32 v144, 0x3b000000, v144
  buffer_load_dwordx4 v201, s[12:15], s47 offen offset:1024 lds
  v_cvt_pk_bf16_f32 v144, v144, v144
  v_lshlrev_b32 v144, 16, v144
  v_add_f32 v144, 0x3727c5ac, v144
  v_cvt_pk_bf16_f32 v144, v144, v144
  v_lshlrev_b32 v144, 16, v144
  v_sqrt_f32 v144, v144
  s_nop 0
  v_cvt_pk_bf16_f32 v152, v144, v146
  v_and_b32 v147, 31, v193
  v_lshrrev_b32 v146, 2, v193
  v_mov_b32 v145, 1073741824
  v_cmp_eq_u32 vcc, 0, v147
  s_nop 1
  v_cndmask_b32 v156, v145, v146, vcc
  s_waitcnt vmcnt(20)
  v_lshlrev_b32 v64, 16, v104
  v_and_b32 v65, 0xffff0000, v104
  v_lshlrev_b32 v66, 16, v105
  v_and_b32 v67, 0xffff0000, v105
  v_lshlrev_b32 v68, 16, v106
  v_and_b32 v69, 0xffff0000, v106
  v_lshlrev_b32 v70, 16, v107
  v_and_b32 v71, 0xffff0000, v107
  v_add_f32 v64, v64, v68
  v_add_f32 v65, v65, v69
  v_add_f32 v66, v66, v70
  v_add_f32 v67, v67, v71
  v_add_f32 v64, v64, v66
  v_add_f32 v65, v65, v67
  v_add_f32 v72, v64, v65
  v_mov_b32 v73, v72
  s_nop 1
  v_permlane32_swap_b32 v72, v73
  v_add_f32 v72, v72, v73
  v_mov_b32 v73, v72
  s_nop 1
  v_permlane16_swap_b32 v72, v73
  v_add_f32 v72, v72, v73
  s_nop 1
  v_add_f32_dpp v72, v72, v72 row_ror:8 row_mask:0xf bank_mask:0xf
  s_nop 1
  v_add_f32_dpp v72, v72, v72 row_ror:4 row_mask:0xf bank_mask:0xf
  s_nop 1
  v_add_f32_dpp v72, v72, v72 row_ror:2 row_mask:0xf bank_mask:0xf
  s_nop 1
  v_add_f32_dpp v154, v72, v72 row_ror:1 row_mask:0xf bank_mask:0xf
  v_mov_b32 v74, 1073741824
  v_cmp_eq_u32 vcc, 0, v193
  s_nop 1
  v_cndmask_b32 v157, v74, 0, vcc
  s_waitcnt vmcnt(9)
  s_barrier
  ds_read_b128 v[160:163], v188 offset:0
  ds_read_b128 a[0:3], v184 offset:0
  ds_read_b128 a[4:7], v184 offset:4096
  ds_read_b64_tr_b16 v[164:165], v192 offset:24576
  ds_read_b64_tr_b16 v[166:167], v192 offset:25088
  s_waitcnt lgkmcnt(3)
  v_mfma_f32_32x32x16_bf16 v[0:15], a[0:3], v[160:163], 0
  ds_read_b128 v[168:171], v189 offset:0
  ds_read_b128 a[8:11], v185 offset:0
  s_add_u32 s45, s35, 2
  s_and_b32 s45, s45, 7
  s_lshl_b32 s46, s45, 7
  s_add_u32 s47, s42, s46
  s_add_u32 m0, s51, 65536
  s_nop 0
  buffer_load_dwordx4 v196, s[8:11], s47 offen offset:0 lds
  s_waitcnt lgkmcnt(4)
  v_mfma_f32_32x32x16_bf16 v[16:31], a[4:7], v[160:163], 0
  ds_read_b128 a[12:15], v185 offset:4096
  ds_read_b64_tr_b16 v[172:173], v192 offset:26624
  s_waitcnt vmcnt(9)
  v_readfirstlane_b32 s36, v114
  s_nop 0
  s_cmp_eq_u32 s36, 0
  s_cbranch_scc1 FZL_nps2
FZL_npr3:
  s_waitcnt lgkmcnt(4)
  v_mfma_f32_32x32x16_bf16 v[32:47], v[164:167], a[0:3], 0
  ds_read_b64_tr_b16 v[174:175], v192 offset:27136
  buffer_load_dwordx4 v197, s[8:11], s47 offen offset:1024 lds
  v_mov_b32 v153, s36
  v_mov_b32 v155, s36
  v_mov_b32 v252, s36
  buffer_store_dwordx2 v[152:153], v156, s[20:23], s96 offen sc1
  buffer_store_dwordx2 v[154:155], v157, s[20:23], s97 offen sc1
  v_mfma_f32_32x32x16_bf16 v[48:63], v[164:167], a[4:7], 0
  buffer_load_dwordx4 v198, s[8:11], s47 offen offset:2048 lds
  v_lshrrev_b32 v121, 5, v193
  s_lshl_b32 s48, s32, 1
  s_lshl_b32 s48, 8, s48
  v_mul_u32_u24 v116, s48, v121
  s_waitcnt lgkmcnt(3)
  v_mfma_f32_32x32x16_bf16 v[0:15], a[8:11], v[168:171], v[0:15]
  ds_read_b128 v[160:163], v190 offset:0
  ds_read_b128 a[16:19], v186 offset:0
  s_cmp_eq_u32 s32, 3
  s_cselect_b64 s[60:61], -1, 0
  s_cselect_b32 s62, -1, 0
  s_mov_b32 s63, 0
  v_mul_u32_u24 v122, 511, v121
  s_waitcnt lgkmcnt(4)
  v_mfma_f32_32x32x16_bf16 v[16:31], a[12:15], v[168:171], v[16:31]
  ds_read_b128 a[20:23], v186 offset:4096
  ds_read_b64_tr_b16 v[164:165], v192 offset:28672
  buffer_load_dwordx4 v199, s[8:11], s47 offen offset:3072 lds
  v_add_u32 v122, 1, v122
  v_cndmask_b32 v122, v116, v122, s[60:61]
  v_cvt_f32_u32 v122, v122
  s_lshl_b32 s48, s48, 1
  s_waitcnt lgkmcnt(4)
  v_mfma_f32_32x32x16_bf16 v[32:47], v[172:175], a[8:11], v[32:47]
  ds_read_b64_tr_b16 v[166:167], v192 offset:29184
  s_add_u32 s47, s43, s46
  s_add_u32 m0, s52, 81920
  s_nop 0
  buffer_load_dwordx4 v204, s[24:27], s47 offen offset:0 lds
  v_add_u32 v116, s48, v116
  v_cndmask_b32 v116, v116, 1, s[60:61]
  v_mfma_f32_32x32x16_bf16 v[48:63], v[172:175], a[12:15], v[48:63]
  v_cvt_f32_u32 v116, v116
  v_bfe_u32 v125, v193, 4, 1
  v_lshlrev_b32 v125, 11, v125
  v_lshl_add_u32 v125, v121, 7, v125
  v_and_b32 v121, 15, v193
  v_lshl_add_u32 v125, v121, 3, v125
  s_lshl_b32 s48, s32, 9
  s_waitcnt lgkmcnt(3)
  v_mfma_f32_32x32x16_bf16 v[0:15], a[16:19], v[160:163], v[0:15]
  ds_read_b128 v[168:171], v191 offset:0
  ds_read_b128 a[24:27], v187 offset:0
  buffer_load_dwordx4 v205, s[24:27], s47 offen offset:1024 lds
  s_add_u32 s48, s48, 133376
  v_add_u32 v125, s48, v125
  v_lshlrev_b32 v119, 16, v108
  v_lshlrev_b32 v120, 16, v109
  s_waitcnt lgkmcnt(4)
  v_mfma_f32_32x32x16_bf16 v[16:31], a[20:23], v[160:163], v[16:31]
  ds_read_b128 a[28:31], v187 offset:4096
  ds_read_b64_tr_b16 v[172:173], v192 offset:30720
  s_mul_i32 s47, s45, 229376
  s_add_u32 s47, s47, s44
  s_add_u32 m0, s52, 90112
  s_nop 0
  buffer_load_dwordx4 v200, s[12:15], s47 offen offset:0 lds
  s_waitcnt lgkmcnt(4)
  v_mfma_f32_32x32x16_bf16 v[32:47], v[164:167], a[16:19], v[32:47]
  ds_read_b64_tr_b16 v[174:175], v192 offset:31232
  v_lshlrev_b32 v121, 16, v110
  v_mul_f32 v121, 0x3fb8aa3b, v121
  v_exp_f32 v121, v121
  s_nop 0
  v_cvt_pk_bf16_f32 v121, v121, v121
  v_mfma_f32_32x32x16_bf16 v[48:63], v[164:167], a[20:23], v[48:63]
  buffer_load_dwordx4 v201, s[12:15], s47 offen offset:1024 lds
  v_lshlrev_b32 v121, 16, v121
  v_mul_f32 v117, v121, v119
  v_mul_f32 v118, v121, v120
  v_mul_f32 v117, 0x3fb8aa3b, v117
  v_mul_f32 v118, 0x3e22f983, v118
  v_mul_f32 v126, v122, v117
  s_waitcnt lgkmcnt(3)
  v_mfma_f32_32x32x16_bf16 v[0:15], a[24:27], v[168:171], v[0:15]
  s_waitcnt vmcnt(10)
  s_waitcnt lgkmcnt(0)
  s_barrier
  ds_read_b128 v[160:163], v188 offset:32768
  ds_read_b128 a[32:35], v184 offset:32768
  s_mul_i32 s47, s41, 229376
  s_add_u32 s47, s47, s44
  s_add_u32 m0, s52, 147456
  s_nop 0
  buffer_load_dwordx4 v200, s[4:7], s47 offen offset:0 lds
  v_mfma_f32_32x32x16_bf16 v[16:31], a[28:31], v[168:171], v[16:31]
  ds_read_b128 a[36:39], v184 offset:36864
  ds_read_b64_tr_b16 v[164:165], v192 offset:57344
  v_mul_f32 v127, v122, v118
  v_exp_f32 v126, v126
  v_fract_f32 v127, v127
  v_mfma_f32_32x32x16_bf16 v[32:47], v[172:175], a[24:27], v[32:47]
  ds_read_b64_tr_b16 v[166:167], v192 offset:57856
  buffer_load_dwordx4 v201, s[4:7], s47 offen offset:1024 lds
  v_cos_f32 v121, v127
  v_sin_f32 v123, v127
  v_mul_f32 v148, v126, v121
  v_mfma_f32_32x32x16_bf16 v[48:63], v[172:175], a[28:31], v[48:63]
  v_mul_f32 v149, v126, v123
  ds_write_b64 v125, v[148:149] offset:0
  v_mul_f32 v126, v116, v117
  v_mul_f32 v127, v116, v118
  v_exp_f32 v126, v126
  v_fract_f32 v127, v127
  s_waitcnt lgkmcnt(4)
  v_mfma_f32_32x32x16_bf16 v[0:15], a[32:35], v[160:163], v[0:15]
  ds_read_b128 v[168:171], v189 offset:32768
  ds_read_b128 a[40:43], v185 offset:32768
  s_add_u32 s45, s35, 3
  s_and_b32 s45, s45, 7
  s_lshl_b32 s46, s45, 7
  s_add_u32 s47, s42, s46
  s_add_u32 m0, s51, 98304
  s_nop 0
  buffer_load_dwordx4 v196, s[8:11], s47 offen offset:0 lds
  s_waitcnt lgkmcnt(5)
  v_mfma_f32_32x32x16_bf16 v[16:31], a[36:39], v[160:163], v[16:31]
  ds_read_b128 a[44:47], v185 offset:36864
  ds_read_b64_tr_b16 v[172:173], v192 offset:59392
  buffer_load_dwordx4 v197, s[8:11], s47 offen offset:1024 lds
  v_cos_f32 v121, v127
  v_sin_f32 v123, v127
  s_waitcnt lgkmcnt(5)
  v_mfma_f32_32x32x16_bf16 v[32:47], v[164:167], a[32:35], v[32:47]
  ds_read_b64_tr_b16 v[174:175], v192 offset:59904
  v_mul_f32 v148, v126, v121
  v_mul_f32 v149, v126, v123
  v_add_f32 v121, -1.0, v148
  v_mul_f32 v122, v119, v119
  v_fma_f32 v122, v120, v120, v122
  v_mfma_f32_32x32x16_bf16 v[48:63], v[164:167], a[36:39], v[48:63]
  buffer_load_dwordx4 v198, s[8:11], s47 offen offset:2048 lds
  v_rcp_f32 v122, v122
  v_mul_f32 v123, v121, v119
  v_fma_f32 v123, v149, v120, v123
  v_mul_f32 v124, v149, v119
  v_fma_f32 v124, -v121, v120, v124
  s_waitcnt lgkmcnt(3)
  v_mfma_f32_32x32x16_bf16 v[0:15], a[40:43], v[168:171], v[0:15]
  ds_read_b128 v[160:163], v190 offset:32768
  ds_read_b128 a[48:51], v186 offset:32768
  buffer_load_dwordx4 v199, s[8:11], s47 offen offset:3072 lds
  v_add_f32 v122, v122, v122
  v_mul_f32 v123, v123, v122
  v_mul_f32 v124, v124, v122
  v_cndmask_b32 v148, v148, v123, s[62:63]
  s_waitcnt lgkmcnt(4)
  v_mfma_f32_32x32x16_bf16 v[16:31], a[44:47], v[168:171], v[16:31]
  ds_read_b128 a[52:55], v186 offset:36864
  ds_read_b64_tr_b16 v[164:165], v192 offset:61440
  v_cndmask_b32 v149, v149, v124, s[62:63]
  ds_write_b64 v125, v[148:149] offset:256
  s_waitcnt lgkmcnt(5)
  v_mfma_f32_32x32x16_bf16 v[32:47], v[172:175], a[40:43], v[32:47]
  ds_read_b64_tr_b16 v[166:167], v192 offset:61952
  s_add_u32 s47, s43, s46
  s_add_u32 m0, s52, 114688
  s_nop 0
  buffer_load_dwordx4 v204, s[24:27], s47 offen offset:0 lds
  v_mfma_f32_32x32x16_bf16 v[48:63], v[172:175], a[44:47], v[48:63]
  buffer_load_dwordx4 v205, s[24:27], s47 offen offset:1024 lds
  s_waitcnt lgkmcnt(4)
  v_mfma_f32_32x32x16_bf16 v[0:15], a[48:51], v[160:163], v[0:15]
  ds_read_b128 v[168:171], v191 offset:32768
  ds_read_b128 a[56:59], v187 offset:32768
  s_waitcnt lgkmcnt(5)
  v_mfma_f32_32x32x16_bf16 v[16:31], a[52:55], v[160:163], v[16:31]
  ds_read_b128 a[60:63], v187 offset:36864
  ds_read_b64_tr_b16 v[172:173], v192 offset:63488
  s_mul_i32 s47, s45, 229376
  s_add_u32 s47, s47, s44
  s_add_u32 m0, s52, 122880
  s_nop 0
  buffer_load_dwordx4 v200, s[12:15], s47 offen offset:0 lds
  s_waitcnt lgkmcnt(4)
  v_mfma_f32_32x32x16_bf16 v[32:47], v[164:167], a[48:51], v[32:47]
  ds_read_b64_tr_b16 v[174:175], v192 offset:64000
  v_mfma_f32_32x32x16_bf16 v[48:63], v[164:167], a[52:55], v[48:63]
  buffer_load_dwordx4 v201, s[12:15], s47 offen offset:1024 lds
  s_waitcnt lgkmcnt(3)
  v_mfma_f32_32x32x16_bf16 v[0:15], a[56:59], v[168:171], v[0:15]
  s_waitcnt vmcnt(10)
  s_waitcnt lgkmcnt(0)
  s_barrier
  v_add_u32 v188, 65536, v188
  ds_read_b128 v[160:163], v188 offset:0
  v_add_u32 v184, 65536, v184
  ds_read_b128 a[64:67], v184 offset:0
  s_add_u32 s45, s35, 4
  s_and_b32 s45, s45, 7
  s_lshl_b32 s46, s45, 7
  s_add_u32 s47, s42, s46
  s_add_u32 m0, s51, 0
  s_nop 0
  buffer_load_dwordx4 v196, s[8:11], s47 offen offset:0 lds
  v_mfma_f32_32x32x16_bf16 v[16:31], a[60:63], v[168:171], v[16:31]
  ds_read_b128 a[68:71], v184 offset:4096
  v_add_u32 v192, 65536, v192
  ds_read_b64_tr_b16 v[164:165], v192 offset:24576
  v_mfma_f32_32x32x16_bf16 v[32:47], v[172:175], a[56:59], v[32:47]
  ds_read_b64_tr_b16 v[166:167], v192 offset:25088
  v_mfma_f32_32x32x16_bf16 v[48:63], v[172:175], a[60:63], v[48:63]
  buffer_load_dwordx4 v197, s[8:11], s47 offen offset:1024 lds
  s_waitcnt lgkmcnt(3)
  v_mfma_f32_32x32x16_bf16 v[0:15], a[64:67], v[160:163], v[0:15]
  v_add_u32 v189, 65536, v189
  ds_read_b128 v[168:171], v189 offset:0
  v_add_u32 v185, 65536, v185
  ds_read_b128 a[72:75], v185 offset:0
  buffer_load_dwordx4 v198, s[8:11], s47 offen offset:2048 lds
  s_waitcnt lgkmcnt(4)
  v_mfma_f32_32x32x16_bf16 v[16:31], a[68:71], v[160:163], v[16:31]
  ds_read_b128 a[76:79], v185 offset:4096
  ds_read_b64_tr_b16 v[172:173], v192 offset:26624
  s_waitcnt lgkmcnt(4)
  v_mfma_f32_32x32x16_bf16 v[32:47], v[164:167], a[64:67], v[32:47]
  ds_read_b64_tr_b16 v[174:175], v192 offset:27136
  v_mfma_f32_32x32x16_bf16 v[48:63], v[164:167], a[68:71], v[48:63]
  buffer_load_dwordx4 v199, s[8:11], s47 offen offset:3072 lds
  s_waitcnt lgkmcnt(3)
  v_mfma_f32_32x32x16_bf16 v[0:15], a[72:75], v[168:171], v[0:15]
  v_add_u32 v190, 65536, v190
  ds_read_b128 v[160:163], v190 offset:0
  v_add_u32 v186, 65536, v186
  ds_read_b128 a[80:83], v186 offset:0
  s_add_u32 s47, s43, s46
  s_add_u32 m0, s52, 16384
  s_nop 0
  buffer_load_dwordx4 v204, s[24:27], s47 offen offset:0 lds
  s_waitcnt lgkmcnt(4)
  v_mfma_f32_32x32x16_bf16 v[16:31], a[76:79], v[168:171], v[16:31]
  ds_read_b128 a[84:87], v186 offset:4096
  ds_read_b64_tr_b16 v[164:165], v192 offset:28672
  s_waitcnt lgkmcnt(4)
  v_mfma_f32_32x32x16_bf16 v[32:47], v[172:175], a[72:75], v[32:47]
  ds_read_b64_tr_b16 v[166:167], v192 offset:29184
  v_mfma_f32_32x32x16_bf16 v[48:63], v[172:175], a[76:79], v[48:63]
  buffer_load_dwordx4 v205, s[24:27], s47 offen offset:1024 lds
  s_waitcnt lgkmcnt(3)
  v_mfma_f32_32x32x16_bf16 v[0:15], a[80:83], v[160:163], v[0:15]
  v_add_u32 v191, 65536, v191
  ds_read_b128 v[168:171], v191 offset:0
  v_add_u32 v187, 65536, v187
  ds_read_b128 a[88:91], v187 offset:0
  s_mul_i32 s47, s45, 229376
  s_add_u32 s47, s47, s44
  s_add_u32 m0, s52, 24576
  s_nop 0
  buffer_load_dwordx4 v200, s[12:15], s47 offen offset:0 lds
  s_waitcnt lgkmcnt(4)
  v_mfma_f32_32x32x16_bf16 v[16:31], a[84:87], v[160:163], v[16:31]
  ds_read_b128 a[92:95], v187 offset:4096
  ds_read_b64_tr_b16 v[172:173], v192 offset:30720
  s_waitcnt lgkmcnt(4)
  v_mfma_f32_32x32x16_bf16 v[32:47], v[164:167], a[80:83], v[32:47]
  ds_read_b64_tr_b16 v[174:175], v192 offset:31232
  v_mfma_f32_32x32x16_bf16 v[48:63], v[164:167], a[84:87], v[48:63]
  buffer_load_dwordx4 v201, s[12:15], s47 offen offset:1024 lds
  s_waitcnt lgkmcnt(3)
  v_mfma_f32_32x32x16_bf16 v[0:15], a[88:91], v[168:171], v[0:15]
  s_waitcnt vmcnt(8)
  s_waitcnt lgkmcnt(0)
  s_barrier
  ds_read_b128 v[160:163], v188 offset:32768
  ds_read_b128 a[96:99], v184 offset:32768
  s_add_u32 s45, s35, 5
  s_and_b32 s45, s45, 7
  s_lshl_b32 s46, s45, 7
  s_add_u32 s47, s42, s46
  s_add_u32 m0, s51, 32768
  s_nop 0
  buffer_load_dwordx4 v196, s[8:11], s47 offen offset:0 lds
  v_mfma_f32_32x32x16_bf16 v[16:31], a[92:95], v[168:171], v[16:31]
  ds_read_b128 a[100:103], v184 offset:36864
  ds_read_b64_tr_b16 v[164:165], v192 offset:57344
  v_mov_b32 v128, 0x3f803f80
  v_mov_b32 v129, 0x3f803f80
  v_mov_b32 v130, 0x3f803f80
  v_mov_b32 v131, 0x3f803f80
  v_mfma_f32_32x32x16_bf16 v[32:47], v[172:175], a[88:91], v[32:47]
  ds_read_b64_tr_b16 v[166:167], v192 offset:57856
  ds_read_b64_tr_b16 v[112:113], v195 offset:0
  ds_read_b64_tr_b16 v[114:115], v195 offset:512
  ds_read_b64_tr_b16 v[116:117], v195 offset:2048
  ds_read_b64_tr_b16 v[118:119], v195 offset:2560
  ds_read_b64_tr_b16 v[120:121], v195 offset:4096
  ds_read_b64_tr_b16 v[122:123], v195 offset:4608
  v_mfma_f32_32x32x16_bf16 v[48:63], v[172:175], a[92:95], v[48:63]
  buffer_load_dwordx4 v197, s[8:11], s47 offen offset:1024 lds
  ds_read_b64_tr_b16 v[124:125], v195 offset:6144
  ds_read_b64_tr_b16 v[126:127], v195 offset:6656
  v_lshlrev_b32 v134, 3, v193
  v_mov_b32 v135, 1073741824
  v_cndmask_b32 v134, v134, v135, s[56:57]
  s_and_b32 s48, s33, 1
  s_waitcnt lgkmcnt(11)
  v_mfma_f32_32x32x16_bf16 v[0:15], a[96:99], v[160:163], v[0:15]
  ds_read_b128 v[168:171], v189 offset:32768
  ds_read_b128 a[104:107], v185 offset:32768
  buffer_load_dwordx4 v198, s[8:11], s47 offen offset:2048 lds
  s_mul_i32 s48, s48, 114688
  s_lshl_b32 s49, s101, 5
  s_add_u32 s48, s48, s49
  s_lshl_b32 s49, s41, 9
  s_waitcnt lgkmcnt(12)
  v_mfma_f32_32x32x16_bf16 v[16:31], a[100:103], v[160:163], v[16:31]
  ds_read_b128 a[108:111], v185 offset:36864
  ds_read_b64_tr_b16 v[172:173], v192 offset:59392
  s_add_u32 s48, s48, s49
  s_lshl_b32 s49, s37, 8
  s_add_u32 s48, s48, s49
  s_add_u32 s96, s48, 12713984
  s_waitcnt lgkmcnt(12)
  v_mfma_f32_32x32x16_bf16 v[32:47], v[164:167], a[96:99], v[32:47]
  ds_read_b64_tr_b16 v[174:175], v192 offset:59904
  s_cmp_eq_u32 s38, 0
  s_cselect_b32 s96, s96, 1073741824
  v_mov_b32 v133, s36
  s_waitcnt lgkmcnt(11)
  v_mfma_f32_32x32x16_bf16 v[96:111], v[128:131], v[112:115], 0
  v_mfma_f32_32x32x16_bf16 v[48:63], v[164:167], a[100:103], v[48:63]
  buffer_load_dwordx4 v199, s[8:11], s47 offen offset:3072 lds
  s_waitcnt lgkmcnt(9)
  v_mfma_f32_32x32x16_bf16 v[96:111], v[128:131], v[116:119], v[96:111]
  s_waitcnt lgkmcnt(7)
  v_mfma_f32_32x32x16_bf16 v[96:111], v[128:131], v[120:123], v[96:111]
  s_waitcnt lgkmcnt(5)
  v_mfma_f32_32x32x16_bf16 v[96:111], v[128:131], v[124:127], v[96:111]
  s_waitcnt lgkmcnt(3)
  v_mfma_f32_32x32x16_bf16 v[0:15], a[104:107], v[168:171], v[0:15]
  ds_read_b128 v[160:163], v190 offset:32768
  ds_read_b128 a[112:115], v186 offset:32768
  s_add_u32 s47, s43, s46
  s_add_u32 m0, s52, 49152
  s_nop 0
  buffer_load_dwordx4 v204, s[24:27], s47 offen offset:0 lds
  s_nop 3
  v_mov_b32 v132, v96
  s_waitcnt lgkmcnt(4)
  v_mfma_f32_32x32x16_bf16 v[16:31], a[108:111], v[168:171], v[16:31]
  ds_read_b128 a[116:119], v186 offset:36864
  ds_read_b64_tr_b16 v[164:165], v192 offset:61440
  buffer_store_dwordx2 v[132:133], v134, s[20:23], s96 offen sc1
  s_waitcnt lgkmcnt(4)
  v_mfma_f32_32x32x16_bf16 v[32:47], v[172:175], a[104:107], v[32:47]
  ds_read_b64_tr_b16 v[166:167], v192 offset:61952
  v_mfma_f32_32x32x16_bf16 v[48:63], v[172:175], a[108:111], v[48:63]
  buffer_load_dwordx4 v205, s[24:27], s47 offen offset:1024 lds
  s_waitcnt lgkmcnt(3)
  v_mfma_f32_32x32x16_bf16 v[0:15], a[112:115], v[160:163], v[0:15]
  ds_read_b128 v[168:171], v191 offset:32768
  ds_read_b128 a[120:123], v187 offset:32768
  s_mul_i32 s47, s45, 229376
  s_add_u32 s47, s47, s44
  s_add_u32 m0, s52, 57344
  s_nop 0
  buffer_load_dwordx4 v200, s[12:15], s47 offen offset:0 lds
  s_waitcnt lgkmcnt(4)
  v_mfma_f32_32x32x16_bf16 v[16:31], a[116:119], v[160:163], v[16:31]
  ds_read_b128 a[124:127], v187 offset:36864
  ds_read_b64_tr_b16 v[172:173], v192 offset:63488
  s_waitcnt lgkmcnt(4)
  v_mfma_f32_32x32x16_bf16 v[32:47], v[164:167], a[112:115], v[32:47]
  ds_read_b64_tr_b16 v[174:175], v192 offset:64000
  v_mfma_f32_32x32x16_bf16 v[48:63], v[164:167], a[116:119], v[48:63]
  buffer_load_dwordx4 v201, s[12:15], s47 offen offset:1024 lds
  s_waitcnt lgkmcnt(3)
  v_mfma_f32_32x32x16_bf16 v[0:15], a[120:123], v[168:171], v[0:15]
  s_waitcnt vmcnt(9)
  s_waitcnt lgkmcnt(0)
  s_barrier
  v_subrev_u32 v188, 65536, v188
  ds_read_b128 v[160:163], v188 offset:0
  v_subrev_u32 v184, 65536, v184
  ds_read_b128 a[128:131], v184 offset:0
  s_add_u32 s45, s35, 6
  s_and_b32 s45, s45, 7
  s_lshl_b32 s46, s45, 7
  s_add_u32 s47, s42, s46
  s_add_u32 m0, s51, 65536
  s_nop 0
  buffer_load_dwordx4 v196, s[8:11], s47 offen offset:0 lds
  v_mfma_f32_32x32x16_bf16 v[16:31], a[124:127], v[168:171], v[16:31]
  ds_read_b128 a[132:135], v184 offset:4096
  v_subrev_u32 v192, 65536, v192
  ds_read_b64_tr_b16 v[164:165], v192 offset:24576
  v_mfma_f32_32x32x16_bf16 v[32:47], v[172:175], a[120:123], v[32:47]
  ds_read_b64_tr_b16 v[166:167], v192 offset:25088
  v_mfma_f32_32x32x16_bf16 v[48:63], v[172:175], a[124:127], v[48:63]
  buffer_load_dwordx4 v197, s[8:11], s47 offen offset:1024 lds
  s_waitcnt lgkmcnt(3)
  v_mfma_f32_32x32x16_bf16 v[0:15], a[128:131], v[160:163], v[0:15]
  v_subrev_u32 v189, 65536, v189
  ds_read_b128 v[168:171], v189 offset:0
  v_subrev_u32 v185, 65536, v185
  ds_read_b128 a[136:139], v185 offset:0
  buffer_load_dwordx4 v198, s[8:11], s47 offen offset:2048 lds
  s_waitcnt lgkmcnt(4)
  v_mfma_f32_32x32x16_bf16 v[16:31], a[132:135], v[160:163], v[16:31]
  ds_read_b128 a[140:143], v185 offset:4096
  ds_read_b64_tr_b16 v[172:173], v192 offset:26624
  s_waitcnt lgkmcnt(4)
  v_mfma_f32_32x32x16_bf16 v[32:47], v[164:167], a[128:131], v[32:47]
  ds_read_b64_tr_b16 v[174:175], v192 offset:27136
  v_mfma_f32_32x32x16_bf16 v[48:63], v[164:167], a[132:135], v[48:63]
  buffer_load_dwordx4 v199, s[8:11], s47 offen offset:3072 lds
  s_waitcnt lgkmcnt(3)
  v_mfma_f32_32x32x16_bf16 v[0:15], a[136:139], v[168:171], v[0:15]
  v_subrev_u32 v190, 65536, v190
  ds_read_b128 v[160:163], v190 offset:0
  v_subrev_u32 v186, 65536, v186
  ds_read_b128 a[144:147], v186 offset:0
  s_add_u32 s47, s43, s46
  s_add_u32 m0, s52, 81920
  s_nop 0
  buffer_load_dwordx4 v204, s[24:27], s47 offen offset:0 lds
  s_waitcnt lgkmcnt(4)
  v_mfma_f32_32x32x16_bf16 v[16:31], a[140:143], v[168:171], v[16:31]
  ds_read_b128 a[148:151], v186 offset:4096
  ds_read_b64_tr_b16 v[164:165], v192 offset:28672
  s_waitcnt lgkmcnt(4)
  v_mfma_f32_32x32x16_bf16 v[32:47], v[172:175], a[136:139], v[32:47]
  ds_read_b64_tr_b16 v[166:167], v192 offset:29184
  v_mfma_f32_32x32x16_bf16 v[48:63], v[172:175], a[140:143], v[48:63]
  buffer_load_dwordx4 v205, s[24:27], s47 offen offset:1024 lds
  s_waitcnt lgkmcnt(3)
  v_mfma_f32_32x32x16_bf16 v[0:15], a[144:147], v[160:163], v[0:15]
  v_subrev_u32 v191, 65536, v191
  ds_read_b128 v[168:171], v191 offset:0
  v_subrev_u32 v187, 65536, v187
  ds_read_b128 a[152:155], v187 offset:0
  s_mul_i32 s47, s45, 229376
  s_add_u32 s47, s47, s44
  s_add_u32 m0, s52, 90112
  s_nop 0
  buffer_load_dwordx4 v200, s[12:15], s47 offen offset:0 lds
  s_waitcnt lgkmcnt(4)
  v_mfma_f32_32x32x16_bf16 v[16:31], a[148:151], v[160:163], v[16:31]
  ds_read_b128 a[156:159], v187 offset:4096
  ds_read_b64_tr_b16 v[172:173], v192 offset:30720
  s_waitcnt lgkmcnt(4)
  v_mfma_f32_32x32x16_bf16 v[32:47], v[164:167], a[144:147], v[32:47]
  ds_read_b64_tr_b16 v[174:175], v192 offset:31232
  v_mfma_f32_32x32x16_bf16 v[48:63], v[164:167], a[148:151], v[48:63]
  buffer_load_dwordx4 v201, s[12:15], s47 offen offset:1024 lds
  s_waitcnt lgkmcnt(3)
  v_mfma_f32_32x32x16_bf16 v[0:15], a[152:155], v[168:171], v[0:15]
  s_waitcnt vmcnt(8)
  s_waitcnt lgkmcnt(0)
  s_barrier
  ds_read_b128 v[160:163], v188 offset:32768
  ds_read_b128 a[160:163], v184 offset:32768
  s_add_u32 s45, s35, 7
  s_and_b32 s45, s45, 7
  s_lshl_b32 s46, s45, 7
  s_add_u32 s47, s42, s46
  s_add_u32 m0, s51, 98304
  s_nop 0
  buffer_load_dwordx4 v196, s[8:11], s47 offen offset:0 lds
  v_mfma_f32_32x32x16_bf16 v[16:31], a[156:159], v[168:171], v[16:31]
  ds_read_b128 a[164:167], v184 offset:36864
  ds_read_b64_tr_b16 v[164:165], v192 offset:57344
  v_bfe_u32 v142, v193, 2, 1
  v_lshlrev_b32 v142, 4, v142
  v_and_b32 v143, 1, v193
  v_lshl_add_u32 v142, v143, 3, v142
  v_bfe_u32 v143, v193, 3, 2
  v_mfma_f32_32x32x16_bf16 v[32:47], v[172:175], a[152:155], v[32:47]
  ds_read_b64_tr_b16 v[166:167], v192 offset:57856
  v_lshl_add_u32 v142, v143, 1, v142
  v_bfe_u32 v143, v193, 1, 1
  v_add_u32 v142, v142, v143
  v_lshlrev_b32 v143, 3, v142
  s_lshl_b32 s48, s33, 10
  s_lshl_b32 s49, s37, 9
  v_mfma_f32_32x32x16_bf16 v[48:63], v[172:175], a[156:159], v[48:63]
  buffer_load_dwordx4 v197, s[8:11], s47 offen offset:1024 lds
  s_add_u32 s48, s48, s49
  s_add_u32 s96, s48, 12582912
  v_and_b32 v144, 31, v193
  v_lshlrev_b32 v144, 3, v144
  s_lshl_b32 s48, s34, 9
  s_lshl_b32 s49, s38, 8
  s_waitcnt lgkmcnt(3)
  v_mfma_f32_32x32x16_bf16 v[0:15], a[160:163], v[160:163], v[0:15]
  ds_read_b128 v[168:171], v189 offset:32768
  ds_read_b128 a[168:171], v185 offset:32768
  buffer_load_dwordx4 v198, s[8:11], s47 offen offset:2048 lds
  s_add_u32 s48, s48, s49
  s_add_u32 s97, s48, 12648448
  buffer_load_dwordx2 v[136:137], v143, s[20:23], s96 offen sc1
  buffer_load_dwordx2 v[138:139], v143, s[20:23], s96 offen offset:256 sc1
  s_waitcnt lgkmcnt(4)
  v_mfma_f32_32x32x16_bf16 v[16:31], a[164:167], v[160:163], v[16:31]
  ds_read_b128 a[172:175], v185 offset:36864
  ds_read_b64_tr_b16 v[172:173], v192 offset:59392
  buffer_load_dwordx2 v[140:141], v144, s[20:23], s97 offen sc1
  s_waitcnt lgkmcnt(4)
  v_mfma_f32_32x32x16_bf16 v[32:47], v[164:167], a[160:163], v[32:47]
  ds_read_b64_tr_b16 v[174:175], v192 offset:59904
  v_mfma_f32_32x32x16_bf16 v[48:63], v[164:167], a[164:167], v[48:63]
  buffer_load_dwordx4 v199, s[8:11], s47 offen offset:3072 lds
  s_waitcnt lgkmcnt(3)
  v_mfma_f32_32x32x16_bf16 v[0:15], a[168:171], v[168:171], v[0:15]
  ds_read_b128 v[160:163], v190 offset:32768
  ds_read_b128 a[176:179], v186 offset:32768
  s_add_u32 s47, s43, s46
  s_add_u32 m0, s52, 114688
  s_nop 0
  buffer_load_dwordx4 v204, s[24:27], s47 offen offset:0 lds
  s_waitcnt lgkmcnt(4)
  v_mfma_f32_32x32x16_bf16 v[16:31], a[172:175], v[168:171], v[16:31]
  ds_read_b128 a[180:183], v186 offset:36864
  ds_read_b64_tr_b16 v[164:165], v192 offset:61440
  s_waitcnt lgkmcnt(4)
  v_mfma_f32_32x32x16_bf16 v[32:47], v[172:175], a[168:171], v[32:47]
  ds_read_b64_tr_b16 v[166:167], v192 offset:61952
  v_mfma_f32_32x32x16_bf16 v[48:63], v[172:175], a[172:175], v[48:63]
  buffer_load_dwordx4 v205, s[24:27], s47 offen offset:1024 lds
  s_waitcnt lgkmcnt(3)
  v_mfma_f32_32x32x16_bf16 v[0:15], a[176:179], v[160:163], v[0:15]
  ds_read_b128 v[168:171], v191 offset:32768
  ds_read_b128 a[184:187], v187 offset:32768
  s_mul_i32 s47, s45, 229376
  s_add_u32 s47, s47, s44
  s_add_u32 m0, s52, 122880
  s_nop 0
  buffer_load_dwordx4 v200, s[12:15], s47 offen offset:0 lds
  s_waitcnt lgkmcnt(4)
  v_mfma_f32_32x32x16_bf16 v[16:31], a[180:183], v[160:163], v[16:31]
  ds_read_b128 a[188:191], v187 offset:36864
  ds_read_b64_tr_b16 v[172:173], v192 offset:63488
  s_waitcnt lgkmcnt(4)
  v_mfma_f32_32x32x16_bf16 v[32:47], v[164:167], a[176:179], v[32:47]
  ds_read_b64_tr_b16 v[174:175], v192 offset:64000
  v_mfma_f32_32x32x16_bf16 v[48:63], v[164:167], a[180:183], v[48:63]
  buffer_load_dwordx4 v201, s[12:15], s47 offen offset:1024 lds
  s_waitcnt lgkmcnt(3)
  v_mfma_f32_32x32x16_bf16 v[0:15], a[184:187], v[168:171], v[0:15]
  s_waitcnt vmcnt(11)
  s_waitcnt lgkmcnt(0)
  s_barrier
  v_add_u32 v188, 65536, v188
  ds_read_b128 v[160:163], v188 offset:0
  v_add_u32 v184, 65536, v184
  ds_read_b128 a[192:195], v184 offset:0
  s_add_u32 s45, s35, s32
  s_add_u32 s45, s45, 0
  s_and_b32 s45, s45, 7
  s_mul_i32 s47, s45, 229376
  s_add_u32 s47, s47, s101
  s_add_u32 m0, s53, 0
  s_nop 0
  buffer_load_dwordx4 v200, s[16:19], s47 offen offset:0 lds
  v_mfma_f32_32x32x16_bf16 v[16:31], a[188:191], v[168:171], v[16:31]
  ds_read_b128 a[196:199], v184 offset:4096
  v_add_u32 v192, 65536, v192
  ds_read_b64_tr_b16 v[164:165], v192 offset:24576
  s_mul_i32 s50, s37, 114688
  s_lshl_b32 s49, s101, 5
  s_add_u32 s50, s50, s49
  s_add_u32 s50, s50, 12713984
  v_mfma_f32_32x32x16_bf16 v[32:47], v[172:175], a[184:187], v[32:47]
  ds_read_b64_tr_b16 v[166:167], v192 offset:25088
  s_mov_b32 s62, s50
  buffer_load_dwordx4 v[96:99], v194, s[20:23], s62 offen offset:0 sc1
  buffer_load_dwordx4 v[100:103], v194, s[20:23], s62 offen offset:1024 sc1
  buffer_load_dwordx4 v[104:107], v194, s[20:23], s62 offen offset:2048 sc1
  buffer_load_dwordx4 v[108:111], v194, s[20:23], s62 offen offset:3072 sc1
  v_mfma_f32_32x32x16_bf16 v[48:63], v[172:175], a[188:191], v[48:63]
  buffer_load_dwordx4 v201, s[16:19], s47 offen offset:1024 lds
  s_waitcnt lgkmcnt(3)
  v_mfma_f32_32x32x16_bf16 v[0:15], a[192:195], v[160:163], v[0:15]
  v_add_u32 v189, 65536, v189
  ds_read_b128 v[168:171], v189 offset:0
  v_add_u32 v185, 65536, v185
  ds_read_b128 a[200:203], v185 offset:0
  buffer_load_dwordx4 v202, s[16:19], s47 offen offset:2048 lds
  s_waitcnt lgkmcnt(4)
  v_mfma_f32_32x32x16_bf16 v[16:31], a[196:199], v[160:163], v[16:31]
  ds_read_b128 a[204:207], v185 offset:4096
  ds_read_b64_tr_b16 v[172:173], v192 offset:26624
  s_waitcnt lgkmcnt(4)
  v_mfma_f32_32x32x16_bf16 v[32:47], v[164:167], a[192:195], v[32:47]
  ds_read_b64_tr_b16 v[174:175], v192 offset:27136
  v_mfma_f32_32x32x16_bf16 v[48:63], v[164:167], a[196:199], v[48:63]
  buffer_load_dwordx4 v203, s[16:19], s47 offen offset:3072 lds
  s_waitcnt lgkmcnt(3)
  v_mfma_f32_32x32x16_bf16 v[0:15], a[200:203], v[168:171], v[0:15]
  v_add_u32 v190, 65536, v190
  ds_read_b128 v[160:163], v190 offset:0
  v_add_u32 v186, 65536, v186
  ds_read_b128 a[208:211], v186 offset:0
  s_add_u32 s47, s47, 114688
  s_add_u32 m0, s53, 4096
  s_nop 0
  buffer_load_dwordx4 v200, s[16:19], s47 offen offset:0 lds
  s_waitcnt lgkmcnt(4)
  v_mfma_f32_32x32x16_bf16 v[16:31], a[204:207], v[168:171], v[16:31]
  ds_read_b128 a[212:215], v186 offset:4096
  ds_read_b64_tr_b16 v[164:165], v192 offset:28672
  s_waitcnt lgkmcnt(4)
  v_mfma_f32_32x32x16_bf16 v[32:47], v[172:175], a[200:203], v[32:47]
  ds_read_b64_tr_b16 v[166:167], v192 offset:29184
  v_mfma_f32_32x32x16_bf16 v[48:63], v[172:175], a[204:207], v[48:63]
  buffer_load_dwordx4 v201, s[16:19], s47 offen offset:1024 lds
  s_waitcnt lgkmcnt(3)
  v_mfma_f32_32x32x16_bf16 v[0:15], a[208:211], v[160:163], v[0:15]
  v_add_u32 v191, 65536, v191
  ds_read_b128 v[168:171], v191 offset:0
  v_add_u32 v187, 65536, v187
  ds_read_b128 a[216:219], v187 offset:0
  buffer_load_dwordx4 v202, s[16:19], s47 offen offset:2048 lds
  s_waitcnt lgkmcnt(4)
  v_mfma_f32_32x32x16_bf16 v[16:31], a[212:215], v[160:163], v[16:31]
  ds_read_b128 a[220:223], v187 offset:4096
  ds_read_b64_tr_b16 v[172:173], v192 offset:30720
  s_waitcnt lgkmcnt(4)
  v_mfma_f32_32x32x16_bf16 v[32:47], v[164:167], a[208:211], v[32:47]
  ds_read_b64_tr_b16 v[174:175], v192 offset:31232
  v_mfma_f32_32x32x16_bf16 v[48:63], v[164:167], a[212:215], v[48:63]
  buffer_load_dwordx4 v203, s[16:19], s47 offen offset:3072 lds
  s_waitcnt lgkmcnt(3)
  v_mfma_f32_32x32x16_bf16 v[0:15], a[216:219], v[168:171], v[0:15]
  s_waitcnt vmcnt(12)
  s_waitcnt lgkmcnt(0)
  s_barrier
  ds_read_b128 v[160:163], v188 offset:32768
  ds_read_b128 a[224:227], v184 offset:32768
  s_add_u32 s45, s35, s32
  s_add_u32 s45, s45, 4
  s_and_b32 s45, s45, 7
  s_mul_i32 s47, s45, 229376
  s_add_u32 s47, s47, s101
  s_add_u32 m0, s53, 32768
  s_nop 0
  buffer_load_dwordx4 v200, s[16:19], s47 offen offset:0 lds
  v_mfma_f32_32x32x16_bf16 v[16:31], a[220:223], v[168:171], v[16:31]
  ds_read_b128 a[228:231], v184 offset:36864
  ds_read_b64_tr_b16 v[164:165], v192 offset:57344
  v_cmp_ne_u32 s[60:61], s36, v137
  v_cmp_ne_u32 vcc, s36, v139
  s_nop 0
  s_or_b64 s[60:61], s[60:61], vcc
  v_mfma_f32_32x32x16_bf16 v[32:47], v[172:175], a[216:219], v[32:47]
  ds_read_b64_tr_b16 v[166:167], v192 offset:57856
  v_cmp_ne_u32 vcc, s36, v141
  s_nop 0
  s_or_b64 s[60:61], s[60:61], vcc
  s_cmp_lg_u64 s[60:61], 0
  s_cbranch_scc1 FZL_slow4
FZL_ret5:
  v_lshlrev_b32 v149, 2, v142
  v_mfma_f32_32x32x16_bf16 v[48:63], v[172:175], a[220:223], v[48:63]
  buffer_load_dwordx4 v201, s[16:19], s47 offen offset:1024 lds
  s_lshl_b32 s48, s37, 8
  s_add_u32 s48, s48, 131072
  v_add_u32 v149, s48, v149
  s_mov_b32 s49, 0xbfb8aa3b
  v_lshlrev_b32 v145, 16, v136
  v_and_b32 v146, 0xffff0000, v136
  s_waitcnt lgkmcnt(3)
  v_mfma_f32_32x32x16_bf16 v[0:15], a[224:227], v[160:163], v[0:15]
  ds_read_b128 v[168:171], v189 offset:32768
  ds_read_b128 a[232:235], v185 offset:32768
  buffer_load_dwordx4 v202, s[16:19], s47 offen offset:2048 lds
  v_xor_b32 v146, 0x80000000, v146
  v_rcp_f32 v147, v145
  v_mul_f32 v216, v145, v145
  s_waitcnt lgkmcnt(4)
  v_mfma_f32_32x32x16_bf16 v[16:31], a[228:231], v[160:163], v[16:31]
  ds_read_b128 a[236:239], v185 offset:36864
  ds_read_b64_tr_b16 v[172:173], v192 offset:59392
  v_lshrrev_b32 v148, 16, v146
  v_or_b32 v146, v146, v148
  v_cndmask_b32 v206, v146, 0, s[56:57]
  v_cndmask_b32 v207, v148, 0, s[56:57]
  v_mov_b32 v208, 0
  s_waitcnt lgkmcnt(4)
  v_mfma_f32_32x32x16_bf16 v[32:47], v[164:167], a[224:227], v[32:47]
  ds_read_b64_tr_b16 v[174:175], v192 offset:59904
  v_mov_b32 v209, 0
  v_mul_f32 v214, s49, v147
  ds_write_b32 v149, v147 offset:0
  v_lshlrev_b32 v145, 16, v138
  v_and_b32 v146, 0xffff0000, v138
  v_xor_b32 v146, 0x80000000, v146
  v_mfma_f32_32x32x16_bf16 v[48:63], v[164:167], a[228:231], v[48:63]
  buffer_load_dwordx4 v203, s[16:19], s47 offen offset:3072 lds
  v_rcp_f32 v147, v145
  v_mul_f32 v217, v145, v145
  v_lshrrev_b32 v148, 16, v146
  v_or_b32 v146, v146, v148
  v_cndmask_b32 v210, v146, 0, s[56:57]
  s_waitcnt lgkmcnt(4)
  v_mfma_f32_32x32x16_bf16 v[0:15], a[232:235], v[168:171], v[0:15]
  ds_read_b128 v[160:163], v190 offset:32768
  ds_read_b128 a[240:243], v186 offset:32768
  s_add_u32 s47, s47, 114688
  s_add_u32 m0, s53, 36864
  s_nop 0
  buffer_load_dwordx4 v200, s[16:19], s47 offen offset:0 lds
  v_cndmask_b32 v211, v148, 0, s[56:57]
  s_waitcnt lgkmcnt(5)
  v_mfma_f32_32x32x16_bf16 v[16:31], a[236:239], v[168:171], v[16:31]
  ds_read_b128 a[244:247], v186 offset:36864
  ds_read_b64_tr_b16 v[164:165], v192 offset:61440
  v_mov_b32 v212, 0
  v_mov_b32 v213, 0
  v_mul_f32 v215, s49, v147
  ds_write_b32 v149, v147 offset:128
  v_cvt_pk_bf16_f32 v145, v140, v140
  s_waitcnt lgkmcnt(6)
  v_mfma_f32_32x32x16_bf16 v[32:47], v[172:175], a[232:235], v[32:47]
  ds_read_b64_tr_b16 v[166:167], v192 offset:61952
  v_and_b32 v145, 0xffff0000, v145
  v_sub_f32 v146, v140, v145
  v_cvt_pk_bf16_f32 v147, v146, v146
  v_and_b32 v147, 0xffff0000, v147
  v_sub_f32 v146, v146, v147
  v_mfma_f32_32x32x16_bf16 v[48:63], v[172:175], a[236:239], v[48:63]
  buffer_load_dwordx4 v201, s[16:19], s47 offen offset:1024 lds
  v_cvt_pk_bf16_f32 v219, v146, 0
  v_lshrrev_b32 v145, 16, v145
  v_or_b32 v218, v145, v147
  v_mov_b32 v220, 0
  v_mov_b32 v221, 0
  s_waitcnt vmcnt(16)
  v_cmp_ne_u32 s[60:61], s36, v97
  s_waitcnt lgkmcnt(4)
  v_mfma_f32_32x32x16_bf16 v[0:15], a[240:243], v[160:163], v[0:15]
  ds_read_b128 v[168:171], v191 offset:32768
  ds_read_b128 a[248:251], v187 offset:32768
  buffer_load_dwordx4 v202, s[16:19], s47 offen offset:2048 lds
  v_cmp_ne_u32 vcc, s36, v99
  s_nop 0
  s_or_b64 s[60:61], s[60:61], vcc
  s_waitcnt lgkmcnt(5)
  v_mfma_f32_32x32x16_bf16 v[16:31], a[244:247], v[160:163], v[16:31]
  ds_read_b128 a[252:255], v187 offset:36864
  ds_read_b64_tr_b16 v[172:173], v192 offset:63488
  s_waitcnt vmcnt(16)
  v_cmp_ne_u32 vcc, s36, v101
  s_nop 0
  s_or_b64 s[60:61], s[60:61], vcc
  s_waitcnt lgkmcnt(4)
  v_mfma_f32_32x32x16_bf16 v[32:47], v[164:167], a[240:243], v[32:47]
  ds_read_b64_tr_b16 v[174:175], v192 offset:64000
  v_cmp_ne_u32 vcc, s36, v103
  s_nop 0
  s_or_b64 s[60:61], s[60:61], vcc
  s_waitcnt vmcnt(15)
  v_cmp_ne_u32 vcc, s36, v105
  s_nop 0
  s_or_b64 s[60:61], s[60:61], vcc
  v_mfma_f32_32x32x16_bf16 v[48:63], v[164:167], a[244:247], v[48:63]
  buffer_load_dwordx4 v203, s[16:19], s47 offen offset:3072 lds
  v_cmp_ne_u32 vcc, s36, v107
  s_nop 0
  s_or_b64 s[60:61], s[60:61], vcc
  s_waitcnt vmcnt(15)
  v_cmp_ne_u32 vcc, s36, v109
  s_nop 0
  s_or_b64 s[60:61], s[60:61], vcc
  s_waitcnt lgkmcnt(3)
  v_mfma_f32_32x32x16_bf16 v[0:15], a[248:251], v[168:171], v[0:15]
  v_cmp_ne_u32 vcc, s36, v111
  s_nop 0
  s_or_b64 s[60:61], s[60:61], vcc
  s_cmp_lg_u64 s[60:61], 0
  s_cbranch_scc1 FZL_slow6
FZL_ret7:
  v_add_f32 v96, v96, v100
  v_add_f32 v98, v98, v102
  v_add_f32 v104, v104, v108
  v_add_f32 v106, v106, v110
  v_add_f32 v96, v96, v104
  v_add_f32 v98, v98, v106
  s_nop 1
  v_permlane32_swap_b32 v96, v98
  v_add_f32 v96, v96, v98
  v_cvt_pk_bf16_f32 v112, v96, v96
  v_and_b32 v112, 0xffff0000, v112
  v_sub_f32 v113, v96, v112
  v_cvt_pk_bf16_f32 v114, v113, v113
  v_and_b32 v114, 0xffff0000, v114
  v_sub_f32 v113, v113, v114
  v_cvt_pk_bf16_f32 v117, v113, 0
  v_lshrrev_b32 v112, 16, v112
  v_or_b32 v116, v112, v114
  v_and_b32 v115, 31, v193
  v_lshlrev_b32 v115, 4, v115
  v_lshrrev_b32 v112, 5, v193
  v_lshl_add_u32 v115, v112, 3, v115
  s_lshl_b32 s48, s37, 9
  s_add_u32 s48, s48, 137472
  v_add_u32 v115, s48, v115
  ds_write_b64 v115, v[116:117]
  s_waitcnt vmcnt(8)
  s_waitcnt lgkmcnt(0)
  s_barrier
  v_subrev_u32 v192, 65536, v192
  ds_read_b64_tr_b16 v[160:161], v192 offset:0
  ds_read_b64_tr_b16 v[162:163], v192 offset:512
  v_mfma_f32_32x32x16_bf16 v[16:31], a[252:255], v[168:171], v[16:31]
  ds_read_b64_tr_b16 v[164:165], v192 offset:2048
  ds_read_b64_tr_b16 v[166:167], v192 offset:2560
  v_mfma_f32_32x32x16_bf16 v[32:47], v[172:175], a[248:251], v[32:47]
  v_lshlrev_b32 v100, 3, v194
  v_lshrrev_b32 v101, 2, v193
  v_lshlrev_b32 v101, 10, v101
  v_and_b32 v102, 3, v193
  v_lshl_add_u32 v101, v102, 8, v101
  s_lshl_b32 s45, s41, 2
  s_add_u32 s45, s45, s32
  s_lshr_b32 s46, s45, 3
  s_mul_i32 s46, s46, 458752
  s_and_b32 s45, s45, 7
  s_lshl_b32 s45, s45, 13
  s_add_u32 s45, s45, s46
  buffer_load_dword v255, v100, s[64:67], s45 offen
  v_mfma_f32_32x32x16_bf16 v[48:63], v[172:175], a[252:255], v[48:63]
  ds_read_b64_tr_b16 v[168:169], v192 offset:4096
  ds_read_b64_tr_b16 v[170:171], v192 offset:4608
  s_waitcnt lgkmcnt(4)
  v_mfma_f32_32x32x16_bf16 v[64:79], v[160:163], a[0:3], 0
  ds_read_b64_tr_b16 v[172:173], v192 offset:6144
  v_mfma_f32_32x32x16_bf16 v[0:15], v[206:209], v[218:221], v[0:15]
  v_mfma_f32_32x32x16_bf16 v[16:31], v[210:213], v[218:221], v[16:31]
  ds_read_b128 v[128:131], v224 offset:0
  ds_read_b128 v[132:135], v224 offset:16
  ds_read_b64 v[136:137], v222 offset:1536
  ds_read_b64 v[138:139], v222 offset:128
  ds_read_b64 v[140:141], v222 offset:256
  s_nop 5
  v_permlane16_swap_b32 v0, v1
  v_mfma_f32_32x32x16_bf16 v[80:95], v[160:163], a[4:7], 0
  ds_read_b64_tr_b16 v[174:175], v192 offset:6656
  v_permlane16_swap_b32 v2, v3
  v_permlane16_swap_b32 v4, v5
  v_permlane16_swap_b32 v6, v7
  v_permlane16_swap_b32 v8, v9
  v_permlane16_swap_b32 v10, v11
  s_waitcnt lgkmcnt(9)
  v_mfma_f32_32x32x16_bf16 v[64:79], v[164:167], a[8:11], v[64:79]
  ds_read_b64_tr_b16 v[160:161], v192 offset:8192
  v_permlane16_swap_b32 v12, v13
  v_permlane16_swap_b32 v14, v15
  s_waitcnt lgkmcnt(6)
  v_mul_f32 v0, v128, v0
  v_mul_f32 v1, v128, v1
  v_mul_f32 v2, v129, v2
  v_mul_f32 v3, v129, v3
  v_mul_f32 v4, v130, v4
  v_mul_f32 v5, v130, v5
  v_mfma_f32_32x32x16_bf16 v[80:95], v[164:167], a[12:15], v[80:95]
  ds_read_b64_tr_b16 v[162:163], v192 offset:8704
  v_mul_f32 v6, v131, v6
  v_mul_f32 v7, v131, v7
  s_waitcnt lgkmcnt(6)
  v_mul_f32 v8, v132, v8
  v_mul_f32 v9, v132, v9
  v_mul_f32 v10, v133, v10
  v_mul_f32 v11, v133, v11
  v_mul_f32 v12, v134, v12
  v_mul_f32 v13, v134, v13
  v_mul_f32 v14, v135, v14
  v_mul_f32 v15, v135, v15
  v_mfma_f32_32x32x16_bf16 v[64:79], v[168:171], a[16:19], v[64:79]
  ds_read_b64_tr_b16 v[164:165], v192 offset:10240
  s_waitcnt lgkmcnt(6)
  v_fma_f32 v142, v136, v0, v2
  v_fma_f32 v143, v136, v1, v3
  v_fma_f32 v142, -v137, v1, v142
  v_fmac_f32 v143, v137, v0
  v_fma_f32 v144, v136, v142, v4
  v_fma_f32 v145, v136, v143, v5
  v_fma_f32 v144, -v137, v143, v144
  v_fmac_f32 v145, v137, v142
  v_mfma_f32_32x32x16_bf16 v[80:95], v[168:171], a[20:23], v[80:95]
  ds_read_b64_tr_b16 v[166:167], v192 offset:10752
  v_fma_f32 v142, v136, v144, v6
  v_fma_f32 v143, v136, v145, v7
  v_fma_f32 v142, -v137, v145, v142
  v_fmac_f32 v143, v137, v144
  v_fma_f32 v144, v136, v142, v8
  v_fma_f32 v145, v136, v143, v9
  v_fma_f32 v144, -v137, v143, v144
  v_fmac_f32 v145, v137, v142
  v_fma_f32 v142, v136, v144, v10
  s_waitcnt lgkmcnt(4)
  v_mfma_f32_32x32x16_bf16 v[64:79], v[172:175], a[24:27], v[64:79]
  ds_read_b64_tr_b16 v[168:169], v192 offset:12288
  v_fma_f32 v143, v136, v145, v11
  v_fma_f32 v142, -v137, v145, v142
  v_fmac_f32 v143, v137, v144
  v_fma_f32 v144, v136, v142, v12
  v_fma_f32 v145, v136, v143, v13
  v_fma_f32 v144, -v137, v143, v144
  v_fmac_f32 v145, v137, v142
  v_fma_f32 v142, v136, v144, v14
  v_fma_f32 v143, v136, v145, v15
  v_mfma_f32_32x32x16_bf16 v[80:95], v[172:175], a[28:31], v[80:95]
  ds_read_b64_tr_b16 v[170:171], v192 offset:12800
  v_fma_f32 v142, -v137, v145, v142
  v_fmac_f32 v143, v137, v144
  v_mov_b32 v144, 0
  v_mov_b32 v145, 0
  v_mov_b32 v146, v142
  v_mov_b32 v147, v143
  v_cndmask_b32 v148, 1.0, v138, s[58:59]
  v_cndmask_b32 v149, 0, v139, s[58:59]
  v_permlane16_swap_b32 v144, v146
  s_waitcnt lgkmcnt(4)
  v_mfma_f32_32x32x16_bf16 v[64:79], v[160:163], a[32:35], v[64:79]
  ds_read_b64_tr_b16 v[172:173], v192 offset:14336
  s_lshl_b32 s45, s41, 2
  s_add_u32 s45, s45, s32
  s_lshr_b32 s46, s45, 3
  s_mul_i32 s46, s46, 458752
  s_and_b32 s45, s45, 7
  s_lshl_b32 s45, s45, 13
  s_add_u32 s45, s45, s46
  s_add_u32 s45, s45, 131072
  buffer_load_dword v255, v100, s[64:67], s45 offen
  v_permlane16_swap_b32 v145, v147
  v_mfma_f32_32x32x16_bf16 v[80:95], v[160:163], a[36:39], v[80:95]
  ds_read_b64_tr_b16 v[174:175], v192 offset:14848
  v_fmac_f32 v142, v138, v144
  v_fmac_f32 v143, v138, v145
  v_fma_f32 v142, -v139, v145, v142
  v_fmac_f32 v143, v139, v144
  v_mov_b32 v146, v142
  v_mov_b32 v147, v143
  v_mov_b32 v150, 0
  v_mov_b32 v151, 0
  v_permlane16_swap_b32 v142, v146
  s_waitcnt lgkmcnt(4)
  v_mfma_f32_32x32x16_bf16 v[64:79], v[164:167], a[40:43], v[64:79]
  ds_read_b64_tr_b16 v[160:161], v192 offset:16384
  v_permlane16_swap_b32 v143, v147
  v_permlane32_swap_b32 v150, v146
  s_nop 0
  v_permlane32_swap_b32 v151, v147
  v_fmac_f32 v146, v140, v150
  v_fmac_f32 v147, v140, v151
  v_fma_f32 v146, -v141, v151, v146
  v_fmac_f32 v147, v141, v150
  v_mfma_f32_32x32x16_bf16 v[80:95], v[164:167], a[44:47], v[80:95]
  ds_read_b64_tr_b16 v[162:163], v192 offset:16896
  v_fma_f32 v230, v148, v150, v144
  v_fma_f32 v231, v148, v151, v145
  v_fma_f32 v230, -v149, v151, v230
  v_fmac_f32 v231, v149, v150
  s_mov_b64 exec, s[56:57]
  ds_write_b64 v225, v[146:147] offset:768
  s_mov_b64 exec, -1
  v_and_b32 v246, 31, v193
  v_lshlrev_b32 v246, 3, v246
  s_lshl_b32 s48, s38, 8
  s_waitcnt lgkmcnt(5)
  v_mfma_f32_32x32x16_bf16 v[64:79], v[168:171], a[48:51], v[64:79]
  ds_read_b64_tr_b16 v[164:165], v192 offset:18432
  s_add_u32 s48, s48, 137472
  v_add_u32 v246, s48, v246
  ds_read_b64 v[244:245], v246
  v_mov_b32 v247, 0
  v_mov_b32 v246, 0
  s_waitcnt lgkmcnt(0)
  s_nop 0
  v_mfma_f32_32x32x16_bf16 v[32:47], v[244:247], v[206:209], v[32:47]
  v_mfma_f32_32x32x16_bf16 v[48:63], v[244:247], v[210:213], v[48:63]
  s_nop 10
  v_mul_f32 v152, v214, v32
  v_mfma_f32_32x32x16_bf16 v[80:95], v[168:171], a[52:55], v[80:95]
  ds_read_b64_tr_b16 v[166:167], v192 offset:18944
  v_mul_f32 v153, v214, v33
  v_mul_f32 v154, v214, v34
  v_mul_f32 v155, v214, v35
  v_mul_f32 v156, v214, v36
  v_mul_f32 v157, v214, v37
  v_mul_f32 v158, v214, v38
  v_mul_f32 v159, v214, v39
  v_exp_f32 v152, v152
  v_exp_f32 v153, v153
  v_mfma_f32_32x32x16_bf16 v[64:79], v[172:175], a[56:59], v[64:79]
  ds_read_b64_tr_b16 v[168:169], v192 offset:20480
  v_exp_f32 v154, v154
  v_exp_f32 v155, v155
  v_exp_f32 v156, v156
  v_exp_f32 v157, v157
  v_exp_f32 v158, v158
  v_mfma_f32_32x32x16_bf16 v[80:95], v[172:175], a[60:63], v[80:95]
  ds_read_b64_tr_b16 v[170:171], v192 offset:20992
  v_exp_f32 v159, v159
  v_fma_f32 v152, v216, v152, v216
  v_fma_f32 v153, v216, v153, v216
  v_fma_f32 v154, v216, v154, v216
  v_fma_f32 v155, v216, v155, v216
  v_fma_f32 v156, v216, v156, v216
  v_fma_f32 v157, v216, v157, v216
  v_fma_f32 v158, v216, v158, v216
  v_mfma_f32_32x32x16_bf16 v[64:79], v[160:163], a[64:67], v[64:79]
  ds_read_b64_tr_b16 v[172:173], v192 offset:22528
  v_fma_f32 v159, v216, v159, v216
  v_rcp_f32 v152, v152
  v_rcp_f32 v153, v153
  v_rcp_f32 v154, v154
  v_rcp_f32 v155, v155
  v_rcp_f32 v156, v156
  v_mfma_f32_32x32x16_bf16 v[80:95], v[160:163], a[68:71], v[80:95]
  ds_read_b64_tr_b16 v[174:175], v192 offset:23040
  v_rcp_f32 v157, v157
  v_rcp_f32 v158, v158
  v_rcp_f32 v159, v159
  v_mul_f32 v32, v32, v152
  v_mul_f32 v33, v33, v153
  v_mul_f32 v34, v34, v154
  v_mul_f32 v35, v35, v155
  v_mul_f32 v36, v36, v156
  s_waitcnt lgkmcnt(4)
  v_mfma_f32_32x32x16_bf16 v[64:79], v[164:167], a[72:75], v[64:79]
  ds_read_b64_tr_b16 v[160:161], v192 offset:24576
  v_mul_f32 v37, v37, v157
  v_mul_f32 v38, v38, v158
  v_mul_f32 v39, v39, v159
  v_mul_f32 v152, v214, v40
  v_mul_f32 v153, v214, v41
  v_mul_f32 v154, v214, v42
  v_mul_f32 v155, v214, v43
  v_mul_f32 v156, v214, v44
  v_mul_f32 v157, v214, v45
  v_mul_f32 v158, v214, v46
  v_mul_f32 v159, v214, v47
  v_mfma_f32_32x32x16_bf16 v[80:95], v[164:167], a[76:79], v[80:95]
  ds_read_b64_tr_b16 v[162:163], v192 offset:25088
  s_lshl_b32 s45, s41, 2
  s_add_u32 s45, s45, s32
  s_lshr_b32 s46, s45, 3
  s_mul_i32 s46, s46, 458752
  s_and_b32 s45, s45, 7
  s_lshl_b32 s45, s45, 13
  s_add_u32 s45, s45, s46
  s_add_u32 s45, s45, 262144
  buffer_load_dword v255, v100, s[64:67], s45 offen
  v_exp_f32 v152, v152
  s_waitcnt lgkmcnt(4)
  v_mfma_f32_32x32x16_bf16 v[64:79], v[168:171], a[80:83], v[64:79]
  ds_read_b64_tr_b16 v[164:165], v192 offset:26624
  v_exp_f32 v153, v153
  v_exp_f32 v154, v154
  v_exp_f32 v155, v155
  v_exp_f32 v156, v156
  v_exp_f32 v157, v157
  v_mfma_f32_32x32x16_bf16 v[80:95], v[168:171], a[84:87], v[80:95]
  ds_read_b64_tr_b16 v[166:167], v192 offset:27136
  v_exp_f32 v158, v158
  v_exp_f32 v159, v159
  v_fma_f32 v152, v216, v152, v216
  v_fma_f32 v153, v216, v153, v216
  v_fma_f32 v154, v216, v154, v216
  v_fma_f32 v155, v216, v155, v216
  v_fma_f32 v156, v216, v156, v216
  s_waitcnt lgkmcnt(4)
  v_mfma_f32_32x32x16_bf16 v[64:79], v[172:175], a[88:91], v[64:79]
  ds_read_b64_tr_b16 v[168:169], v192 offset:28672
  v_fma_f32 v157, v216, v157, v216
  v_fma_f32 v158, v216, v158, v216
  v_fma_f32 v159, v216, v159, v216
  v_rcp_f32 v152, v152
  v_rcp_f32 v153, v153
  v_rcp_f32 v154, v154
  v_mfma_f32_32x32x16_bf16 v[80:95], v[172:175], a[92:95], v[80:95]
  ds_read_b64_tr_b16 v[170:171], v192 offset:29184
  v_rcp_f32 v155, v155
  v_rcp_f32 v156, v156
  v_rcp_f32 v157, v157
  v_rcp_f32 v158, v158
  v_rcp_f32 v159, v159
  v_mul_f32 v40, v40, v152
  s_waitcnt lgkmcnt(4)
  v_mfma_f32_32x32x16_bf16 v[64:79], v[160:163], a[96:99], v[64:79]
  ds_read_b64_tr_b16 v[172:173], v192 offset:30720
  v_mul_f32 v41, v41, v153
  v_mul_f32 v42, v42, v154
  v_mul_f32 v43, v43, v155
  v_mul_f32 v44, v44, v156
  v_mul_f32 v45, v45, v157
  v_mul_f32 v46, v46, v158
  v_mul_f32 v47, v47, v159
  ds_read_b128 v[128:131], v224 offset:128
  ds_read_b128 v[132:135], v224 offset:144
  ds_read_b64 v[136:137], v222 offset:1536
  ds_read_b64 v[138:139], v222 offset:128
  v_mfma_f32_32x32x16_bf16 v[80:95], v[160:163], a[100:103], v[80:95]
  ds_read_b64_tr_b16 v[174:175], v192 offset:31232
  ds_read_b64 v[140:141], v222 offset:256
  v_permlane16_swap_b32 v16, v17
  v_permlane16_swap_b32 v18, v19
  v_permlane16_swap_b32 v20, v21
  v_permlane16_swap_b32 v22, v23
  v_permlane16_swap_b32 v24, v25
  s_waitcnt vmcnt(3)
  s_waitcnt lgkmcnt(0)
  s_barrier
  v_mfma_f32_32x32x16_bf16 v[64:79], v[164:167], a[104:107], v[64:79]
  ds_read_b64_tr_b16 v[160:161], v192 offset:32768
  v_permlane16_swap_b32 v26, v27
  v_permlane16_swap_b32 v28, v29
  v_permlane16_swap_b32 v30, v31
  v_mul_f32 v16, v128, v16
  v_mul_f32 v17, v128, v17
  v_mul_f32 v18, v129, v18
  v_mul_f32 v19, v129, v19
  v_mul_f32 v20, v130, v20
  v_mfma_f32_32x32x16_bf16 v[80:95], v[164:167], a[108:111], v[80:95]
  ds_read_b64_tr_b16 v[162:163], v192 offset:33280
  v_mul_f32 v21, v130, v21
  v_mul_f32 v22, v131, v22
  v_mul_f32 v23, v131, v23
  v_mul_f32 v24, v132, v24
  v_mul_f32 v25, v132, v25
  v_mul_f32 v26, v133, v26
  v_mul_f32 v27, v133, v27
  v_mul_f32 v28, v134, v28
  v_mul_f32 v29, v134, v29
  v_mul_f32 v30, v135, v30
  v_mul_f32 v31, v135, v31
  v_mfma_f32_32x32x16_bf16 v[64:79], v[168:171], a[112:115], v[64:79]
  ds_read_b64_tr_b16 v[164:165], v192 offset:34816
  v_fma_f32 v142, v136, v16, v18
  v_fma_f32 v143, v136, v17, v19
  v_fma_f32 v142, -v137, v17, v142
  v_fmac_f32 v143, v137, v16
  v_fma_f32 v144, v136, v142, v20
  v_fma_f32 v145, v136, v143, v21
  v_fma_f32 v144, -v137, v143, v144
  v_fmac_f32 v145, v137, v142
  v_fma_f32 v142, v136, v144, v22
  v_mfma_f32_32x32x16_bf16 v[80:95], v[168:171], a[116:119], v[80:95]
  ds_read_b64_tr_b16 v[166:167], v192 offset:35328
  v_fma_f32 v143, v136, v145, v23
  v_fma_f32 v142, -v137, v145, v142
  v_fmac_f32 v143, v137, v144
  v_fma_f32 v144, v136, v142, v24
  v_fma_f32 v145, v136, v143, v25
  v_fma_f32 v144, -v137, v143, v144
  v_fmac_f32 v145, v137, v142
  v_fma_f32 v142, v136, v144, v26
  v_fma_f32 v143, v136, v145, v27
  v_mfma_f32_32x32x16_bf16 v[64:79], v[172:175], a[120:123], v[64:79]
  ds_read_b64_tr_b16 v[168:169], v192 offset:36864
  s_lshl_b32 s45, s41, 2
  s_add_u32 s45, s45, s32
  s_lshr_b32 s46, s45, 3
  s_mul_i32 s46, s46, 458752
  s_and_b32 s45, s45, 7
  s_lshl_b32 s45, s45, 13
  s_add_u32 s45, s45, s46
  s_add_u32 s45, s45, 393216
  buffer_load_dword v255, v100, s[64:67], s45 offen
  v_fma_f32 v142, -v137, v145, v142
  v_fmac_f32 v143, v137, v144
  v_mfma_f32_32x32x16_bf16 v[80:95], v[172:175], a[124:127], v[80:95]
  ds_read_b64_tr_b16 v[170:171], v192 offset:37376
  v_fma_f32 v144, v136, v142, v28
  v_fma_f32 v145, v136, v143, v29
  v_fma_f32 v144, -v137, v143, v144
  v_fmac_f32 v145, v137, v142
  v_fma_f32 v142, v136, v144, v30
  v_fma_f32 v143, v136, v145, v31
  v_fma_f32 v142, -v137, v145, v142
  v_fmac_f32 v143, v137, v144
  v_mov_b32 v144, 0
  s_waitcnt lgkmcnt(4)
  v_mfma_f32_32x32x16_bf16 v[64:79], v[160:163], a[128:131], v[64:79]
  ds_read_b64_tr_b16 v[172:173], v192 offset:38912
  v_mov_b32 v145, 0
  v_mov_b32 v146, v142
  v_mov_b32 v147, v143
  v_cndmask_b32 v148, 1.0, v138, s[58:59]
  v_cndmask_b32 v149, 0, v139, s[58:59]
  v_permlane16_swap_b32 v144, v146
  v_permlane16_swap_b32 v145, v147
  v_fmac_f32 v142, v138, v144
  v_mfma_f32_32x32x16_bf16 v[80:95], v[160:163], a[132:135], v[80:95]
  ds_read_b64_tr_b16 v[174:175], v192 offset:39424
  v_fmac_f32 v143, v138, v145
  v_fma_f32 v142, -v139, v145, v142
  v_fmac_f32 v143, v139, v144
  v_mov_b32 v146, v142
  v_mov_b32 v147, v143
  v_mov_b32 v150, 0
  v_mov_b32 v151, 0
  v_permlane16_swap_b32 v142, v146
  v_permlane16_swap_b32 v143, v147
  s_waitcnt lgkmcnt(4)
  v_mfma_f32_32x32x16_bf16 v[64:79], v[164:167], a[136:139], v[64:79]
  ds_read_b64_tr_b16 v[160:161], v192 offset:40960
  v_permlane32_swap_b32 v150, v146
  v_permlane32_swap_b32 v151, v147
  v_fmac_f32 v146, v140, v150
  v_fmac_f32 v147, v140, v151
  v_fma_f32 v146, -v141, v151, v146
  v_fmac_f32 v147, v141, v150
  v_fma_f32 v232, v148, v150, v144
  v_fma_f32 v233, v148, v151, v145
  v_mfma_f32_32x32x16_bf16 v[80:95], v[164:167], a[140:143], v[80:95]
  ds_read_b64_tr_b16 v[162:163], v192 offset:41472
  v_fma_f32 v232, -v149, v151, v232
  v_fmac_f32 v233, v149, v150
  s_mov_b64 exec, s[56:57]
  ds_write_b64 v225, v[146:147] offset:1024
  s_mov_b64 exec, -1
  v_mul_f32 v152, v215, v48
  v_mul_f32 v153, v215, v49
  v_mul_f32 v154, v215, v50
  v_mul_f32 v155, v215, v51
  v_mul_f32 v156, v215, v52
  v_mul_f32 v157, v215, v53
  s_waitcnt lgkmcnt(5)
  v_mfma_f32_32x32x16_bf16 v[64:79], v[168:171], a[144:147], v[64:79]
  ds_read_b64_tr_b16 v[164:165], v192 offset:43008
  v_mul_f32 v158, v215, v54
  v_mul_f32 v159, v215, v55
  v_exp_f32 v152, v152
  v_exp_f32 v153, v153
  v_exp_f32 v154, v154
  v_exp_f32 v155, v155
  v_mfma_f32_32x32x16_bf16 v[80:95], v[168:171], a[148:151], v[80:95]
  ds_read_b64_tr_b16 v[166:167], v192 offset:43520
  v_exp_f32 v156, v156
  v_exp_f32 v157, v157
  v_exp_f32 v158, v158
  v_exp_f32 v159, v159
  v_fma_f32 v152, v217, v152, v217
  v_fma_f32 v153, v217, v153, v217
  s_waitcnt lgkmcnt(5)
  v_mfma_f32_32x32x16_bf16 v[64:79], v[172:175], a[152:155], v[64:79]
  ds_read_b64_tr_b16 v[168:169], v192 offset:45056
  v_fma_f32 v154, v217, v154, v217
  v_fma_f32 v155, v217, v155, v217
  v_fma_f32 v156, v217, v156, v217
  v_fma_f32 v157, v217, v157, v217
  v_fma_f32 v158, v217, v158, v217
  v_fma_f32 v159, v217, v159, v217
  v_rcp_f32 v152, v152
  v_mfma_f32_32x32x16_bf16 v[80:95], v[172:175], a[156:159], v[80:95]
  ds_read_b64_tr_b16 v[170:171], v192 offset:45568
  v_rcp_f32 v153, v153
  v_rcp_f32 v154, v154
  v_rcp_f32 v155, v155
  v_rcp_f32 v156, v156
  v_rcp_f32 v157, v157
  s_waitcnt lgkmcnt(5)
  v_mfma_f32_32x32x16_bf16 v[64:79], v[160:163], a[160:163], v[64:79]
  ds_read_b64_tr_b16 v[172:173], v192 offset:47104
  v_rcp_f32 v158, v158
  v_rcp_f32 v159, v159
  v_mul_f32 v48, v48, v152
  v_mul_f32 v49, v49, v153
  v_mul_f32 v50, v50, v154
  v_mul_f32 v51, v51, v155
  v_mul_f32 v52, v52, v156
  v_mul_f32 v53, v53, v157
  v_mul_f32 v54, v54, v158
  v_mfma_f32_32x32x16_bf16 v[80:95], v[160:163], a[164:167], v[80:95]
  ds_read_b64_tr_b16 v[174:175], v192 offset:47616
  s_lshl_b32 s45, s41, 2
  s_add_u32 s45, s45, s32
  s_lshl_b32 s45, s45, 14
  buffer_load_dword v255, v101, s[68:71], s45 offen
  v_mul_f32 v55, v55, v159
  v_mul_f32 v152, v215, v56
  v_mul_f32 v153, v215, v57
  v_mul_f32 v154, v215, v58
  v_mul_f32 v155, v215, v59
  v_mul_f32 v156, v215, v60
  v_mul_f32 v157, v215, v61
  s_waitcnt lgkmcnt(4)
  v_mfma_f32_32x32x16_bf16 v[64:79], v[164:167], a[168:171], v[64:79]
  ds_read_b64_tr_b16 v[160:161], v192 offset:49152
  v_mul_f32 v158, v215, v62
  v_mul_f32 v159, v215, v63
  v_exp_f32 v152, v152
  v_exp_f32 v153, v153
  v_exp_f32 v154, v154
  v_exp_f32 v155, v155
  v_mfma_f32_32x32x16_bf16 v[80:95], v[164:167], a[172:175], v[80:95]
  ds_read_b64_tr_b16 v[162:163], v192 offset:49664
  v_exp_f32 v156, v156
  v_exp_f32 v157, v157
  v_exp_f32 v158, v158
  v_exp_f32 v159, v159
  v_fma_f32 v152, v217, v152, v217
  v_fma_f32 v153, v217, v153, v217
  s_waitcnt lgkmcnt(4)
  v_mfma_f32_32x32x16_bf16 v[64:79], v[168:171], a[176:179], v[64:79]
  ds_read_b64_tr_b16 v[164:165], v192 offset:51200
  v_fma_f32 v154, v217, v154, v217
  v_fma_f32 v155, v217, v155, v217
  v_fma_f32 v156, v217, v156, v217
  v_fma_f32 v157, v217, v157, v217
  v_fma_f32 v158, v217, v158, v217
  v_fma_f32 v159, v217, v159, v217
  v_rcp_f32 v152, v152
  v_mfma_f32_32x32x16_bf16 v[80:95], v[168:171], a[180:183], v[80:95]
  ds_read_b64_tr_b16 v[166:167], v192 offset:51712
  v_rcp_f32 v153, v153
  v_rcp_f32 v154, v154
  v_rcp_f32 v155, v155
  v_rcp_f32 v156, v156
  v_rcp_f32 v157, v157
  s_waitcnt lgkmcnt(4)
  v_mfma_f32_32x32x16_bf16 v[64:79], v[172:175], a[184:187], v[64:79]
  ds_read_b64_tr_b16 v[168:169], v192 offset:53248
  v_rcp_f32 v158, v158
  v_rcp_f32 v159, v159
  v_mul_f32 v56, v56, v152
  v_mul_f32 v57, v57, v153
  v_mul_f32 v58, v58, v154
  v_mul_f32 v59, v59, v155
  v_mul_f32 v60, v60, v156
  v_mul_f32 v61, v61, v157
  v_mul_f32 v62, v62, v158
  v_mfma_f32_32x32x16_bf16 v[80:95], v[172:175], a[188:191], v[80:95]
  ds_read_b64_tr_b16 v[170:171], v192 offset:53760
  v_mul_f32 v63, v63, v159
  s_waitcnt lgkmcnt(4)
  v_mfma_f32_32x32x16_bf16 v[64:79], v[160:163], a[192:195], v[64:79]
  ds_read_b64_tr_b16 v[172:173], v192 offset:55296
  v_mfma_f32_32x32x16_bf16 v[80:95], v[160:163], a[196:199], v[80:95]
  ds_read_b64_tr_b16 v[174:175], v192 offset:55808
  s_waitcnt lgkmcnt(4)
  v_mfma_f32_32x32x16_bf16 v[64:79], v[164:167], a[200:203], v[64:79]
  ds_read_b64_tr_b16 v[160:161], v192 offset:57344
  v_mfma_f32_32x32x16_bf16 v[80:95], v[164:167], a[204:207], v[80:95]
  ds_read_b64_tr_b16 v[162:163], v192 offset:57856
  s_waitcnt lgkmcnt(4)
  v_mfma_f32_32x32x16_bf16 v[64:79], v[168:171], a[208:211], v[64:79]
  ds_read_b64_tr_b16 v[164:165], v192 offset:59392
  s_lshl_b32 s45, s41, 2
  s_add_u32 s45, s45, s32
  s_lshl_b32 s45, s45, 14
  buffer_load_dword v255, v101, s[84:87], s45 offen
  v_mfma_f32_32x32x16_bf16 v[80:95], v[168:171], a[212:215], v[80:95]
  ds_read_b64_tr_b16 v[166:167], v192 offset:59904
  s_waitcnt lgkmcnt(4)
  v_mfma_f32_32x32x16_bf16 v[64:79], v[172:175], a[216:219], v[64:79]
  ds_read_b64_tr_b16 v[168:169], v192 offset:61440
  v_mfma_f32_32x32x16_bf16 v[80:95], v[172:175], a[220:223], v[80:95]
  ds_read_b64_tr_b16 v[170:171], v192 offset:61952
  s_waitcnt lgkmcnt(4)
  v_mfma_f32_32x32x16_bf16 v[64:79], v[160:163], a[224:227], v[64:79]
  ds_read_b64_tr_b16 v[172:173], v192 offset:63488
  v_mfma_f32_32x32x16_bf16 v[80:95], v[160:163], a[228:231], v[80:95]
  ds_read_b64_tr_b16 v[174:175], v192 offset:64000
  s_waitcnt lgkmcnt(4)
  v_mfma_f32_32x32x16_bf16 v[64:79], v[164:167], a[232:235], v[64:79]
  v_mfma_f32_32x32x16_bf16 v[80:95], v[164:167], a[236:239], v[80:95]
  s_waitcnt lgkmcnt(2)
  v_mfma_f32_32x32x16_bf16 v[64:79], v[168:171], a[240:243], v[64:79]
  v_mfma_f32_32x32x16_bf16 v[80:95], v[168:171], a[244:247], v[80:95]
  s_waitcnt lgkmcnt(0)
  v_mfma_f32_32x32x16_bf16 v[64:79], v[172:175], a[248:251], v[64:79]
  v_mfma_f32_32x32x16_bf16 v[80:95], v[172:175], a[252:255], v[80:95]
  s_barrier
  ds_read_b64 v[240:241], v225 offset:0
  ds_read_b64 v[242:243], v225 offset:256
  ds_read_b64 v[244:245], v225 offset:512
  ds_read_b64 v[246:247], v225 offset:768
  ds_read_b64 v[248:249], v225 offset:1024
  ds_read_b64 v[250:251], v222 offset:640
  s_lshl_b32 s48, s34, 13
  s_lshl_b32 s49, s38, 12
  s_add_u32 s48, s48, s49
  s_add_u32 s96, s48, 13631488
  s_waitcnt lgkmcnt(0)
  v_fmac_f32 v242, v250, v240
  v_fmac_f32 v243, v250, v241
  v_fma_f32 v242, -v251, v241, v242
  v_fmac_f32 v243, v251, v240
  v_fma_f32 v234, v250, v242, v244
  v_fma_f32 v235, v250, v243, v245
  v_fma_f32 v234, -v251, v243, v234
  v_fmac_f32 v235, v251, v242
  v_fma_f32 v236, v250, v234, v246
  v_fma_f32 v237, v250, v235, v247
  v_fma_f32 v236, -v251, v235, v236
  v_fmac_f32 v237, v251, v234
  v_fmac_f32 v248, v250, v236
  v_fmac_f32 v249, v250, v237
  v_fma_f32 v248, -v251, v237, v248
  v_fmac_f32 v249, v251, v236
  v_mov_b32 v240, v248
  v_mov_b32 v241, s36
  v_mov_b32 v242, v249
  v_mov_b32 v243, s36
  buffer_store_dwordx4 v[240:243], v228, s[20:23], s96 offen sc1
  v_and_b32 v246, 31, v193
  v_lshlrev_b32 v246, 3, v246
  s_lshl_b32 s48, s38, 8
  s_add_u32 s48, s48, 137984
  v_add_u32 v246, s48, v246
  ds_read_b64 v[244:245], v246
  v_mov_b32 v247, 0
  v_mov_b32 v246, 0
  s_waitcnt lgkmcnt(0)
  s_nop 0
  v_mfma_f32_32x32x16_bf16 v[64:79], v[244:247], v[206:209], v[64:79]
  v_mfma_f32_32x32x16_bf16 v[80:95], v[244:247], v[210:213], v[80:95]
  s_nop 10
  v_mul_f32 v64, v64, v32
  v_mul_f32 v65, v65, v33
  v_mul_f32 v66, v66, v34
  v_mul_f32 v67, v67, v35
  v_mul_f32 v68, v68, v36
  v_mul_f32 v69, v69, v37
  v_mul_f32 v70, v70, v38
  v_mul_f32 v71, v71, v39
  v_cvt_pk_bf16_f32 v64, v64, v65
  v_cvt_pk_bf16_f32 v65, v66, v67
  v_cvt_pk_bf16_f32 v66, v68, v69
  v_cvt_pk_bf16_f32 v67, v70, v71
  s_mov_b32 s97, s55
  buffer_store_dwordx4 v[64:67], v194, s[20:23], s97 offen offset:0 sc1
  v_mul_f32 v72, v72, v40
  v_mul_f32 v73, v73, v41
  v_mul_f32 v74, v74, v42
  v_mul_f32 v75, v75, v43
  v_mul_f32 v76, v76, v44
  v_mul_f32 v77, v77, v45
  v_mul_f32 v78, v78, v46
  v_mul_f32 v79, v79, v47
  v_cvt_pk_bf16_f32 v72, v72, v73
  v_cvt_pk_bf16_f32 v73, v74, v75
  v_cvt_pk_bf16_f32 v74, v76, v77
  v_cvt_pk_bf16_f32 v75, v78, v79
  s_mov_b32 s97, s55
  buffer_store_dwordx4 v[72:75], v194, s[20:23], s97 offen offset:1024 sc1
  v_mul_f32 v80, v80, v48
  v_mul_f32 v81, v81, v49
  v_mul_f32 v82, v82, v50
  v_mul_f32 v83, v83, v51
  v_mul_f32 v84, v84, v52
  v_mul_f32 v85, v85, v53
  v_mul_f32 v86, v86, v54
  v_mul_f32 v87, v87, v55
  v_cvt_pk_bf16_f32 v80, v80, v81
  v_cvt_pk_bf16_f32 v81, v82, v83
  v_cvt_pk_bf16_f32 v82, v84, v85
  v_cvt_pk_bf16_f32 v83, v86, v87
  s_add_u32 s97, s55, 180224
  buffer_store_dwordx4 v[80:83], v194, s[20:23], s97 offen offset:0 sc1
  v_mul_f32 v88, v88, v56
  v_mul_f32 v89, v89, v57
  v_mul_f32 v90, v90, v58
  v_mul_f32 v91, v91, v59
  v_mul_f32 v92, v92, v60
  v_mul_f32 v93, v93, v61
  v_mul_f32 v94, v94, v62
  v_mul_f32 v95, v95, v63
  v_cvt_pk_bf16_f32 v88, v88, v89
  v_cvt_pk_bf16_f32 v89, v90, v91
  v_cvt_pk_bf16_f32 v90, v92, v93
  v_cvt_pk_bf16_f32 v91, v94, v95
  s_add_u32 s97, s55, 180224
  buffer_store_dwordx4 v[88:91], v194, s[20:23], s97 offen offset:1024 sc1
  s_waitcnt vmcnt(0)
  buffer_store_dword v252, v229, s[20:23], s100 offen offset:0 sc1
  v_and_b32 v56, 15, v193
  v_lshlrev_b32 v56, 4, v56
  v_lshrrev_b32 v57, 4, v193
  v_sub_u32 v57, s33, v57
  v_add_u32 v57, -1, v57
  v_lshl_add_u32 v48, v57, 8, v56
  v_mov_b32 v52, 1073741824
  v_cmp_le_i32 vcc, 0, v57
  s_nop 1
  v_cndmask_b32 v48, v52, v48, vcc
  v_cndmask_b32 v52, 0, v252, vcc
  v_add_u32 v57, -4, v57
  v_lshl_add_u32 v49, v57, 8, v56
  v_mov_b32 v53, 1073741824
  v_cmp_le_i32 vcc, 0, v57
  s_nop 1
  v_cndmask_b32 v49, v53, v49, vcc
  v_cndmask_b32 v53, 0, v252, vcc
  v_add_u32 v57, -4, v57
  v_lshl_add_u32 v50, v57, 8, v56
  v_mov_b32 v54, 1073741824
  v_cmp_le_i32 vcc, 0, v57
  s_nop 1
  v_cndmask_b32 v50, v54, v50, vcc
  v_cndmask_b32 v54, 0, v252, vcc
  v_add_u32 v57, -4, v57
  v_lshl_add_u32 v51, v57, 8, v56
  v_mov_b32 v55, 1073741824
  v_cmp_le_i32 vcc, 0, v57
  s_nop 1
  v_cndmask_b32 v51, v55, v51, vcc
  v_cndmask_b32 v55, 0, v252, vcc
  buffer_load_dwordx4 v[32:35], v48, s[20:23], s96 offen sc1
  buffer_load_dwordx4 v[36:39], v49, s[20:23], s96 offen sc1
  buffer_load_dwordx4 v[40:43], v50, s[20:23], s96 offen sc1
  buffer_load_dwordx4 v[44:47], v51, s[20:23], s96 offen sc1
  s_lshl_b32 s45, s41, 2
  s_add_u32 s45, s45, s32
  s_lshr_b32 s46, s45, 3
  s_mul_i32 s46, s46, 458752
  s_and_b32 s45, s45, 7
  s_lshl_b32 s45, s45, 13
  s_add_u32 s45, s45, s46
  s_add_u32 s45, s45, 65536
  buffer_load_dword v255, v100, s[64:67], s45 offen
  ds_read_b64 v[56:57], v222 offset:1664
  ds_read_b64 v[58:59], v223 offset:1024
  s_waitcnt vmcnt(4)
  v_cmp_ne_u32 s[60:61], v52, v33
  v_cmp_ne_u32 vcc, v52, v35
  s_nop 0
  s_or_b64 s[60:61], s[60:61], vcc
  s_waitcnt vmcnt(3)
  v_cmp_ne_u32 vcc, v53, v37
  s_nop 0
  s_or_b64 s[60:61], s[60:61], vcc
  v_cmp_ne_u32 vcc, v53, v39
  s_nop 0
  s_or_b64 s[60:61], s[60:61], vcc
  s_waitcnt vmcnt(2)
  v_cmp_ne_u32 vcc, v54, v41
  s_nop 0
  s_or_b64 s[60:61], s[60:61], vcc
  v_cmp_ne_u32 vcc, v54, v43
  s_nop 0
  s_or_b64 s[60:61], s[60:61], vcc
  s_waitcnt vmcnt(1)
  v_cmp_ne_u32 vcc, v55, v45
  s_nop 0
  s_or_b64 s[60:61], s[60:61], vcc
  v_cmp_ne_u32 vcc, v55, v47
  s_nop 0
  s_or_b64 s[60:61], s[60:61], vcc
  s_cmp_lg_u64 s[60:61], 0
  s_cbranch_scc1 FZL_slow8
FZL_ret9:
  s_waitcnt lgkmcnt(1)
  v_fmac_f32 v40, v56, v44
  v_fmac_f32 v42, v56, v46
  v_fma_f32 v40, -v57, v46, v40
  v_fmac_f32 v42, v57, v44
  v_fmac_f32 v36, v56, v40
  v_fmac_f32 v38, v56, v42
  v_fma_f32 v36, -v57, v42, v36
  v_fmac_f32 v38, v57, v40
  v_fmac_f32 v32, v56, v36
  v_fmac_f32 v34, v56, v38
  v_fma_f32 v32, -v57, v38, v32
  v_fmac_f32 v34, v57, v36
  s_waitcnt lgkmcnt(0)
  v_mul_f32 v36, v58, v32
  v_mul_f32 v37, v58, v34
  v_fma_f32 v36, -v59, v34, v36
  v_fmac_f32 v37, v59, v32
  s_nop 1
  v_permlane16_swap_b32 v36, v37
  v_add_f32 v36, v36, v37
  v_mov_b32 v37, v36
  s_nop 1
  v_permlane32_swap_b32 v36, v37
  v_add_f32 v238, v36, v37
  v_mov_b32 v239, v238
  s_nop 1
  v_permlane16_swap_b32 v238, v239
  s_lshl_b32 s48, s37, 8
  v_add_u32 v184, s48, v222
  ds_read_b64 v[242:243], v184 offset:512
  ds_read_b64 v[244:245], v223
  ds_read_b64 v[240:241], v222 offset:1536
  ds_read_b64 v[246:247], v222 offset:1792
  s_lshl_b32 s48, s34, 1
  s_add_u32 s48, s48, s38
  s_lshr_b32 s49, s48, 2
  s_lshl_b32 s49, s49, 3
  s_and_b32 s48, s48, 3
  s_add_u32 s48, s48, s49
  s_add_u32 s48, s48, 112
  s_lshl_b32 s48, s48, 10
  s_add_u32 s50, s48, s54
  s_waitcnt lgkmcnt(3)
  v_fmac_f32 v234, v242, v238
  v_fmac_f32 v235, v242, v239
  v_fma_f32 v234, -v243, v239, v234
  v_fmac_f32 v235, v243, v238
  s_waitcnt lgkmcnt(2)
  v_fmac_f32 v230, v244, v234
  v_fmac_f32 v231, v244, v235
  v_fma_f32 v230, -v245, v235, v230
  v_fmac_f32 v231, v245, v234
  s_waitcnt lgkmcnt(1)
  v_fmac_f32 v0, v240, v230
  v_fmac_f32 v1, v240, v231
  v_fma_f32 v0, -v241, v231, v0
  v_fmac_f32 v1, v241, v230
  v_fmac_f32 v2, v240, v0
  v_fmac_f32 v3, v240, v1
  v_fma_f32 v2, -v241, v1, v2
  v_fmac_f32 v3, v241, v0
  s_waitcnt lgkmcnt(0)
  v_mul_f32 v248, v0, v246
  v_mul_f32 v249, v0, v247
  v_fma_f32 v0, -v1, v247, v248
  v_fma_f32 v1, -v1, v246, -v249
  v_fmac_f32 v4, v240, v2
  v_fmac_f32 v5, v240, v3
  v_fma_f32 v4, -v241, v3, v4
  v_fmac_f32 v5, v241, v2
  v_mul_f32 v250, v2, v246
  v_mul_f32 v251, v2, v247
  v_fma_f32 v2, -v3, v247, v250
  v_fma_f32 v3, -v3, v246, -v251
  v_fmac_f32 v6, v240, v4
  v_fmac_f32 v7, v240, v5
  v_fma_f32 v6, -v241, v5, v6
  v_fmac_f32 v7, v241, v4
  v_mul_f32 v248, v4, v246
  v_mul_f32 v249, v4, v247
  v_fma_f32 v4, -v5, v247, v248
  v_fma_f32 v5, -v5, v246, -v249
  v_fmac_f32 v8, v240, v6
  v_fmac_f32 v9, v240, v7
  v_fma_f32 v8, -v241, v7, v8
  v_fmac_f32 v9, v241, v6
  v_mul_f32 v250, v6, v246
  v_mul_f32 v251, v6, v247
  v_fma_f32 v6, -v7, v247, v250
  v_fma_f32 v7, -v7, v246, -v251
  v_fmac_f32 v10, v240, v8
  v_fmac_f32 v11, v240, v9
  v_fma_f32 v10, -v241, v9, v10
  v_fmac_f32 v11, v241, v8
  v_mul_f32 v248, v8, v246
  v_mul_f32 v249, v8, v247
  v_fma_f32 v8, -v9, v247, v248
  v_fma_f32 v9, -v9, v246, -v249
  v_fmac_f32 v12, v240, v10
  v_fmac_f32 v13, v240, v11
  v_fma_f32 v12, -v241, v11, v12
  v_fmac_f32 v13, v241, v10
  v_mul_f32 v250, v10, v246
  v_mul_f32 v251, v10, v247
  v_fma_f32 v10, -v11, v247, v250
  v_fma_f32 v11, -v11, v246, -v251
  v_fmac_f32 v14, v240, v12
  v_fmac_f32 v15, v240, v13
  v_fma_f32 v14, -v241, v13, v14
  v_fmac_f32 v15, v241, v12
  v_mul_f32 v248, v12, v246
  v_mul_f32 v249, v12, v247
  v_fma_f32 v12, -v13, v247, v248
  v_fma_f32 v13, -v13, v246, -v249
  v_mul_f32 v250, v14, v246
  v_mul_f32 v251, v14, v247
  v_fma_f32 v14, -v15, v247, v250
  v_fma_f32 v15, -v15, v246, -v251
  v_cvt_pk_bf16_f32 v184, v0, v2
  v_cvt_pk_bf16_f32 v185, v4, v6
  v_cvt_pk_bf16_f32 v186, v8, v10
  v_cvt_pk_bf16_f32 v187, v12, v14
  v_cvt_pk_bf16_f32 v188, v1, v3
  v_cvt_pk_bf16_f32 v189, v5, v7
  v_cvt_pk_bf16_f32 v190, v9, v11
  v_cvt_pk_bf16_f32 v191, v13, v15
  ds_write_b128 v226, v[184:187]
  ds_write_b128 v226, v[188:191] offset:1280
  ds_read_b64_tr_b16 v[0:1], v227 offset:0
  ds_read_b64_tr_b16 v[2:3], v227 offset:320
  ds_read_b64_tr_b16 v[4:5], v227 offset:1280
  ds_read_b64_tr_b16 v[6:7], v227 offset:1600
  s_waitcnt lgkmcnt(2)
  buffer_store_dwordx4 v[0:3], v194, s[20:23], s50 offen sc1
  s_add_u32 s50, s50, 4096
  s_waitcnt lgkmcnt(0)
  buffer_store_dwordx4 v[4:7], v194, s[20:23], s50 offen sc1
  s_lshl_b32 s48, s37, 8
  v_add_u32 v184, s48, v222
  ds_read_b64 v[242:243], v184 offset:640
  ds_read_b64 v[244:245], v223
  ds_read_b64 v[240:241], v222 offset:1536
  ds_read_b64 v[246:247], v222 offset:1792
  s_lshl_b32 s48, s34, 1
  s_add_u32 s48, s48, s38
  s_lshr_b32 s49, s48, 2
  s_lshl_b32 s49, s49, 3
  s_and_b32 s48, s48, 3
  s_add_u32 s48, s48, s49
  s_add_u32 s48, s48, 112
  s_lshl_b32 s48, s48, 10
  s_add_u32 s50, s48, s54
  s_add_u32 s50, s50, 180224
  s_waitcnt lgkmcnt(3)
  v_fmac_f32 v236, v242, v238
  v_fmac_f32 v237, v242, v239
  v_fma_f32 v236, -v243, v239, v236
  v_fmac_f32 v237, v243, v238
  s_waitcnt lgkmcnt(2)
  v_fmac_f32 v232, v244, v236
  v_fmac_f32 v233, v244, v237
  v_fma_f32 v232, -v245, v237, v232
  v_fmac_f32 v233, v245, v236
  s_waitcnt lgkmcnt(1)
  v_fmac_f32 v16, v240, v232
  v_fmac_f32 v17, v240, v233
  v_fma_f32 v16, -v241, v233, v16
  v_fmac_f32 v17, v241, v232
  v_fmac_f32 v18, v240, v16
  v_fmac_f32 v19, v240, v17
  v_fma_f32 v18, -v241, v17, v18
  v_fmac_f32 v19, v241, v16
  s_waitcnt lgkmcnt(0)
  v_mul_f32 v248, v16, v246
  v_mul_f32 v249, v16, v247
  v_fma_f32 v16, -v17, v247, v248
  v_fma_f32 v17, -v17, v246, -v249
  v_fmac_f32 v20, v240, v18
  v_fmac_f32 v21, v240, v19
  v_fma_f32 v20, -v241, v19, v20
  v_fmac_f32 v21, v241, v18
  v_mul_f32 v250, v18, v246
  v_mul_f32 v251, v18, v247
  v_fma_f32 v18, -v19, v247, v250
  v_fma_f32 v19, -v19, v246, -v251
  v_fmac_f32 v22, v240, v20
  v_fmac_f32 v23, v240, v21
  v_fma_f32 v22, -v241, v21, v22
  v_fmac_f32 v23, v241, v20
  v_mul_f32 v248, v20, v246
  v_mul_f32 v249, v20, v247
  v_fma_f32 v20, -v21, v247, v248
  v_fma_f32 v21, -v21, v246, -v249
  v_fmac_f32 v24, v240, v22
  v_fmac_f32 v25, v240, v23
  v_fma_f32 v24, -v241, v23, v24
  v_fmac_f32 v25, v241, v22
  v_mul_f32 v250, v22, v246
  v_mul_f32 v251, v22, v247
  v_fma_f32 v22, -v23, v247, v250
  v_fma_f32 v23, -v23, v246, -v251
  v_fmac_f32 v26, v240, v24
  v_fmac_f32 v27, v240, v25
  v_fma_f32 v26, -v241, v25, v26
  v_fmac_f32 v27, v241, v24
  v_mul_f32 v248, v24, v246
  v_mul_f32 v249, v24, v247
  v_fma_f32 v24, -v25, v247, v248
  v_fma_f32 v25, -v25, v246, -v249
  v_fmac_f32 v28, v240, v26
  v_fmac_f32 v29, v240, v27
  v_fma_f32 v28, -v241, v27, v28
  v_fmac_f32 v29, v241, v26
  v_mul_f32 v250, v26, v246
  v_mul_f32 v251, v26, v247
  v_fma_f32 v26, -v27, v247, v250
  v_fma_f32 v27, -v27, v246, -v251
  v_fmac_f32 v30, v240, v28
  v_fmac_f32 v31, v240, v29
  v_fma_f32 v30, -v241, v29, v30
  v_fmac_f32 v31, v241, v28
  v_mul_f32 v248, v28, v246
  v_mul_f32 v249, v28, v247
  v_fma_f32 v28, -v29, v247, v248
  v_fma_f32 v29, -v29, v246, -v249
  v_mul_f32 v250, v30, v246
  v_mul_f32 v251, v30, v247
  v_fma_f32 v30, -v31, v247, v250
  v_fma_f32 v31, -v31, v246, -v251
  v_cvt_pk_bf16_f32 v184, v16, v18
  v_cvt_pk_bf16_f32 v185, v20, v22
  v_cvt_pk_bf16_f32 v186, v24, v26
  v_cvt_pk_bf16_f32 v187, v28, v30
  v_cvt_pk_bf16_f32 v188, v17, v19
  v_cvt_pk_bf16_f32 v189, v21, v23
  v_cvt_pk_bf16_f32 v190, v25, v27
  v_cvt_pk_bf16_f32 v191, v29, v31
  ds_write_b128 v226, v[184:187]
  ds_write_b128 v226, v[188:191] offset:1280
  ds_read_b64_tr_b16 v[16:17], v227 offset:0
  ds_read_b64_tr_b16 v[18:19], v227 offset:320
  ds_read_b64_tr_b16 v[20:21], v227 offset:1280
  ds_read_b64_tr_b16 v[22:23], v227 offset:1600
  s_waitcnt lgkmcnt(2)
  buffer_store_dwordx4 v[16:19], v194, s[20:23], s50 offen sc1
  s_add_u32 s50, s50, 4096
  s_waitcnt lgkmcnt(0)
  buffer_store_dwordx4 v[20:23], v194, s[20:23], s50 offen sc1
  buffer_load_dword v253, v183, s[20:23], s74 offen sc1
  s_add_u32 m0, s53, 65536
  s_add_u32 s47, s78, 0
  buffer_load_dwordx4 v176, s[64:67], s47 offen offset:0 lds
  buffer_load_dwordx4 v177, s[64:67], s47 offen offset:1024 lds
  buffer_load_dwordx4 v178, s[64:67], s47 offen offset:2048 lds
  buffer_load_dwordx4 v179, s[64:67], s47 offen offset:3072 lds
  s_add_u32 m0, s53, 69632
  s_add_u32 s47, s78, 32768
  buffer_load_dwordx4 v176, s[64:67], s47 offen offset:0 lds
  buffer_load_dwordx4 v177, s[64:67], s47 offen offset:1024 lds
  buffer_load_dwordx4 v178, s[64:67], s47 offen offset:2048 lds
  buffer_load_dwordx4 v179, s[64:67], s47 offen offset:3072 lds
  s_add_u32 m0, s53, 98304
  s_add_u32 s47, s78, 131072
  buffer_load_dwordx4 v176, s[64:67], s47 offen offset:0 lds
  buffer_load_dwordx4 v177, s[64:67], s47 offen offset:1024 lds
  buffer_load_dwordx4 v178, s[64:67], s47 offen offset:2048 lds
  buffer_load_dwordx4 v179, s[64:67], s47 offen offset:3072 lds
  s_add_u32 m0, s53, 102400
  s_add_u32 s47, s78, 163840
  buffer_load_dwordx4 v176, s[64:67], s47 offen offset:0 lds
  buffer_load_dwordx4 v177, s[64:67], s47 offen offset:1024 lds
  buffer_load_dwordx4 v178, s[64:67], s47 offen offset:2048 lds
  buffer_load_dwordx4 v179, s[64:67], s47 offen offset:3072 lds
  s_add_u32 m0, s53, 0
  s_add_u32 s47, s78, 262144
  buffer_load_dwordx4 v176, s[64:67], s47 offen offset:0 lds
  buffer_load_dwordx4 v177, s[64:67], s47 offen offset:1024 lds
  buffer_load_dwordx4 v178, s[64:67], s47 offen offset:2048 lds
  buffer_load_dwordx4 v179, s[64:67], s47 offen offset:3072 lds
  s_add_u32 m0, s53, 4096
  s_add_u32 s47, s78, 294912
  buffer_load_dwordx4 v176, s[64:67], s47 offen offset:0 lds
  buffer_load_dwordx4 v177, s[64:67], s47 offen offset:1024 lds
  buffer_load_dwordx4 v178, s[64:67], s47 offen offset:2048 lds
  buffer_load_dwordx4 v179, s[64:67], s47 offen offset:3072 lds
  s_waitcnt vmcnt(25)
  buffer_store_dword v252, v229, s[20:23], s100 offen offset:32 sc1
  s_waitcnt vmcnt(25)
  v_cmp_eq_u32 vcc, s36, v253
  s_nop 0
  s_and_b32 s45, vcc_lo, 0xff
  s_cmp_eq_u32 s45, 0xff
  s_cbranch_scc0 FZL_pslow10
FZL_pret11:
  v_lshrrev_b32 v201, 3, v193
  v_cmp_gt_u32 vcc, 1, v201
  v_mov_b32 v201, 0
  v_and_b32 v200, 7, v193
  v_lshl_add_u32 v200, v200, 7, v201
  v_mov_b32 v201, 1073741824
  v_cndmask_b32 v200, v201, v200, vcc
  s_lshr_b32 s45, s41, 2
  s_mul_i32 s45, s45, 180224
  s_and_b32 s46, s41, 3
  s_lshl_b32 s46, s46, 10
  s_add_u32 s45, s45, s46
  s_add_u32 s45, s45, s72
  s_add_u32 s45, s45, 16384
  buffer_load_dword v255, v200, s[20:23], s45 offen sc1
  s_add_u32 s46, s72, 0
  buffer_load_dwordx4 a[0:3], v194, s[20:23], s46 offen offset:0 sc1
  buffer_load_dwordx4 a[4:7], v182, s[20:23], s46 offen offset:0 sc1
  buffer_load_dwordx4 a[8:11], v194, s[20:23], s46 offen offset:1024 sc1
  buffer_load_dwordx4 a[12:15], v182, s[20:23], s46 offen offset:1024 sc1
  buffer_load_dwordx4 a[16:19], v194, s[20:23], s46 offen offset:2048 sc1
  buffer_load_dwordx4 a[20:23], v182, s[20:23], s46 offen offset:2048 sc1
  buffer_load_dwordx4 a[24:27], v194, s[20:23], s46 offen offset:3072 sc1
  buffer_load_dwordx4 a[28:31], v182, s[20:23], s46 offen offset:3072 sc1
  s_add_u32 s46, s72, 8192
  buffer_load_dwordx4 a[32:35], v194, s[20:23], s46 offen offset:0 sc1
  buffer_load_dwordx4 a[36:39], v182, s[20:23], s46 offen offset:0 sc1
  buffer_load_dwordx4 a[40:43], v194, s[20:23], s46 offen offset:1024 sc1
  buffer_load_dwordx4 a[44:47], v182, s[20:23], s46 offen offset:1024 sc1
  buffer_load_dwordx4 a[48:51], v194, s[20:23], s46 offen offset:2048 sc1
  buffer_load_dwordx4 a[52:55], v182, s[20:23], s46 offen offset:2048 sc1
  buffer_load_dwordx4 a[56:59], v194, s[20:23], s46 offen offset:3072 sc1
  buffer_load_dwordx4 a[60:63], v182, s[20:23], s46 offen offset:3072 sc1
  v_lshrrev_b32 v219, 4, v193
  v_and_b32 v220, 15, v193
  v_lshlrev_b32 v204, 10, v219
  v_lshl_add_u32 v204, v220, 3, v204
  v_lshlrev_b32 v205, 3, v219
  v_lshlrev_b32 v218, 3, v220
  v_add_u32 v218, s77, v218
  s_add_u32 s45, s75, 0
  buffer_load_dwordx2 v[32:33], v204, s[8:11], s45 offen
  s_add_u32 s45, s75, 4096
  buffer_load_dwordx2 v[34:35], v204, s[8:11], s45 offen
  s_add_u32 s45, s75, 8192
  buffer_load_dwordx2 v[36:37], v204, s[8:11], s45 offen
  s_add_u32 s45, s75, 12288
  buffer_load_dwordx2 v[38:39], v204, s[8:11], s45 offen
  buffer_load_dwordx2 v[40:41], v205, s[20:23], s76 offen offset:0 sc1
  buffer_load_dwordx2 v[42:43], v205, s[20:23], s76 offen offset:32 sc1
  buffer_load_dwordx2 v[44:45], v205, s[20:23], s76 offen offset:64 sc1
  buffer_load_dwordx2 v[46:47], v205, s[20:23], s76 offen offset:96 sc1
  global_load_dwordx2 v[48:49], v218, s[80:81]
  v_lshrrev_b32 v240, 3, v193
  v_lshlrev_b32 v240, 10, v240
  v_lshrrev_b32 v241, 4, v193
  v_and_b32 v242, 7, v193
  v_xor_b32 v241, v241, v242
  v_lshl_add_u32 v196, v241, 4, v240
  v_xor_b32 v197, 64, v196
  v_add_u32 v197, 7168, v197
  v_add_u32 v198, 14336, v196
  v_add_u32 v199, 14336, v197
  v_and_b32 v240, 31, v193
  v_lshlrev_b32 v240, 7, v240
  v_bfe_u32 v242, v193, 1, 3
  v_lshrrev_b32 v241, 5, v193
  v_xor_b32 v242, v242, v241
  v_lshl_add_u32 v240, v242, 4, v240
  v_add_u32 v184, s53, v240
  v_xor_b32 v185, 32, v184
  v_xor_b32 v186, 64, v184
  v_xor_b32 v187, 96, v184
  s_waitcnt vmcnt(43)
  v_add_u32 v180, 65536, v180
  ds_read_b64_tr_b16 v[160:161], v180 offset:0
  ds_read_b64_tr_b16 v[162:163], v180 offset:1024
  v_add_u32 v181, 65536, v181
  ds_read_b64_tr_b16 v[164:165], v181 offset:0
  ds_read_b64_tr_b16 v[166:167], v181 offset:1024
  s_waitcnt vmcnt(24) lgkmcnt(2)
  v_mfma_f32_32x32x16_bf16 a[128:143], v[160:163], a[0:3], 0
  ds_read_b64_tr_b16 v[168:169], v180 offset:2048
  s_add_u32 m0, s53, 32768
  s_add_u32 s47, s79, 0
  buffer_load_dwordx4 v196, s[68:71], s47 offen offset:0 lds
  s_waitcnt vmcnt(24)
  v_mfma_f32_32x32x16_bf16 a[144:159], v[160:163], a[4:7], 0
  ds_read_b64_tr_b16 v[170:171], v180 offset:3072
  buffer_load_dwordx4 v197, s[68:71], s47 offen offset:1024 lds
  s_waitcnt lgkmcnt(2)
  v_mfma_f32_32x32x16_bf16 a[160:175], v[164:167], a[0:3], 0
  ds_read_b64_tr_b16 v[172:173], v181 offset:2048
  buffer_load_dwordx4 v198, s[68:71], s47 offen offset:2048 lds
  v_mfma_f32_32x32x16_bf16 a[176:191], v[164:167], a[4:7], 0
  ds_read_b64_tr_b16 v[174:175], v181 offset:3072
  buffer_load_dwordx4 v199, s[68:71], s47 offen offset:3072 lds
  s_waitcnt vmcnt(26) lgkmcnt(2)
  v_mfma_f32_32x32x16_bf16 a[128:143], v[168:171], a[8:11], a[128:143]
  ds_read_b64_tr_b16 v[160:161], v180 offset:4096
  s_add_u32 m0, s53, 36864
  s_add_u32 s47, s79, 32768
  buffer_load_dwordx4 v196, s[68:71], s47 offen offset:0 lds
  s_waitcnt vmcnt(26)
  v_mfma_f32_32x32x16_bf16 a[144:159], v[168:171], a[12:15], a[144:159]
  ds_read_b64_tr_b16 v[162:163], v180 offset:5120
  buffer_load_dwordx4 v197, s[68:71], s47 offen offset:1024 lds
  s_waitcnt lgkmcnt(2)
  v_mfma_f32_32x32x16_bf16 a[160:175], v[172:175], a[8:11], a[160:175]
  ds_read_b64_tr_b16 v[164:165], v181 offset:4096
  buffer_load_dwordx4 v198, s[68:71], s47 offen offset:2048 lds
  buffer_load_dwordx4 v199, s[68:71], s47 offen offset:3072 lds
  v_mfma_f32_32x32x16_bf16 a[176:191], v[172:175], a[12:15], a[176:191]
  ds_read_b64_tr_b16 v[166:167], v181 offset:5120
  s_add_u32 s46, s72, 16384
  buffer_load_dwordx4 a[64:67], v194, s[20:23], s46 offen offset:0 sc1
  s_waitcnt vmcnt(29) lgkmcnt(2)
  v_mfma_f32_32x32x16_bf16 a[128:143], v[160:163], a[16:19], a[128:143]
  ds_read_b64_tr_b16 v[168:169], v180 offset:6144
  buffer_load_dwordx4 a[68:71], v182, s[20:23], s46 offen offset:0 sc1
  s_waitcnt vmcnt(29)
  v_mfma_f32_32x32x16_bf16 a[144:159], v[160:163], a[20:23], a[144:159]
  ds_read_b64_tr_b16 v[170:171], v180 offset:7168
  buffer_load_dwordx4 a[72:75], v194, s[20:23], s46 offen offset:1024 sc1
  s_waitcnt lgkmcnt(2)
  v_mfma_f32_32x32x16_bf16 a[160:175], v[164:167], a[16:19], a[160:175]
  ds_read_b64_tr_b16 v[172:173], v181 offset:6144
  buffer_load_dwordx4 a[76:79], v182, s[20:23], s46 offen offset:1024 sc1
  v_mfma_f32_32x32x16_bf16 a[176:191], v[164:167], a[20:23], a[176:191]
  ds_read_b64_tr_b16 v[174:175], v181 offset:7168
  buffer_load_dwordx4 a[80:83], v194, s[20:23], s46 offen offset:2048 sc1
  s_waitcnt vmcnt(31) lgkmcnt(2)
  v_mfma_f32_32x32x16_bf16 a[128:143], v[168:171], a[24:27], a[128:143]
  ds_read_b64_tr_b16 v[160:161], v180 offset:32768
  buffer_load_dwordx4 a[84:87], v182, s[20:23], s46 offen offset:2048 sc1
  s_waitcnt vmcnt(31)
  v_mfma_f32_32x32x16_bf16 a[144:159], v[168:171], a[28:31], a[144:159]
  ds_read_b64_tr_b16 v[162:163], v180 offset:33792
  buffer_load_dwordx4 a[88:91], v194, s[20:23], s46 offen offset:3072 sc1
  s_waitcnt lgkmcnt(2)
  v_mfma_f32_32x32x16_bf16 a[160:175], v[172:175], a[24:27], a[160:175]
  ds_read_b64_tr_b16 v[164:165], v181 offset:32768
  buffer_load_dwordx4 a[92:95], v182, s[20:23], s46 offen offset:3072 sc1
  v_mfma_f32_32x32x16_bf16 a[176:191], v[172:175], a[28:31], a[176:191]
  ds_read_b64_tr_b16 v[166:167], v181 offset:33792
  buffer_load_dword v253, v183, s[20:23], s74 offen sc1
  s_waitcnt vmcnt(33) lgkmcnt(2)
  v_mfma_f32_32x32x16_bf16 a[128:143], v[160:163], a[32:35], a[128:143]
  ds_read_b64_tr_b16 v[168:169], v180 offset:34816
  s_add_u32 m0, s53, 65536
  s_add_u32 s47, s79, 0
  buffer_load_dwordx4 v196, s[84:87], s47 offen offset:0 lds
  v_bfe_u32 v240, v193, 2, 1
  v_lshlrev_b32 v240, 4, v240
  v_and_b32 v241, 1, v193
  v_lshl_add_u32 v240, v241, 3, v240
  v_bfe_u32 v241, v193, 3, 2
  v_lshl_add_u32 v240, v241, 1, v240
  v_bfe_u32 v241, v193, 1, 1
  v_add_u32 v240, v240, v241
  v_bfe_u32 v241, v240, 3, 2
  v_lshlrev_b32 v241, 1, v241
  s_waitcnt vmcnt(33)
  v_mfma_f32_32x32x16_bf16 a[144:159], v[160:163], a[36:39], a[144:159]
  ds_read_b64_tr_b16 v[170:171], v180 offset:35840
  buffer_load_dwordx4 v197, s[84:87], s47 offen offset:1024 lds
  v_and_b32 v242, 7, v240
  v_xor_b32 v242, v242, v241
  v_lshrrev_b32 v243, 5, v193
  v_xor_b32 v242, v242, v243
  v_lshlrev_b32 v240, 8, v240
  v_lshl_add_u32 v240, v242, 4, v240
  s_add_u32 s48, s53, 65536
  v_add_u32 v89, s48, v240
  v_and_b32 v240, 31, v193
  v_bfe_u32 v241, v240, 3, 2
  v_lshlrev_b32 v241, 1, v241
  v_and_b32 v242, 7, v240
  v_xor_b32 v242, v242, v241
  s_waitcnt lgkmcnt(2)
  v_mfma_f32_32x32x16_bf16 a[160:175], v[164:167], a[32:35], a[160:175]
  ds_read_b64_tr_b16 v[172:173], v181 offset:34816
  buffer_load_dwordx4 v198, s[84:87], s47 offen offset:2048 lds
  v_xor_b32 v242, v242, v243
  v_lshlrev_b32 v240, 8, v240
  v_lshl_add_u32 v240, v242, 4, v240
  s_add_u32 s48, s53, 0
  v_add_u32 v88, s48, v240
  v_add_u32 v96, 131072, v88
  v_lshrrev_b32 v241, 4, v193
  v_and_b32 v242, 15, v193
  v_xor_b32 v240, v241, v242
  s_lshl_b32 s48, s37, 2
  v_xor_b32 v240, s48, v240
  v_lshlrev_b32 v240, 4, v240
  v_lshl_add_u32 v240, v241, 8, v240
  v_mfma_f32_32x32x16_bf16 a[176:191], v[164:167], a[36:39], a[176:191]
  ds_read_b64_tr_b16 v[174:175], v181 offset:35840
  buffer_load_dwordx4 v199, s[84:87], s47 offen offset:3072 lds
  s_add_u32 m0, s53, 69632
  s_add_u32 s47, s79, 32768
  buffer_load_dwordx4 v196, s[84:87], s47 offen offset:0 lds
  s_lshl_b32 s48, s37, 12
  s_mul_i32 s49, s38, 131072
  s_add_u32 s48, s48, s49
  s_add_u32 s48, s48, 0
  v_add_u32 v90, s48, v240
  v_xor_b32 v91, 64, v90
  v_xor_b32 v92, 32, v90
  v_xor_b32 v93, 96, v90
  v_lshlrev_b32 v95, 11, v241
  v_lshl_add_u32 v95, v242, 4, v95
  v_lshlrev_b32 v94, 10, v241
  s_waitcnt vmcnt(36) lgkmcnt(2)
  v_mfma_f32_32x32x16_bf16 a[128:143], v[168:171], a[40:43], a[128:143]
  ds_read_b64_tr_b16 v[160:161], v180 offset:36864
  buffer_load_dwordx4 v197, s[84:87], s47 offen offset:1024 lds
  v_lshl_add_u32 v94, v242, 3, v94
  v_lshlrev_b32 v50, 3, v241
  v_lshlrev_b32 v51, 3, v242
  v_add_u32 v51, s77, v51
  s_waitcnt vmcnt(36)
  v_mfma_f32_32x32x16_bf16 a[144:159], v[168:171], a[44:47], a[144:159]
  ds_read_b64_tr_b16 v[162:163], v180 offset:37888
  buffer_load_dwordx4 v198, s[84:87], s47 offen offset:2048 lds
  s_waitcnt lgkmcnt(2)
  v_mfma_f32_32x32x16_bf16 a[160:175], v[172:175], a[40:43], a[160:175]
  ds_read_b64_tr_b16 v[164:165], v181 offset:36864
  buffer_load_dwordx4 v199, s[84:87], s47 offen offset:3072 lds
  v_mfma_f32_32x32x16_bf16 a[176:191], v[172:175], a[44:47], a[176:191]
  ds_read_b64_tr_b16 v[166:167], v181 offset:37888
  s_waitcnt vmcnt(8)
  v_cmp_eq_u32 vcc, s36, v253
  s_nop 0
  s_and_b32 s45, vcc_lo, 0xff00
  s_cmp_eq_u32 s45, 0xff00
  s_cbranch_scc0 FZL_pslow12
FZL_pret13:
  s_waitcnt lgkmcnt(2)
  v_mfma_f32_32x32x16_bf16 a[128:143], v[160:163], a[48:51], a[128:143]
  ds_read_b64_tr_b16 v[168:169], v180 offset:38912
  v_mfma_f32_32x32x16_bf16 a[144:159], v[160:163], a[52:55], a[144:159]
  ds_read_b64_tr_b16 v[170:171], v180 offset:39936
  s_add_u32 s46, s73, 0
  buffer_load_dwordx4 a[96:99], v194, s[20:23], s46 offen offset:0 sc1
  s_waitcnt lgkmcnt(2)
  v_mfma_f32_32x32x16_bf16 a[160:175], v[164:167], a[48:51], a[160:175]
  ds_read_b64_tr_b16 v[172:173], v181 offset:38912
  buffer_load_dwordx4 a[100:103], v182, s[20:23], s46 offen offset:0 sc1
  v_mfma_f32_32x32x16_bf16 a[176:191], v[164:167], a[52:55], a[176:191]
  ds_read_b64_tr_b16 v[174:175], v181 offset:39936
  buffer_load_dwordx4 a[104:107], v194, s[20:23], s46 offen offset:1024 sc1
  buffer_load_dwordx4 a[108:111], v182, s[20:23], s46 offen offset:1024 sc1
  s_waitcnt lgkmcnt(2)
  v_mfma_f32_32x32x16_bf16 a[128:143], v[168:171], a[56:59], a[128:143]
  v_subrev_u32 v180, 65536, v180
  ds_read_b64_tr_b16 v[160:161], v180 offset:0
  buffer_load_dwordx4 a[112:115], v194, s[20:23], s46 offen offset:2048 sc1
  v_mfma_f32_32x32x16_bf16 a[144:159], v[168:171], a[60:63], a[144:159]
  ds_read_b64_tr_b16 v[162:163], v180 offset:1024
  buffer_load_dwordx4 a[116:119], v182, s[20:23], s46 offen offset:2048 sc1
  s_waitcnt lgkmcnt(2)
  v_mfma_f32_32x32x16_bf16 a[160:175], v[172:175], a[56:59], a[160:175]
  v_subrev_u32 v181, 65536, v181
  ds_read_b64_tr_b16 v[164:165], v181 offset:0
  buffer_load_dwordx4 a[120:123], v194, s[20:23], s46 offen offset:3072 sc1
  v_mfma_f32_32x32x16_bf16 a[176:191], v[172:175], a[60:63], a[176:191]
  ds_read_b64_tr_b16 v[166:167], v181 offset:1024
  buffer_load_dwordx4 a[124:127], v182, s[20:23], s46 offen offset:3072 sc1
  s_waitcnt lgkmcnt(0)
  s_barrier
  v_mfma_f32_32x32x16_bf16 a[128:143], v[160:163], a[64:67], a[128:143]
  ds_read_b64_tr_b16 v[168:169], v180 offset:2048
  s_add_u32 m0, s53, 98304
  s_add_u32 s47, s79, 128
  buffer_load_dwordx4 v196, s[68:71], s47 offen offset:0 lds
  v_mfma_f32_32x32x16_bf16 a[144:159], v[160:163], a[68:71], a[144:159]
  ds_read_b64_tr_b16 v[170:171], v180 offset:3072
  buffer_load_dwordx4 v197, s[68:71], s47 offen offset:1024 lds
  v_mfma_f32_32x32x16_bf16 a[160:175], v[164:167], a[64:67], a[160:175]
  ds_read_b64_tr_b16 v[172:173], v181 offset:2048
  buffer_load_dwordx4 v198, s[68:71], s47 offen offset:2048 lds
  v_mfma_f32_32x32x16_bf16 a[176:191], v[164:167], a[68:71], a[176:191]
  ds_read_b64_tr_b16 v[174:175], v181 offset:3072
  buffer_load_dwordx4 v199, s[68:71], s47 offen offset:3072 lds
  s_waitcnt lgkmcnt(2)
  v_mfma_f32_32x32x16_bf16 a[128:143], v[168:171], a[72:75], a[128:143]
  ds_read_b64_tr_b16 v[160:161], v180 offset:4096
  s_add_u32 m0, s53, 102400
  s_add_u32 s47, s79, 32896
  buffer_load_dwordx4 v196, s[68:71], s47 offen offset:0 lds
  v_mfma_f32_32x32x16_bf16 a[144:159], v[168:171], a[76:79], a[144:159]
  ds_read_b64_tr_b16 v[162:163], v180 offset:5120
  buffer_load_dwordx4 v197, s[68:71], s47 offen offset:1024 lds
  s_waitcnt lgkmcnt(2)
  v_mfma_f32_32x32x16_bf16 a[160:175], v[172:175], a[72:75], a[160:175]
  ds_read_b64_tr_b16 v[164:165], v181 offset:4096
  buffer_load_dwordx4 v198, s[68:71], s47 offen offset:2048 lds
  v_mfma_f32_32x32x16_bf16 a[176:191], v[172:175], a[76:79], a[176:191]
  ds_read_b64_tr_b16 v[166:167], v181 offset:5120
  buffer_load_dwordx4 v199, s[68:71], s47 offen offset:3072 lds
  s_waitcnt lgkmcnt(2)
  v_mfma_f32_32x32x16_bf16 a[128:143], v[160:163], a[80:83], a[128:143]
  ds_read_b64_tr_b16 v[168:169], v180 offset:6144
  s_add_u32 s46, s73, 4096
  buffer_load_dwordx4 a[0:3], v194, s[20:23], s46 offen offset:0 sc1
  v_mfma_f32_32x32x16_bf16 a[144:159], v[160:163], a[84:87], a[144:159]
  ds_read_b64_tr_b16 v[170:171], v180 offset:7168
  buffer_load_dwordx4 a[4:7], v182, s[20:23], s46 offen offset:0 sc1
  s_waitcnt lgkmcnt(2)
  v_mfma_f32_32x32x16_bf16 a[160:175], v[164:167], a[80:83], a[160:175]
  ds_read_b64_tr_b16 v[172:173], v181 offset:6144
  buffer_load_dwordx4 a[8:11], v194, s[20:23], s46 offen offset:1024 sc1
  v_mfma_f32_32x32x16_bf16 a[176:191], v[164:167], a[84:87], a[176:191]
  ds_read_b64_tr_b16 v[174:175], v181 offset:7168
  buffer_load_dwordx4 a[12:15], v182, s[20:23], s46 offen offset:1024 sc1
  s_waitcnt lgkmcnt(2)
  v_mfma_f32_32x32x16_bf16 a[128:143], v[168:171], a[88:91], a[128:143]
  ds_read_b128 v[160:163], v184 offset:32768
  buffer_load_dwordx4 a[16:19], v194, s[20:23], s46 offen offset:2048 sc1
  v_mfma_f32_32x32x16_bf16 a[144:159], v[168:171], a[92:95], a[144:159]
  ds_read_b128 v[164:167], v184 offset:36864
  buffer_load_dwordx4 a[20:23], v182, s[20:23], s46 offen offset:2048 sc1
  s_waitcnt lgkmcnt(2)
  v_mfma_f32_32x32x16_bf16 a[160:175], v[172:175], a[88:91], a[160:175]
  buffer_load_dwordx4 a[24:27], v194, s[20:23], s46 offen offset:3072 sc1
  v_mfma_f32_32x32x16_bf16 a[176:191], v[172:175], a[92:95], a[176:191]
  buffer_load_dwordx4 a[28:31], v182, s[20:23], s46 offen offset:3072 sc1
  s_waitcnt vmcnt(23) lgkmcnt(1)
  v_mfma_f32_32x32x16_bf16 a[192:207], v[160:163], a[96:99], 0
  ds_read_b128 v[168:171], v185 offset:32768
  s_add_u32 m0, s53, 0
  s_add_u32 s47, s79, 128
  buffer_load_dwordx4 v196, s[84:87], s47 offen offset:0 lds
  s_waitcnt vmcnt(23)
  v_mfma_f32_32x32x16_bf16 a[208:223], v[160:163], a[100:103], 0
  ds_read_b128 v[172:175], v185 offset:36864
  buffer_load_dwordx4 v197, s[84:87], s47 offen offset:1024 lds
  s_waitcnt lgkmcnt(2)
  v_mfma_f32_32x32x16_bf16 a[224:239], v[164:167], a[96:99], 0
  buffer_load_dwordx4 v198, s[84:87], s47 offen offset:2048 lds
  v_mfma_f32_32x32x16_bf16 a[240:255], v[164:167], a[100:103], 0
  buffer_load_dwordx4 v199, s[84:87], s47 offen offset:3072 lds
  s_waitcnt vmcnt(25) lgkmcnt(1)
  v_mfma_f32_32x32x16_bf16 a[192:207], v[168:171], a[104:107], a[192:207]
  ds_read_b128 v[160:163], v186 offset:32768
  s_add_u32 m0, s53, 4096
  s_add_u32 s47, s79, 32896
  buffer_load_dwordx4 v196, s[84:87], s47 offen offset:0 lds
  s_waitcnt vmcnt(25)
  v_mfma_f32_32x32x16_bf16 a[208:223], v[168:171], a[108:111], a[208:223]
  ds_read_b128 v[164:167], v186 offset:36864
  buffer_load_dwordx4 v197, s[84:87], s47 offen offset:1024 lds
  s_waitcnt lgkmcnt(2)
  v_mfma_f32_32x32x16_bf16 a[224:239], v[172:175], a[104:107], a[224:239]
  buffer_load_dwordx4 v198, s[84:87], s47 offen offset:2048 lds
  v_mfma_f32_32x32x16_bf16 a[240:255], v[172:175], a[108:111], a[240:255]
  buffer_load_dwordx4 v199, s[84:87], s47 offen offset:3072 lds
  s_waitcnt vmcnt(27) lgkmcnt(1)
  v_mfma_f32_32x32x16_bf16 a[192:207], v[160:163], a[112:115], a[192:207]
  ds_read_b128 v[168:171], v187 offset:32768
  s_add_u32 s46, s73, 8192
  buffer_load_dwordx4 a[32:35], v194, s[20:23], s46 offen offset:0 sc1
  s_waitcnt vmcnt(27)
  v_mfma_f32_32x32x16_bf16 a[208:223], v[160:163], a[116:119], a[208:223]
  ds_read_b128 v[172:175], v187 offset:36864
  buffer_load_dwordx4 a[36:39], v182, s[20:23], s46 offen offset:0 sc1
  s_waitcnt lgkmcnt(2)
  v_mfma_f32_32x32x16_bf16 a[224:239], v[164:167], a[112:115], a[224:239]
  buffer_load_dwordx4 a[40:43], v194, s[20:23], s46 offen offset:1024 sc1
  v_mfma_f32_32x32x16_bf16 a[240:255], v[164:167], a[116:119], a[240:255]
  buffer_load_dwordx4 a[44:47], v182, s[20:23], s46 offen offset:1024 sc1
  s_waitcnt vmcnt(29) lgkmcnt(1)
  v_mfma_f32_32x32x16_bf16 a[192:207], v[168:171], a[120:123], a[192:207]
  v_add_u32 v184, 65536, v184
  ds_read_b128 v[160:163], v184 offset:0
  buffer_load_dwordx4 a[48:51], v194, s[20:23], s46 offen offset:2048 sc1
  s_waitcnt vmcnt(29)
  v_mfma_f32_32x32x16_bf16 a[208:223], v[168:171], a[124:127], a[208:223]
  ds_read_b128 v[164:167], v184 offset:4096
  buffer_load_dwordx4 a[52:55], v182, s[20:23], s46 offen offset:2048 sc1
  s_waitcnt lgkmcnt(2)
  v_mfma_f32_32x32x16_bf16 a[224:239], v[172:175], a[120:123], a[224:239]
  buffer_load_dwordx4 a[56:59], v194, s[20:23], s46 offen offset:3072 sc1
  v_mfma_f32_32x32x16_bf16 a[240:255], v[172:175], a[124:127], a[240:255]
  buffer_load_dwordx4 a[60:63], v182, s[20:23], s46 offen offset:3072 sc1
  s_waitcnt vmcnt(23) lgkmcnt(1)
  v_mfma_f32_32x32x16_bf16 a[192:207], v[160:163], a[0:3], a[192:207]
  v_add_u32 v185, 65536, v185
  ds_read_b128 v[168:171], v185 offset:0
  s_add_u32 m0, s53, 32768
  s_add_u32 s47, s78, 393216
  buffer_load_dwordx4 v176, s[64:67], s47 offen offset:0 lds
  v_lshlrev_b32 v52, 16, v48
  v_and_b32 v53, 0xffff0000, v48
  v_lshlrev_b32 v54, 16, v49
  s_waitcnt vmcnt(23)
  v_mfma_f32_32x32x16_bf16 a[208:223], v[160:163], a[4:7], a[208:223]
  ds_read_b128 v[172:175], v185 offset:4096
  buffer_load_dwordx4 v177, s[64:67], s47 offen offset:1024 lds
  v_and_b32 v55, 0xffff0000, v49
  v_lshlrev_b32 v41, 16, v40
  v_rcp_f32 v41, v41
  v_and_b32 v40, 0xffff0000, v40
  s_waitcnt lgkmcnt(2)
  v_mfma_f32_32x32x16_bf16 a[224:239], v[164:167], a[0:3], a[224:239]
  buffer_load_dwordx4 v178, s[64:67], s47 offen offset:2048 lds
  v_lshlrev_b32 v56, 16, v32
  v_and_b32 v57, 0xffff0000, v32
  v_lshlrev_b32 v58, 16, v33
  v_and_b32 v59, 0xffff0000, v33
  v_sub_f32 v72, v56, v40
  v_sub_f32 v73, v57, v40
  v_mfma_f32_32x32x16_bf16 a[240:255], v[164:167], a[4:7], a[240:255]
  buffer_load_dwordx4 v179, s[64:67], s47 offen offset:3072 lds
  v_sub_f32 v74, v58, v40
  v_sub_f32 v75, v59, v40
  v_mul_f32 v72, v72, v41
  v_mul_f32 v73, v73, v41
  v_mul_f32 v74, v74, v41
  v_mul_f32 v75, v75, v41
  v_mul_f32 v72, v72, v52
  s_waitcnt vmcnt(25) lgkmcnt(1)
  v_mfma_f32_32x32x16_bf16 a[192:207], v[168:171], a[8:11], a[192:207]
  v_add_u32 v186, 65536, v186
  ds_read_b128 v[160:163], v186 offset:0
  s_add_u32 m0, s53, 36864
  s_add_u32 s47, s78, 425984
  buffer_load_dwordx4 v176, s[64:67], s47 offen offset:0 lds
  v_mul_f32 v73, v73, v53
  v_mul_f32 v74, v74, v54
  v_mul_f32 v75, v75, v55
  s_waitcnt vmcnt(25)
  v_mfma_f32_32x32x16_bf16 a[208:223], v[168:171], a[12:15], a[208:223]
  ds_read_b128 v[164:167], v186 offset:4096
  buffer_load_dwordx4 v177, s[64:67], s47 offen offset:1024 lds
  v_lshlrev_b32 v43, 16, v42
  v_rcp_f32 v43, v43
  v_and_b32 v42, 0xffff0000, v42
  v_lshlrev_b32 v60, 16, v34
  s_waitcnt lgkmcnt(2)
  v_mfma_f32_32x32x16_bf16 a[224:239], v[172:175], a[8:11], a[224:239]
  buffer_load_dwordx4 v178, s[64:67], s47 offen offset:2048 lds
  v_and_b32 v61, 0xffff0000, v34
  v_lshlrev_b32 v62, 16, v35
  v_and_b32 v63, 0xffff0000, v35
  v_sub_f32 v76, v60, v42
  v_sub_f32 v77, v61, v42
  v_sub_f32 v78, v62, v42
  v_mfma_f32_32x32x16_bf16 a[240:255], v[172:175], a[12:15], a[240:255]
  buffer_load_dwordx4 v179, s[64:67], s47 offen offset:3072 lds
  v_sub_f32 v79, v63, v42
  v_mul_f32 v76, v76, v43
  v_mul_f32 v77, v77, v43
  v_mul_f32 v78, v78, v43
  v_mul_f32 v79, v79, v43
  v_mul_f32 v76, v76, v52
  v_mul_f32 v77, v77, v53
  s_waitcnt vmcnt(27) lgkmcnt(1)
  v_mfma_f32_32x32x16_bf16 a[192:207], v[160:163], a[16:19], a[192:207]
  v_add_u32 v187, 65536, v187
  ds_read_b128 v[168:171], v187 offset:0
  s_add_u32 s46, s73, 12288
  buffer_load_dwordx4 a[64:67], v194, s[20:23], s46 offen offset:0 sc1
  v_mul_f32 v78, v78, v54
  v_mul_f32 v79, v79, v55
  v_lshlrev_b32 v45, 16, v44
  s_waitcnt vmcnt(27)
  v_mfma_f32_32x32x16_bf16 a[208:223], v[160:163], a[20:23], a[208:223]
  ds_read_b128 v[172:175], v187 offset:4096
  buffer_load_dwordx4 a[68:71], v182, s[20:23], s46 offen offset:0 sc1
  v_rcp_f32 v45, v45
  v_and_b32 v44, 0xffff0000, v44
  v_lshlrev_b32 v64, 16, v36
  v_and_b32 v65, 0xffff0000, v36
  s_waitcnt lgkmcnt(2)
  v_mfma_f32_32x32x16_bf16 a[224:239], v[164:167], a[16:19], a[224:239]
  buffer_load_dwordx4 a[72:75], v194, s[20:23], s46 offen offset:1024 sc1
  v_lshlrev_b32 v66, 16, v37
  v_and_b32 v67, 0xffff0000, v37
  v_sub_f32 v80, v64, v44
  v_sub_f32 v81, v65, v44
  v_sub_f32 v82, v66, v44
  v_sub_f32 v83, v67, v44
  v_mul_f32 v80, v80, v45
  v_mfma_f32_32x32x16_bf16 a[240:255], v[164:167], a[20:23], a[240:255]
  buffer_load_dwordx4 a[76:79], v182, s[20:23], s46 offen offset:1024 sc1
  v_mul_f32 v81, v81, v45
  v_mul_f32 v82, v82, v45
  v_mul_f32 v83, v83, v45
  v_mul_f32 v80, v80, v52
  v_mul_f32 v81, v81, v53
  v_mul_f32 v82, v82, v54
  v_mul_f32 v83, v83, v55
  s_waitcnt vmcnt(29) lgkmcnt(1)
  v_mfma_f32_32x32x16_bf16 a[192:207], v[168:171], a[24:27], a[192:207]
  ds_read_b128 v[160:163], v184 offset:32768
  buffer_load_dwordx4 a[80:83], v194, s[20:23], s46 offen offset:2048 sc1
  v_lshlrev_b32 v47, 16, v46
  v_rcp_f32 v47, v47
  v_and_b32 v46, 0xffff0000, v46
  v_lshlrev_b32 v68, 16, v38
  s_waitcnt vmcnt(29)
  v_mfma_f32_32x32x16_bf16 a[208:223], v[168:171], a[28:31], a[208:223]
  ds_read_b128 v[164:167], v184 offset:36864
  buffer_load_dwordx4 a[84:87], v182, s[20:23], s46 offen offset:2048 sc1
  v_and_b32 v69, 0xffff0000, v38
  v_lshlrev_b32 v70, 16, v39
  v_and_b32 v71, 0xffff0000, v39
  v_sub_f32 v84, v68, v46
  v_sub_f32 v85, v69, v46
  s_waitcnt lgkmcnt(2)
  v_mfma_f32_32x32x16_bf16 a[224:239], v[172:175], a[24:27], a[224:239]
  buffer_load_dwordx4 a[88:91], v194, s[20:23], s46 offen offset:3072 sc1
  v_sub_f32 v86, v70, v46
  v_sub_f32 v87, v71, v46
  v_mul_f32 v84, v84, v47
  v_mul_f32 v85, v85, v47
  v_mul_f32 v86, v86, v47
  v_mul_f32 v87, v87, v47
  v_mul_f32 v84, v84, v52
  v_mfma_f32_32x32x16_bf16 a[240:255], v[172:175], a[28:31], a[240:255]
  buffer_load_dwordx4 a[92:95], v182, s[20:23], s46 offen offset:3072 sc1
  v_mul_f32 v85, v85, v53
  v_mul_f32 v86, v86, v54
  v_mul_f32 v87, v87, v55
  s_waitcnt vmcnt(23) lgkmcnt(1)
  v_mfma_f32_32x32x16_bf16 a[192:207], v[160:163], a[32:35], a[192:207]
  ds_read_b128 v[168:171], v185 offset:32768
  s_add_u32 m0, s53, 65536
  s_add_u32 s47, s78, 65536
  buffer_load_dwordx4 v176, s[64:67], s47 offen offset:0 lds
  s_waitcnt vmcnt(23)
  v_mfma_f32_32x32x16_bf16 a[208:223], v[160:163], a[36:39], a[208:223]
  ds_read_b128 v[172:175], v185 offset:36864
  buffer_load_dwordx4 v177, s[64:67], s47 offen offset:1024 lds
  s_waitcnt lgkmcnt(2)
  v_mfma_f32_32x32x16_bf16 a[224:239], v[164:167], a[32:35], a[224:239]
  buffer_load_dwordx4 v178, s[64:67], s47 offen offset:2048 lds
  v_mfma_f32_32x32x16_bf16 a[240:255], v[164:167], a[36:39], a[240:255]
  buffer_load_dwordx4 v179, s[64:67], s47 offen offset:3072 lds
  s_waitcnt vmcnt(25) lgkmcnt(1)
  v_mfma_f32_32x32x16_bf16 a[192:207], v[168:171], a[40:43], a[192:207]
  ds_read_b128 v[160:163], v186 offset:32768
  s_add_u32 m0, s53, 69632
  s_add_u32 s47, s78, 98304
  buffer_load_dwordx4 v176, s[64:67], s47 offen offset:0 lds
  s_waitcnt vmcnt(25)
  v_mfma_f32_32x32x16_bf16 a[208:223], v[168:171], a[44:47], a[208:223]
  ds_read_b128 v[164:167], v186 offset:36864
  buffer_load_dwordx4 v177, s[64:67], s47 offen offset:1024 lds
  s_waitcnt lgkmcnt(2)
  v_mfma_f32_32x32x16_bf16 a[224:239], v[172:175], a[40:43], a[224:239]
  buffer_load_dwordx4 v178, s[64:67], s47 offen offset:2048 lds
  buffer_load_dwordx4 v179, s[64:67], s47 offen offset:3072 lds
  v_mfma_f32_32x32x16_bf16 a[240:255], v[172:175], a[44:47], a[240:255]
  s_add_u32 s46, s72, 24576
  buffer_load_dwordx4 a[96:99], v194, s[20:23], s46 offen offset:0 sc1
  s_waitcnt vmcnt(28) lgkmcnt(1)
  v_mfma_f32_32x32x16_bf16 a[192:207], v[160:163], a[48:51], a[192:207]
  ds_read_b128 v[168:171], v187 offset:32768
  buffer_load_dwordx4 a[100:103], v182, s[20:23], s46 offen offset:0 sc1
  s_waitcnt vmcnt(28)
  v_mfma_f32_32x32x16_bf16 a[208:223], v[160:163], a[52:55], a[208:223]
  ds_read_b128 v[172:175], v187 offset:36864
  buffer_load_dwordx4 a[104:107], v194, s[20:23], s46 offen offset:1024 sc1
  s_waitcnt lgkmcnt(2)
  v_mfma_f32_32x32x16_bf16 a[224:239], v[164:167], a[48:51], a[224:239]
  buffer_load_dwordx4 a[108:111], v182, s[20:23], s46 offen offset:1024 sc1
  v_mfma_f32_32x32x16_bf16 a[240:255], v[164:167], a[52:55], a[240:255]
  buffer_load_dwordx4 a[112:115], v194, s[20:23], s46 offen offset:2048 sc1
  s_waitcnt vmcnt(30) lgkmcnt(1)
  v_mfma_f32_32x32x16_bf16 a[192:207], v[168:171], a[56:59], a[192:207]
  v_subrev_u32 v184, 65536, v184
  ds_read_b128 v[160:163], v184 offset:0
  buffer_load_dwordx4 a[116:119], v182, s[20:23], s46 offen offset:2048 sc1
  s_waitcnt vmcnt(30)
  v_mfma_f32_32x32x16_bf16 a[208:223], v[168:171], a[60:63], a[208:223]
  ds_read_b128 v[164:167], v184 offset:4096
  buffer_load_dwordx4 a[120:123], v194, s[20:23], s46 offen offset:3072 sc1
  s_waitcnt lgkmcnt(2)
  v_mfma_f32_32x32x16_bf16 a[224:239], v[172:175], a[56:59], a[224:239]
  buffer_load_dwordx4 a[124:127], v182, s[20:23], s46 offen offset:3072 sc1
  v_mfma_f32_32x32x16_bf16 a[240:255], v[172:175], a[60:63], a[240:255]
  buffer_load_dword v253, v183, s[20:23], s74 offen sc1
  s_waitcnt vmcnt(24) lgkmcnt(1)
  v_mfma_f32_32x32x16_bf16 a[192:207], v[160:163], a[64:67], a[192:207]
  v_subrev_u32 v185, 65536, v185
  ds_read_b128 v[168:171], v185 offset:0
  s_add_u32 m0, s53, 98304
  s_add_u32 s47, s78, 196608
  buffer_load_dwordx4 v176, s[64:67], s47 offen offset:0 lds
  s_waitcnt vmcnt(24)
  v_mfma_f32_32x32x16_bf16 a[208:223], v[160:163], a[68:71], a[208:223]
  ds_read_b128 v[172:175], v185 offset:4096
  buffer_load_dwordx4 v177, s[64:67], s47 offen offset:1024 lds
  s_waitcnt lgkmcnt(2)
  v_mfma_f32_32x32x16_bf16 a[224:239], v[164:167], a[64:67], a[224:239]
  buffer_load_dwordx4 v178, s[64:67], s47 offen offset:2048 lds
  v_mfma_f32_32x32x16_bf16 a[240:255], v[164:167], a[68:71], a[240:255]
  buffer_load_dwordx4 v179, s[64:67], s47 offen offset:3072 lds
  s_add_u32 m0, s53, 102400
  s_add_u32 s47, s78, 229376
  buffer_load_dwordx4 v176, s[64:67], s47 offen offset:0 lds
  s_waitcnt vmcnt(27) lgkmcnt(1)
  v_mfma_f32_32x32x16_bf16 a[192:207], v[168:171], a[72:75], a[192:207]
  v_subrev_u32 v186, 65536, v186
  ds_read_b128 v[160:163], v186 offset:0
  buffer_load_dwordx4 v177, s[64:67], s47 offen offset:1024 lds
  s_waitcnt vmcnt(27)
  v_mfma_f32_32x32x16_bf16 a[208:223], v[168:171], a[76:79], a[208:223]
  ds_read_b128 v[164:167], v186 offset:4096
  buffer_load_dwordx4 v178, s[64:67], s47 offen offset:2048 lds
  s_waitcnt lgkmcnt(2)
  v_mfma_f32_32x32x16_bf16 a[224:239], v[172:175], a[72:75], a[224:239]
  buffer_load_dwordx4 v179, s[64:67], s47 offen offset:3072 lds
  v_mfma_f32_32x32x16_bf16 a[240:255], v[172:175], a[76:79], a[240:255]
  s_waitcnt vmcnt(8)
  v_cmp_eq_u32 vcc, s36, v253
  s_nop 0
  s_and_b32 s45, vcc_lo, 0x3f0000
  s_cmp_eq_u32 s45, 0x3f0000
  s_cbranch_scc0 FZL_pslow14
FZL_pret15:
  s_waitcnt lgkmcnt(1)
  v_mfma_f32_32x32x16_bf16 a[192:207], v[160:163], a[80:83], a[192:207]
  v_subrev_u32 v187, 65536, v187
  ds_read_b128 v[168:171], v187 offset:0
  v_mfma_f32_32x32x16_bf16 a[208:223], v[160:163], a[84:87], a[208:223]
  ds_read_b128 v[172:175], v187 offset:4096
  s_add_u32 s46, s72, 4096
  buffer_load_dwordx4 a[0:3], v194, s[20:23], s46 offen offset:0 sc1
  s_waitcnt lgkmcnt(2)
  v_mfma_f32_32x32x16_bf16 a[224:239], v[164:167], a[80:83], a[224:239]
  buffer_load_dwordx4 a[4:7], v182, s[20:23], s46 offen offset:0 sc1
  v_mfma_f32_32x32x16_bf16 a[240:255], v[164:167], a[84:87], a[240:255]
  buffer_load_dwordx4 a[8:11], v194, s[20:23], s46 offen offset:1024 sc1
  buffer_load_dwordx4 a[12:15], v182, s[20:23], s46 offen offset:1024 sc1
  s_waitcnt lgkmcnt(1)
  v_mfma_f32_32x32x16_bf16 a[192:207], v[168:171], a[88:91], a[192:207]
  ds_read_b64_tr_b16 v[160:161], v180 offset:32768
  buffer_load_dwordx4 a[16:19], v194, s[20:23], s46 offen offset:2048 sc1
  v_mfma_f32_32x32x16_bf16 a[208:223], v[168:171], a[92:95], a[208:223]
  ds_read_b64_tr_b16 v[162:163], v180 offset:33792
  buffer_load_dwordx4 a[20:23], v182, s[20:23], s46 offen offset:2048 sc1
  s_waitcnt lgkmcnt(2)
  v_mfma_f32_32x32x16_bf16 a[224:239], v[172:175], a[88:91], a[224:239]
  ds_read_b64_tr_b16 v[164:165], v181 offset:32768
  buffer_load_dwordx4 a[24:27], v194, s[20:23], s46 offen offset:3072 sc1
  v_mfma_f32_32x32x16_bf16 a[240:255], v[172:175], a[92:95], a[240:255]
  ds_read_b64_tr_b16 v[166:167], v181 offset:33792
  buffer_load_dwordx4 a[28:31], v182, s[20:23], s46 offen offset:3072 sc1
  s_waitcnt lgkmcnt(2)
  v_mfma_f32_32x32x16_bf16 a[128:143], v[160:163], a[96:99], a[128:143]
  ds_read_b64_tr_b16 v[168:169], v180 offset:34816
  s_add_u32 s46, s72, 12288
  buffer_load_dwordx4 a[32:35], v194, s[20:23], s46 offen offset:0 sc1
  ds_write_b128 v88, a[192:195] offset:0
  v_mfma_f32_32x32x16_bf16 a[144:159], v[160:163], a[100:103], a[144:159]
  ds_read_b64_tr_b16 v[170:171], v180 offset:35840
  ds_write_b128 v96, a[208:211]
  s_waitcnt lgkmcnt(4)
  v_mfma_f32_32x32x16_bf16 a[160:175], v[164:167], a[96:99], a[160:175]
  ds_read_b64_tr_b16 v[172:173], v181 offset:34816
  v_mfma_f32_32x32x16_bf16 a[176:191], v[164:167], a[100:103], a[176:191]
  ds_read_b64_tr_b16 v[174:175], v181 offset:35840
  buffer_load_dwordx4 a[36:39], v182, s[20:23], s46 offen offset:0 sc1
  v_xor_b32 v241, 32, v88
  v_xor_b32 v243, 32, v96
  ds_write_b128 v241, a[196:199] offset:0
  s_waitcnt lgkmcnt(4)
  v_mfma_f32_32x32x16_bf16 a[128:143], v[168:171], a[104:107], a[128:143]
  ds_read_b64_tr_b16 v[160:161], v180 offset:36864
  buffer_load_dwordx4 a[40:43], v194, s[20:23], s46 offen offset:1024 sc1
  ds_write_b128 v243, a[212:215]
  v_mfma_f32_32x32x16_bf16 a[144:159], v[168:171], a[108:111], a[144:159]
  ds_read_b64_tr_b16 v[162:163], v180 offset:37888
  s_waitcnt lgkmcnt(4)
  v_mfma_f32_32x32x16_bf16 a[160:175], v[172:175], a[104:107], a[160:175]
  ds_read_b64_tr_b16 v[164:165], v181 offset:36864
  v_xor_b32 v240, 64, v88
  v_xor_b32 v242, 64, v96
  ds_write_b128 v240, a[200:203] offset:0
  v_mfma_f32_32x32x16_bf16 a[176:191], v[172:175], a[108:111], a[176:191]
  ds_read_b64_tr_b16 v[166:167], v181 offset:37888
  buffer_load_dwordx4 a[44:47], v182, s[20:23], s46 offen offset:1024 sc1
  ds_write_b128 v242, a[216:219]
  s_waitcnt lgkmcnt(4)
  v_mfma_f32_32x32x16_bf16 a[128:143], v[160:163], a[112:115], a[128:143]
  ds_read_b64_tr_b16 v[168:169], v180 offset:38912
  buffer_load_dwordx4 a[48:51], v194, s[20:23], s46 offen offset:2048 sc1
  v_mfma_f32_32x32x16_bf16 a[144:159], v[160:163], a[116:119], a[144:159]
  ds_read_b64_tr_b16 v[170:171], v180 offset:39936
  v_xor_b32 v241, 96, v88
  v_xor_b32 v243, 96, v96
  ds_write_b128 v241, a[204:207] offset:0
  s_waitcnt lgkmcnt(4)
  v_mfma_f32_32x32x16_bf16 a[160:175], v[164:167], a[112:115], a[160:175]
  ds_read_b64_tr_b16 v[172:173], v181 offset:38912
  ds_write_b128 v243, a[220:223]
  v_mfma_f32_32x32x16_bf16 a[176:191], v[164:167], a[116:119], a[176:191]
  ds_read_b64_tr_b16 v[174:175], v181 offset:39936
  buffer_load_dwordx4 a[52:55], v182, s[20:23], s46 offen offset:2048 sc1
  s_waitcnt lgkmcnt(4)
  v_mfma_f32_32x32x16_bf16 a[128:143], v[168:171], a[120:123], a[128:143]
  v_add_u32 v180, 65536, v180
  ds_read_b64_tr_b16 v[160:161], v180 offset:0
  buffer_load_dwordx4 a[56:59], v194, s[20:23], s46 offen offset:3072 sc1
  v_xor_b32 v240, 128, v88
  v_xor_b32 v242, 128, v96
  ds_write_b128 v240, a[224:227] offset:0
  v_mfma_f32_32x32x16_bf16 a[144:159], v[168:171], a[124:127], a[144:159]
  ds_read_b64_tr_b16 v[162:163], v180 offset:1024
  ds_write_b128 v242, a[240:243]
  s_waitcnt lgkmcnt(4)
  v_mfma_f32_32x32x16_bf16 a[160:175], v[172:175], a[120:123], a[160:175]
  v_add_u32 v181, 65536, v181
  ds_read_b64_tr_b16 v[164:165], v181 offset:0
  v_mfma_f32_32x32x16_bf16 a[176:191], v[172:175], a[124:127], a[176:191]
  ds_read_b64_tr_b16 v[166:167], v181 offset:1024
  buffer_load_dwordx4 a[60:63], v182, s[20:23], s46 offen offset:3072 sc1
  v_xor_b32 v241, 160, v88
  v_xor_b32 v243, 160, v96
  ds_write_b128 v241, a[228:231] offset:0
  s_waitcnt vmcnt(15) lgkmcnt(4)
  v_mfma_f32_32x32x16_bf16 a[128:143], v[160:163], a[0:3], a[128:143]
  ds_read_b64_tr_b16 v[168:169], v180 offset:2048
  s_add_u32 m0, s53, 32768
  s_add_u32 s47, s78, 327680
  buffer_load_dwordx4 v176, s[64:67], s47 offen offset:0 lds
  ds_write_b128 v243, a[244:247]
  s_waitcnt vmcnt(15)
  v_mfma_f32_32x32x16_bf16 a[144:159], v[160:163], a[4:7], a[144:159]
  ds_read_b64_tr_b16 v[170:171], v180 offset:3072
  buffer_load_dwordx4 v177, s[64:67], s47 offen offset:1024 lds
  s_waitcnt lgkmcnt(4)
  v_mfma_f32_32x32x16_bf16 a[160:175], v[164:167], a[0:3], a[160:175]
  ds_read_b64_tr_b16 v[172:173], v181 offset:2048
  buffer_load_dwordx4 v178, s[64:67], s47 offen offset:2048 lds
  v_xor_b32 v240, 192, v88
  v_xor_b32 v242, 192, v96
  ds_write_b128 v240, a[232:235] offset:0
  v_mfma_f32_32x32x16_bf16 a[176:191], v[164:167], a[4:7], a[176:191]
  ds_read_b64_tr_b16 v[174:175], v181 offset:3072
  buffer_load_dwordx4 v179, s[64:67], s47 offen offset:3072 lds
  ds_write_b128 v242, a[248:251]
  s_waitcnt vmcnt(17) lgkmcnt(4)
  v_mfma_f32_32x32x16_bf16 a[128:143], v[168:171], a[8:11], a[128:143]
  ds_read_b64_tr_b16 v[160:161], v180 offset:4096
  s_add_u32 m0, s53, 36864
  s_add_u32 s47, s78, 360448
  buffer_load_dwordx4 v176, s[64:67], s47 offen offset:0 lds
  s_waitcnt vmcnt(17)
  v_mfma_f32_32x32x16_bf16 a[144:159], v[168:171], a[12:15], a[144:159]
  ds_read_b64_tr_b16 v[162:163], v180 offset:5120
  buffer_load_dwordx4 v177, s[64:67], s47 offen offset:1024 lds
  v_xor_b32 v241, 224, v88
  v_xor_b32 v243, 224, v96
  ds_write_b128 v241, a[236:239] offset:0
  s_waitcnt lgkmcnt(4)
  v_mfma_f32_32x32x16_bf16 a[160:175], v[172:175], a[8:11], a[160:175]
  ds_read_b64_tr_b16 v[164:165], v181 offset:4096
  buffer_load_dwordx4 v178, s[64:67], s47 offen offset:2048 lds
  ds_write_b128 v243, a[252:255]
  v_mfma_f32_32x32x16_bf16 a[176:191], v[172:175], a[12:15], a[176:191]
  ds_read_b64_tr_b16 v[166:167], v181 offset:5120
  buffer_load_dwordx4 v179, s[64:67], s47 offen offset:3072 lds
  s_waitcnt vmcnt(19) lgkmcnt(4)
  v_mfma_f32_32x32x16_bf16 a[128:143], v[160:163], a[16:19], a[128:143]
  ds_read_b64_tr_b16 v[168:169], v180 offset:6144
  s_add_u32 s46, s72, 20480
  buffer_load_dwordx4 a[64:67], v194, s[20:23], s46 offen offset:0 sc1
  s_waitcnt vmcnt(19)
  v_mfma_f32_32x32x16_bf16 a[144:159], v[160:163], a[20:23], a[144:159]
  ds_read_b64_tr_b16 v[170:171], v180 offset:7168
  buffer_load_dwordx4 a[68:71], v182, s[20:23], s46 offen offset:0 sc1
  s_waitcnt lgkmcnt(2)
  v_mfma_f32_32x32x16_bf16 a[160:175], v[164:167], a[16:19], a[160:175]
  ds_read_b64_tr_b16 v[172:173], v181 offset:6144
  buffer_load_dwordx4 a[72:75], v194, s[20:23], s46 offen offset:1024 sc1
  v_mfma_f32_32x32x16_bf16 a[176:191], v[164:167], a[20:23], a[176:191]
  s_waitcnt lgkmcnt(0)
  s_barrier
  ds_read_b64_tr_b16 v[174:175], v181 offset:7168
  buffer_load_dwordx4 a[76:79], v182, s[20:23], s46 offen offset:1024 sc1
  ds_read_b128 v[96:99], v90 offset:0
  s_waitcnt vmcnt(21)
  v_mfma_f32_32x32x16_bf16 a[128:143], v[168:171], a[24:27], a[128:143]
  ds_read_b64_tr_b16 v[160:161], v180 offset:32768
  buffer_load_dwordx4 a[80:83], v194, s[20:23], s46 offen offset:2048 sc1
  ds_read_b128 v[112:115], v90 offset:8192
  s_waitcnt vmcnt(21)
  v_mfma_f32_32x32x16_bf16 a[144:159], v[168:171], a[28:31], a[144:159]
  ds_read_b64_tr_b16 v[162:163], v180 offset:33792
  buffer_load_dwordx4 a[84:87], v182, s[20:23], s46 offen offset:2048 sc1
  ds_read_b128 v[128:131], v90 offset:16384
  s_waitcnt lgkmcnt(5)
  v_mfma_f32_32x32x16_bf16 a[160:175], v[172:175], a[24:27], a[160:175]
  ds_read_b64_tr_b16 v[164:165], v181 offset:32768
  buffer_load_dwordx4 a[88:91], v194, s[20:23], s46 offen offset:3072 sc1
  ds_read_b128 v[144:147], v90 offset:24576
  v_mfma_f32_32x32x16_bf16 a[176:191], v[172:175], a[28:31], a[176:191]
  ds_read_b64_tr_b16 v[166:167], v181 offset:33792
  buffer_load_dwordx4 a[92:95], v182, s[20:23], s46 offen offset:3072 sc1
  ds_read_b128 v[100:103], v91 offset:1024
  s_waitcnt vmcnt(23) lgkmcnt(5)
  v_mfma_f32_32x32x16_bf16 a[128:143], v[160:163], a[32:35], a[128:143]
  ds_read_b64_tr_b16 v[168:169], v180 offset:34816
  ds_read_b128 v[116:119], v91 offset:9216
  s_waitcnt vmcnt(22)
  v_mfma_f32_32x32x16_bf16 a[144:159], v[160:163], a[36:39], a[144:159]
  ds_read_b64_tr_b16 v[170:171], v180 offset:35840
  ds_read_b128 v[132:135], v91 offset:17408
  s_waitcnt lgkmcnt(5)
  v_mfma_f32_32x32x16_bf16 a[160:175], v[164:167], a[32:35], a[160:175]
  ds_read_b64_tr_b16 v[172:173], v181 offset:34816
  ds_read_b128 v[148:151], v91 offset:25600
  v_mfma_f32_32x32x16_bf16 a[176:191], v[164:167], a[36:39], a[176:191]
  ds_read_b64_tr_b16 v[174:175], v181 offset:35840
  ds_read_b128 v[104:107], v92 offset:2048
  s_waitcnt vmcnt(21) lgkmcnt(5)
  v_mfma_f32_32x32x16_bf16 a[128:143], v[168:171], a[40:43], a[128:143]
  ds_read_b64_tr_b16 v[160:161], v180 offset:36864
  ds_read_b128 v[120:123], v92 offset:10240
  s_waitcnt vmcnt(20)
  v_mfma_f32_32x32x16_bf16 a[144:159], v[168:171], a[44:47], a[144:159]
  ds_read_b64_tr_b16 v[162:163], v180 offset:37888
  ds_read_b128 v[136:139], v92 offset:18432
  s_waitcnt lgkmcnt(5)
  v_mfma_f32_32x32x16_bf16 a[160:175], v[172:175], a[40:43], a[160:175]
  ds_read_b64_tr_b16 v[164:165], v181 offset:36864
  ds_read_b128 v[152:155], v92 offset:26624
  v_mfma_f32_32x32x16_bf16 a[176:191], v[172:175], a[44:47], a[176:191]
  ds_read_b64_tr_b16 v[166:167], v181 offset:37888
  ds_read_b128 v[108:111], v93 offset:3072
  s_waitcnt vmcnt(19) lgkmcnt(5)
  v_mfma_f32_32x32x16_bf16 a[128:143], v[160:163], a[48:51], a[128:143]
  ds_read_b64_tr_b16 v[168:169], v180 offset:38912
  ds_read_b128 v[124:127], v93 offset:11264
  s_waitcnt vmcnt(18)
  v_mfma_f32_32x32x16_bf16 a[144:159], v[160:163], a[52:55], a[144:159]
  ds_read_b64_tr_b16 v[170:171], v180 offset:39936
  ds_read_b128 v[140:143], v93 offset:19456
  s_waitcnt lgkmcnt(5)
  v_mfma_f32_32x32x16_bf16 a[160:175], v[164:167], a[48:51], a[160:175]
  ds_read_b64_tr_b16 v[172:173], v181 offset:38912
  ds_read_b128 v[156:159], v93 offset:27648
  s_mul_i32 s48, s38, 98304
  s_sub_u32 s48, 65536, s48
  v_add_u32 v90, s48, v90
  v_add_u32 v91, s48, v91
  v_add_u32 v92, s48, v92
  v_add_u32 v93, s48, v93
  v_mfma_f32_32x32x16_bf16 a[176:191], v[164:167], a[52:55], a[176:191]
  ds_read_b64_tr_b16 v[174:175], v181 offset:39936
  v_add_f32 v96, v96, v112
  v_add_f32 v128, v128, v144
  v_add_f32 v97, v97, v113
  v_add_f32 v129, v129, v145
  v_add_f32 v98, v98, v114
  v_add_f32 v130, v130, v146
  v_add_f32 v99, v99, v115
  s_waitcnt vmcnt(17) lgkmcnt(4)
  v_mfma_f32_32x32x16_bf16 a[128:143], v[168:171], a[56:59], a[128:143]
  s_waitcnt vmcnt(8)
  v_subrev_u32 v180, 65536, v180
  ds_read_b64_tr_b16 v[0:1], v180 offset:32768
  ds_read_b64_tr_b16 v[2:3], v180 offset:33792
  v_add_f32 v131, v131, v147
  v_add_f32 v96, v96, v128
  v_add_f32 v97, v97, v129
  v_add_f32 v98, v98, v130
  v_mfma_f32_32x32x16_bf16 a[144:159], v[168:171], a[60:63], a[144:159]
  ds_read_b64_tr_b16 v[4:5], v180 offset:34816
  ds_read_b64_tr_b16 v[6:7], v180 offset:35840
  v_add_f32 v99, v99, v131
  v_add_f32 v100, v100, v116
  v_add_f32 v132, v132, v148
  v_add_f32 v101, v101, v117
  v_add_f32 v133, v133, v149
  v_add_f32 v102, v102, v118
  s_waitcnt lgkmcnt(4)
  v_mfma_f32_32x32x16_bf16 a[160:175], v[172:175], a[56:59], a[160:175]
  ds_read_b64_tr_b16 v[8:9], v180 offset:36864
  ds_read_b64_tr_b16 v[10:11], v180 offset:37888
  v_add_f32 v134, v134, v150
  v_add_f32 v103, v103, v119
  v_add_f32 v135, v135, v151
  v_add_f32 v100, v100, v132
  v_add_f32 v101, v101, v133
  v_add_f32 v102, v102, v134
  v_mfma_f32_32x32x16_bf16 a[176:191], v[172:175], a[60:63], a[176:191]
  ds_read_b64_tr_b16 v[12:13], v180 offset:38912
  ds_read_b64_tr_b16 v[14:15], v180 offset:39936
  v_add_f32 v103, v103, v135
  v_add_f32 v104, v104, v120
  v_add_f32 v136, v136, v152
  v_add_f32 v105, v105, v121
  v_add_f32 v137, v137, v153
  v_add_f32 v106, v106, v122
  s_waitcnt vmcnt(7) lgkmcnt(6)
  v_mfma_f32_32x32x16_bf16 a[128:143], v[0:3], a[64:67], a[128:143]
  v_subrev_u32 v181, 65536, v181
  ds_read_b64_tr_b16 v[16:17], v181 offset:32768
  ds_read_b64_tr_b16 v[18:19], v181 offset:33792
  v_add_f32 v138, v138, v154
  v_add_f32 v107, v107, v123
  v_add_f32 v139, v139, v155
  v_add_f32 v104, v104, v136
  v_add_f32 v105, v105, v137
  s_waitcnt vmcnt(5) lgkmcnt(6)
  v_mfma_f32_32x32x16_bf16 a[128:143], v[4:7], a[72:75], a[128:143]
  ds_read_b64_tr_b16 v[20:21], v181 offset:34816
  ds_read_b64_tr_b16 v[22:23], v181 offset:35840
  v_add_f32 v106, v106, v138
  v_add_f32 v107, v107, v139
  v_add_f32 v108, v108, v124
  v_add_f32 v140, v140, v156
  v_add_f32 v109, v109, v125
  v_add_f32 v141, v141, v157
  s_waitcnt vmcnt(3) lgkmcnt(6)
  v_mfma_f32_32x32x16_bf16 a[128:143], v[8:11], a[80:83], a[128:143]
  ds_read_b64_tr_b16 v[24:25], v181 offset:36864
  ds_read_b64_tr_b16 v[26:27], v181 offset:37888
  v_add_f32 v110, v110, v126
  v_add_f32 v142, v142, v158
  v_add_f32 v111, v111, v127
  v_add_f32 v143, v143, v159
  v_add_f32 v108, v108, v140
  v_add_f32 v109, v109, v141
  s_waitcnt vmcnt(1) lgkmcnt(6)
  v_mfma_f32_32x32x16_bf16 a[128:143], v[12:15], a[88:91], a[128:143]
  ds_read_b64_tr_b16 v[28:29], v181 offset:38912
  ds_read_b64_tr_b16 v[30:31], v181 offset:39936
  v_add_f32 v110, v110, v142
  v_add_f32 v111, v111, v143
  v_add_f32 v96, v96, v72
  v_add_f32 v97, v97, v73
  v_add_f32 v98, v98, v74
  v_add_f32 v99, v99, v75
  v_mfma_f32_32x32x16_bf16 a[144:159], v[0:3], a[68:71], a[144:159]
  v_add_f32 v100, v100, v76
  v_add_f32 v101, v101, v77
  v_add_f32 v102, v102, v78
  v_add_f32 v103, v103, v79
  v_add_f32 v104, v104, v80
  v_add_f32 v105, v105, v81
  v_add_f32 v106, v106, v82
  v_add_f32 v107, v107, v83
  v_mfma_f32_32x32x16_bf16 a[144:159], v[4:7], a[76:79], a[144:159]
  ds_write_b128 v89, a[128:131] offset:0
  v_xor_b32 v241, 32, v89
  v_add_f32 v108, v108, v84
  v_add_f32 v109, v109, v85
  v_add_f32 v110, v110, v86
  v_add_f32 v111, v111, v87
  v_mfma_f32_32x32x16_bf16 a[144:159], v[8:11], a[84:87], a[144:159]
  ds_write_b128 v241, a[132:135] offset:0
  v_xor_b32 v240, 64, v89
  s_waitcnt vmcnt(0)
  v_mfma_f32_32x32x16_bf16 a[144:159], v[12:15], a[92:95], a[144:159]
  ds_write_b128 v240, a[136:139] offset:0
  v_xor_b32 v241, 96, v89
  s_waitcnt lgkmcnt(9)
  v_mfma_f32_32x32x16_bf16 a[160:175], v[16:19], a[64:67], a[160:175]
  ds_write_b128 v241, a[140:143] offset:0
  s_waitcnt lgkmcnt(8)
  v_mfma_f32_32x32x16_bf16 a[160:175], v[20:23], a[72:75], a[160:175]
  s_nop 4
  ds_write_b128 v89, a[144:147] offset:32768
  v_xor_b32 v241, 32, v89
  s_waitcnt lgkmcnt(7)
  v_mfma_f32_32x32x16_bf16 a[160:175], v[24:27], a[80:83], a[160:175]
  ds_write_b128 v241, a[148:151] offset:32768
  v_xor_b32 v240, 64, v89
  s_waitcnt lgkmcnt(6)
  v_mfma_f32_32x32x16_bf16 a[160:175], v[28:31], a[88:91], a[160:175]
  ds_write_b128 v240, a[152:155] offset:32768
  v_xor_b32 v241, 96, v89
  v_mfma_f32_32x32x16_bf16 a[176:191], v[16:19], a[68:71], a[176:191]
  ds_write_b128 v241, a[156:159] offset:32768
  v_mfma_f32_32x32x16_bf16 a[176:191], v[20:23], a[76:79], a[176:191]
  v_xor_b32 v240, 128, v89
  s_nop 5
  ds_write_b128 v240, a[160:163] offset:0
  v_mfma_f32_32x32x16_bf16 a[176:191], v[24:27], a[84:87], a[176:191]
  v_xor_b32 v241, 160, v89
  ds_write_b128 v241, a[164:167] offset:0
  v_mfma_f32_32x32x16_bf16 a[176:191], v[28:31], a[92:95], a[176:191]
  v_xor_b32 v240, 192, v89
  ds_write_b128 v240, a[168:171] offset:0
  v_xor_b32 v241, 224, v89
  ds_write_b128 v241, a[172:175] offset:0
  v_xor_b32 v240, 128, v89
  s_nop 6
  ds_write_b128 v240, a[176:179] offset:32768
  v_xor_b32 v241, 160, v89
  ds_write_b128 v241, a[180:183] offset:32768
  v_xor_b32 v240, 192, v89
  ds_write_b128 v240, a[184:187] offset:32768
  v_xor_b32 v241, 224, v89
  ds_write_b128 v241, a[188:191] offset:32768
  v_mov_b32 v160, 0xbfb8aa3b
  v_mov_b32 v162, 1.0
  v_mov_b32 v161, 0xbfb8aa3b
  v_mov_b32 v163, 1.0
  s_waitcnt lgkmcnt(0)
  s_barrier
  ds_read_b128 v[0:3], v90 offset:0
  ds_read_b128 v[112:115], v90 offset:8192
  ds_read_b128 v[128:131], v90 offset:16384
  ds_read_b128 v[144:147], v90 offset:24576
  ds_read_b128 v[4:7], v91 offset:1024
  ds_read_b128 v[116:119], v91 offset:9216
  ds_read_b128 v[132:135], v91 offset:17408
  ds_read_b128 v[148:151], v91 offset:25600
  ds_read_b128 v[8:11], v92 offset:2048
  ds_read_b128 v[120:123], v92 offset:10240
  ds_read_b128 v[136:139], v92 offset:18432
  ds_read_b128 v[152:155], v92 offset:26624
  ds_read_b128 v[12:15], v93 offset:3072
  ds_read_b128 v[124:127], v93 offset:11264
  ds_read_b128 v[140:143], v93 offset:19456
  ds_read_b128 v[156:159], v93 offset:27648
  s_waitcnt lgkmcnt(12)
  v_pk_add_f32 v[0:1], v[0:1], v[144:145]
  v_pk_add_f32 v[112:113], v[112:113], v[128:129]
  v_pk_add_f32 v[2:3], v[2:3], v[146:147]
  v_pk_add_f32 v[114:115], v[114:115], v[130:131]
  v_pk_add_f32 v[0:1], v[0:1], v[112:113]
  v_pk_add_f32 v[2:3], v[2:3], v[114:115]
  v_pk_mul_f32 v[112:113], v[0:1], v[160:161]
  v_pk_mul_f32 v[114:115], v[2:3], v[160:161]
  v_exp_f32 v112, v112
  v_exp_f32 v113, v113
  v_exp_f32 v114, v114
  v_exp_f32 v115, v115
  v_pk_add_f32 v[112:113], v[112:113], v[162:163]
  v_pk_add_f32 v[114:115], v[114:115], v[162:163]
  v_rcp_f32 v112, v112
  v_rcp_f32 v113, v113
  v_rcp_f32 v114, v114
  v_rcp_f32 v115, v115
  v_pk_mul_f32 v[0:1], v[0:1], v[112:113]
  v_pk_mul_f32 v[2:3], v[2:3], v[114:115]
  v_pk_fma_f32 v[0:1], v[0:1], v[96:97], v[56:57]
  v_pk_fma_f32 v[2:3], v[2:3], v[98:99], v[58:59]
  s_add_u32 s48, s88, 0
  buffer_store_dwordx4 v[0:3], v95, s[92:95], s48 offen sc0 sc1
  s_waitcnt lgkmcnt(8)
  v_pk_add_f32 v[4:5], v[4:5], v[148:149]
  v_pk_add_f32 v[116:117], v[116:117], v[132:133]
  v_pk_add_f32 v[6:7], v[6:7], v[150:151]
  v_pk_add_f32 v[118:119], v[118:119], v[134:135]
  v_pk_add_f32 v[4:5], v[4:5], v[116:117]
  v_pk_add_f32 v[6:7], v[6:7], v[118:119]
  v_pk_mul_f32 v[116:117], v[4:5], v[160:161]
  v_pk_mul_f32 v[118:119], v[6:7], v[160:161]
  v_exp_f32 v116, v116
  v_exp_f32 v117, v117
  v_exp_f32 v118, v118
  v_exp_f32 v119, v119
  v_pk_add_f32 v[116:117], v[116:117], v[162:163]
  v_pk_add_f32 v[118:119], v[118:119], v[162:163]
  v_rcp_f32 v116, v116
  v_rcp_f32 v117, v117
  v_rcp_f32 v118, v118
  v_rcp_f32 v119, v119
  v_pk_mul_f32 v[4:5], v[4:5], v[116:117]
  v_pk_mul_f32 v[6:7], v[6:7], v[118:119]
  v_pk_fma_f32 v[4:5], v[4:5], v[100:101], v[60:61]
  v_pk_fma_f32 v[6:7], v[6:7], v[102:103], v[62:63]
  s_add_u32 s48, s88, 8192
  buffer_store_dwordx4 v[4:7], v95, s[92:95], s48 offen sc0 sc1
  s_waitcnt lgkmcnt(4)
  v_pk_add_f32 v[8:9], v[8:9], v[152:153]
  v_pk_add_f32 v[120:121], v[120:121], v[136:137]
  v_pk_add_f32 v[10:11], v[10:11], v[154:155]
  v_pk_add_f32 v[122:123], v[122:123], v[138:139]
  v_pk_add_f32 v[8:9], v[8:9], v[120:121]
  v_pk_add_f32 v[10:11], v[10:11], v[122:123]
  v_pk_mul_f32 v[120:121], v[8:9], v[160:161]
  v_pk_mul_f32 v[122:123], v[10:11], v[160:161]
  v_exp_f32 v120, v120
  v_exp_f32 v121, v121
  v_exp_f32 v122, v122
  v_exp_f32 v123, v123
  v_pk_add_f32 v[120:121], v[120:121], v[162:163]
  v_pk_add_f32 v[122:123], v[122:123], v[162:163]
  v_rcp_f32 v120, v120
  v_rcp_f32 v121, v121
  v_rcp_f32 v122, v122
  v_rcp_f32 v123, v123
  v_pk_mul_f32 v[8:9], v[8:9], v[120:121]
  v_pk_mul_f32 v[10:11], v[10:11], v[122:123]
  v_pk_fma_f32 v[8:9], v[8:9], v[104:105], v[64:65]
  v_pk_fma_f32 v[10:11], v[10:11], v[106:107], v[66:67]
  s_add_u32 s48, s88, 16384
  buffer_store_dwordx4 v[8:11], v95, s[92:95], s48 offen sc0 sc1
  s_waitcnt lgkmcnt(0)
  v_pk_add_f32 v[12:13], v[12:13], v[156:157]
  v_pk_add_f32 v[124:125], v[124:125], v[140:141]
  v_pk_add_f32 v[14:15], v[14:15], v[158:159]
  v_pk_add_f32 v[126:127], v[126:127], v[142:143]
  v_pk_add_f32 v[12:13], v[12:13], v[124:125]
  v_pk_add_f32 v[14:15], v[14:15], v[126:127]
  v_pk_mul_f32 v[124:125], v[12:13], v[160:161]
  v_pk_mul_f32 v[126:127], v[14:15], v[160:161]
  v_exp_f32 v124, v124
  v_exp_f32 v125, v125
  v_exp_f32 v126, v126
  v_exp_f32 v127, v127
  v_pk_add_f32 v[124:125], v[124:125], v[162:163]
  v_pk_add_f32 v[126:127], v[126:127], v[162:163]
  v_rcp_f32 v124, v124
  v_rcp_f32 v125, v125
  v_rcp_f32 v126, v126
  v_rcp_f32 v127, v127
  v_pk_mul_f32 v[12:13], v[12:13], v[124:125]
  v_pk_mul_f32 v[14:15], v[14:15], v[126:127]
  v_pk_fma_f32 v[12:13], v[12:13], v[108:109], v[68:69]
  v_pk_fma_f32 v[14:15], v[14:15], v[110:111], v[70:71]
  s_add_u32 s48, s88, 24576
  buffer_store_dwordx4 v[12:15], v95, s[92:95], s48 offen sc0 sc1
  s_endpgm
FZL_nps2:
  s_mov_b32 s3, 0
FZL_nps2l:
  buffer_load_dword v114, v115, s[28:31], 0 offen sc1
  s_waitcnt vmcnt(0)
  v_readfirstlane_b32 s36, v114
  s_add_u32 s3, s3, 1
  s_cmp_gt_u32 s3, 100000
  s_cbranch_scc1 FZL_npr3
  s_cmp_eq_u32 s36, 0
  s_cbranch_scc1 FZL_nps2l
  s_nop 4
  s_branch FZL_npr3
FZL_slow4:
  s_mov_b32 s3, 0
FZL_slow4l:
  buffer_load_dwordx2 v[136:137], v143, s[20:23], s96 offen sc1
  buffer_load_dwordx2 v[138:139], v143, s[20:23], s96 offen offset:256 sc1
  buffer_load_dwordx2 v[140:141], v144, s[20:23], s97 offen sc1
  s_waitcnt vmcnt(0)
  v_cmp_ne_u32 s[60:61], s36, v137
  v_cmp_ne_u32 vcc, s36, v139
  s_nop 0
  s_or_b64 s[60:61], s[60:61], vcc
  v_cmp_ne_u32 vcc, s36, v141
  s_nop 0
  s_or_b64 s[60:61], s[60:61], vcc
  s_add_u32 s3, s3, 1
  s_cmp_gt_u32 s3, 100000
  s_cbranch_scc1 FZL_ret5
  s_cmp_lg_u64 s[60:61], 0
  s_cbranch_scc1 FZL_slow4l
  s_nop 4
  s_branch FZL_ret5
FZL_slow6:
  s_mov_b32 s3, 0
FZL_slow6l:
  buffer_load_dwordx4 v[96:99], v194, s[20:23], s62 offen offset:0 sc1
  buffer_load_dwordx4 v[100:103], v194, s[20:23], s62 offen offset:1024 sc1
  buffer_load_dwordx4 v[104:107], v194, s[20:23], s62 offen offset:2048 sc1
  buffer_load_dwordx4 v[108:111], v194, s[20:23], s62 offen offset:3072 sc1
  s_waitcnt vmcnt(0)
  v_cmp_ne_u32 s[60:61], s36, v97
  v_cmp_ne_u32 vcc, s36, v99
  s_nop 0
  s_or_b64 s[60:61], s[60:61], vcc
  v_cmp_ne_u32 vcc, s36, v101
  s_nop 0
  s_or_b64 s[60:61], s[60:61], vcc
  v_cmp_ne_u32 vcc, s36, v103
  s_nop 0
  s_or_b64 s[60:61], s[60:61], vcc
  v_cmp_ne_u32 vcc, s36, v105
  s_nop 0
  s_or_b64 s[60:61], s[60:61], vcc
  v_cmp_ne_u32 vcc, s36, v107
  s_nop 0
  s_or_b64 s[60:61], s[60:61], vcc
  v_cmp_ne_u32 vcc, s36, v109
  s_nop 0
  s_or_b64 s[60:61], s[60:61], vcc
  v_cmp_ne_u32 vcc, s36, v111
  s_nop 0
  s_or_b64 s[60:61], s[60:61], vcc
  s_add_u32 s3, s3, 1
  s_cmp_gt_u32 s3, 100000
  s_cbranch_scc1 FZL_ret7
  s_cmp_lg_u64 s[60:61], 0
  s_cbranch_scc1 FZL_slow6l
  s_nop 4
  s_branch FZL_ret7
FZL_slow8:
  s_mov_b32 s3, 0
FZL_slow8l:
  buffer_load_dwordx4 v[32:35], v48, s[20:23], s96 offen sc1
  buffer_load_dwordx4 v[36:39], v49, s[20:23], s96 offen sc1
  buffer_load_dwordx4 v[40:43], v50, s[20:23], s96 offen sc1
  buffer_load_dwordx4 v[44:47], v51, s[20:23], s96 offen sc1
  s_waitcnt vmcnt(0)
  v_cmp_ne_u32 s[60:61], v52, v33
  v_cmp_ne_u32 vcc, v52, v35
  s_nop 0
  s_or_b64 s[60:61], s[60:61], vcc
  v_cmp_ne_u32 vcc, v53, v37
  s_nop 0
  s_or_b64 s[60:61], s[60:61], vcc
  v_cmp_ne_u32 vcc, v53, v39
  s_nop 0
  s_or_b64 s[60:61], s[60:61], vcc
  v_cmp_ne_u32 vcc, v54, v41
  s_nop 0
  s_or_b64 s[60:61], s[60:61], vcc
  v_cmp_ne_u32 vcc, v54, v43
  s_nop 0
  s_or_b64 s[60:61], s[60:61], vcc
  v_cmp_ne_u32 vcc, v55, v45
  s_nop 0
  s_or_b64 s[60:61], s[60:61], vcc
  v_cmp_ne_u32 vcc, v55, v47
  s_nop 0
  s_or_b64 s[60:61], s[60:61], vcc
  s_add_u32 s3, s3, 1
  s_cmp_gt_u32 s3, 100000
  s_cbranch_scc1 FZL_ret9
  s_cmp_lg_u64 s[60:61], 0
  s_cbranch_scc1 FZL_slow8l
  s_nop 4
  s_branch FZL_ret9
FZL_pslow10:
  s_mov_b32 s3, 0
FZL_pslow10l:
  buffer_load_dword v253, v183, s[20:23], s74 offen sc1
  s_waitcnt vmcnt(0)
  v_cmp_eq_u32 vcc, s36, v253
  s_nop 0
  s_and_b32 s45, vcc_lo, 0xff
  s_add_u32 s3, s3, 1
  s_cmp_gt_u32 s3, 100000
  s_cbranch_scc1 FZL_pret11
  s_cmp_eq_u32 s45, 0xff
  s_cbranch_scc0 FZL_pslow10l
  s_nop 4
  s_branch FZL_pret11
FZL_pslow12:
  s_mov_b32 s3, 0
FZL_pslow12l:
  buffer_load_dword v253, v183, s[20:23], s74 offen sc1
  s_waitcnt vmcnt(0)
  v_cmp_eq_u32 vcc, s36, v253
  s_nop 0
  s_and_b32 s45, vcc_lo, 0xff00
  s_add_u32 s3, s3, 1
  s_cmp_gt_u32 s3, 100000
  s_cbranch_scc1 FZL_pret13
  s_cmp_eq_u32 s45, 0xff00
  s_cbranch_scc0 FZL_pslow12l
  s_nop 4
  s_branch FZL_pret13
FZL_pslow14:
  s_mov_b32 s3, 0
FZL_pslow14l:
  buffer_load_dword v253, v183, s[20:23], s74 offen sc1
  s_waitcnt vmcnt(0)
  v_cmp_eq_u32 vcc, s36, v253
  s_nop 0
  s_and_b32 s45, vcc_lo, 0x3f0000
  s_add_u32 s3, s3, 1
  s_cmp_gt_u32 s3, 100000
  s_cbranch_scc1 FZL_pret15
  s_cmp_eq_u32 s45, 0x3f0000
  s_cbranch_scc0 FZL_pslow14l
  s_nop 4
  s_branch FZL_pret15
FZ_done:
  s_endpgm
TEXT_END:
  s_endpgm
.section .rodata,"a"
.p2align 6
.amdhsa_kernel recurrent_scan__ssm_conv_s5__glu_gated_swiglu__prompt_kernel
  .amdhsa_next_free_vgpr 512
  .amdhsa_next_free_sgpr 102
  .amdhsa_accum_offset 256
  .amdhsa_group_segment_fixed_size 0
  .amdhsa_kernarg_size 128
  .amdhsa_user_sgpr_count 2
  .amdhsa_user_sgpr_kernarg_segment_ptr 1
  .amdhsa_system_sgpr_workgroup_id_x 1
.end_amdhsa_kernel
```
